```python
import torch

def _softmax(x, axis=-1):
    return torch.softmax(x, dim=axis)
def _gelu(x):
    return torch.nn.functional.gelu(x, approximate="tanh")
def _silu(x):
    return torch.nn.functional.silu(x)
def _sigmoid(x):
    return torch.sigmoid(x)
def _layernorm(x, axis=-1, eps=1e-5):
    m = x.mean(dim=axis, keepdim=True)
    v = x.var(dim=axis, keepdim=True, unbiased=False)
    return (x - m) / torch.sqrt(v + eps)
def _scatter_add(tgt, idx, src, axis=0):
    return tgt.clone().index_add_(axis, idx, src)
def _segment_sum(src, seg, n):
    out = torch.zeros((n,) + src.shape[1:], dtype=src.dtype)
    return out.index_add_(0, seg, src)
def _pad(x, pw):
    flat = tuple(v for pair in reversed(pw) for v in pair)
    return torch.nn.functional.pad(x, flat)

kernel_name = 'parallel_sum__ssm_conv_s5__glu_gated_bilinear__prompt'

def setup_inputs():

    _w = (lambda a: (lambda t: t.to(torch.bfloat16) if t.is_floating_point() else t)(torch.as_tensor(a)))
    def _A_setup():
        B, S, D = 1, 2048, 640
        P = D
        Lambda_re = -0.5 * (lambda _x: torch.exp(torch.as_tensor(_x)))((lambda *s: torch.randn(*s, dtype=torch.bfloat16) * 0.2)(P))
        Lambda_im = (lambda *s: torch.randn(*s, dtype=torch.bfloat16) * 0.8)(P) * 1.0
        B_re = (lambda *s: torch.randn(*s, dtype=torch.bfloat16) * 0.2)(P, D) * (D ** -0.5)
        B_im = (lambda *s: torch.randn(*s, dtype=torch.bfloat16) * 0.2)(P, D) * (D ** -0.5)
        C_re = (lambda *s: torch.randn(*s, dtype=torch.bfloat16) * 0.2)(D, P) * (P ** -0.5)
        C_im = (lambda *s: torch.randn(*s, dtype=torch.bfloat16) * 0.2)(D, P) * (P ** -0.5)
        log_dt = (lambda *s: torch.randn(*s, dtype=torch.bfloat16) * 0.2)(P) * 0.3 - 2.0
        Dskip = (lambda *s: torch.randn(*s, dtype=torch.bfloat16) * 0.05)(D)
        return {
            "x": _w((lambda *s: torch.randn(*s, dtype=torch.bfloat16) * 0.05)(B, S, D)),
            "Lambda_re": _w(Lambda_re),
            "Lambda_im": _w(Lambda_im),
            "B_re": _w(B_re),
            "B_im": _w(B_im),
            "C_re": _w(C_re),
            "C_im": _w(C_im),
            "log_dt": _w(log_dt),
            "Dskip": _w(Dskip),
        }
    _A_in = _A_setup()

    def _B_setup():
        B, S, D, F = 1, 2048, 640, 1728
        return {
            "x": _w((lambda *s: torch.randn(*s, dtype=torch.bfloat16) * 0.05)(B, S, D)),
            "w_gate": _w((lambda *s: torch.randn(*s, dtype=torch.bfloat16) * 0.4)(D, F) * (D ** -0.5)),
            "w_up": _w((lambda *s: torch.randn(*s, dtype=torch.bfloat16) * 0.4)(D, F) * (D ** -0.5)),
            "w_down": _w((lambda *s: torch.randn(*s, dtype=torch.bfloat16) * 0.4)(F, D) * (F ** -0.5)),
        }
    _B_in = _B_setup()

    return {
        "A_x": _A_in["x"],
        "A_Lambda_re": _A_in["Lambda_re"],
        "A_Lambda_im": _A_in["Lambda_im"],
        "A_B_re": _A_in["B_re"],
        "A_B_im": _A_in["B_im"],
        "A_C_re": _A_in["C_re"],
        "A_C_im": _A_in["C_im"],
        "A_log_dt": _A_in["log_dt"],
        "A_Dskip": _A_in["Dskip"],
        "B_x": _B_in["x"],
        "B_w_gate": _B_in["w_gate"],
        "B_w_up": _B_in["w_up"],
        "B_w_down": _B_in["w_down"],
    }

def reference(A_x, A_Lambda_re, A_Lambda_im, A_B_re, A_B_im, A_C_re, A_C_im, A_log_dt, A_Dskip, B_x, B_w_gate, B_w_up, B_w_down):
    def _A_ref(x, Lambda_re, Lambda_im, B_re, B_im, C_re, C_im, log_dt, Dskip):
        Bsz, L, H = x.shape
        Lam = Lambda_re + 1j * Lambda_im
        Bmat = B_re + 1j * B_im
        Cmat = C_re + 1j * C_im
        dt = torch.exp(log_dt)
        Lam_bar = torch.exp(dt * Lam)
        B_bar = ((Lam_bar - 1.0) / Lam)[:, None] * Bmat
        Bu = torch.einsum("bld,pd->blp", x + 0j, B_bar)
        h = torch.zeros_like(Bu[:, 0, :])
        hs = []
        for t in range(L):
            h = Lam_bar[None, :] * h + Bu[:, t, :]
            hs.append(h)
        hseq = torch.stack(hs, 1)
        y = 2.0 * torch.einsum("blp,dp->bld", hseq, Cmat).real + x * Dskip[None, None, :]
        return y

    def _B_ref(x, w_gate, w_up, w_down):
        g = torch.einsum("bsd,df->bsf", x, w_gate)
        u = torch.einsum("bsd,df->bsf", x, w_up)
        h = g * u
        return torch.einsum("bsf,fd->bsd", h, w_down)

    x = A_x
    xn = _layernorm(x, axis=-1)
    return x + _A_ref(xn, A_Lambda_re, A_Lambda_im, A_B_re, A_B_im, A_C_re, A_C_im, A_log_dt, A_Dskip) + _B_ref(xn, B_w_gate, B_w_up, B_w_down)
```

```asm
; @launch kernel=gemm1_kernel grid=(256,1,1) block=(512,1,1) lds=163840
.amdgcn_target "amdgcn-amd-amdhsa--gfx950"
.text
.p2align 8
.type gemm1_kernel,@function
gemm1_kernel:
  s_cmp_ge_u32 s2, 256
  s_cbranch_scc1 K1_END
  s_load_dwordx2 s[4:5], s[0:1], 120
  s_load_dwordx2 s[6:7], s[0:1], 0
  s_load_dwordx4 s[44:47], s[0:1], 8
  s_load_dwordx4 s[48:51], s[0:1], 24
  s_load_dwordx2 s[52:53], s[0:1], 56
  s_load_dwordx2 s[54:55], s[0:1], 112
  s_load_dwordx4 s[56:59], s[0:1], 80
  s_load_dwordx2 s[96:97], s[0:1], 64
  s_load_dwordx2 s[100:101], s[0:1], 104
  v_and_b32 v1, 63, v0
  v_lshrrev_b32 v2, 6, v0
  s_nop 0
  v_readfirstlane_b32 s3, v2
  s_and_b32 s60, s2, 7
  s_lshr_b32 s61, s2, 3
  s_lshr_b32 s62, s60, 2
  s_and_b32 s63, s60, 3
  s_lshl_b32 s62, s62, 2
  s_lshr_b32 s64, s61, 3
  s_add_u32 s62, s62, s64
  s_and_b32 s64, s61, 7
  s_lshl_b32 s86, s63, 3
  s_lshr_b32 s65, 0x18120c07, s86
  s_and_b32 s65, s65, 255
  s_add_u32 s65, s65, s64
  s_add_u32 s86, s86, s64
  s_lshl_b32 s64, s64, 2
  s_add_u32 s63, s63, s64
  s_cmp_lt_u32 s63, 10
  s_cselect_b32 s63, s63, s65
  s_mov_b32 s35, s63
  s_waitcnt lgkmcnt(0)

  s_mov_b32 s8, s6
  s_mov_b32 s9, s7
  s_mov_b32 s10, 2621440
  s_mov_b32 s11, 0x20000
  s_sub_u32 s65, s3, 4
  s_cmp_ge_u32 s65, 2
  s_cbranch_scc1 K1_NOTLOADER

  s_and_b32 s43, s3, 1
  v_and_b32 v31, 15, v1
  s_lshr_b32 s65, s61, 3
  s_lshl_b32 s65, s65, 4
  s_mov_b32 s15, 0x20000
  s_cmp_lt_u32 s63, 10
  s_cselect_b64 vcc, -1, 0
  s_cbranch_scc1 K1_LT_SSM
  s_sub_u32 s63, s63, 10
  s_cmp_eq_u32 s43, 0
  s_cselect_b32 s12, s56, s58
  s_cselect_b32 s13, s57, s59
  s_mov_b32 s14, 2211840
  s_mul_i32 s40, s63, 160
  s_mov_b32 s33, 221184
  s_mul_i32 s65, s65, 3456
  v_mul_u32_u24 v22, 3456, v31
  v_bfe_u32 v23, v1, 4, 1
  v_mul_u32_u24 v23, 156, v23
  v_add_u32 v22, v22, v23
  s_mov_b32 exec_lo, -1
  s_branch K1_LT_GO

K1_LT_SSM:
  s_cmp_eq_u32 s43, 0
  s_cselect_b32 s12, s48, s50
  s_cselect_b32 s13, s49, s51
  s_mov_b32 s14, 819200
  s_mul_i32 s40, s63, 81920
  s_mov_b32 s33, 128
  s_mul_i32 s65, s65, 1280
  v_mul_u32_u24 v22, 1280, v31
  s_mov_b32 exec_lo, 0xffff

K1_LT_GO:
  s_mov_b32 exec_hi, 0
  s_add_u32 s65, s65, s40
  s_lshl_b32 s66, s62, 8
  s_and_b32 s67, s61, 7
  s_lshl_b32 s67, s67, 5
  s_add_u32 s66, s66, s67
  s_lshl_b32 s67, s43, 4
  s_add_u32 s66, s66, s67
  s_mul_i32 s66, s66, 1280
  v_mul_u32_u24 v23, 1280, v31

  buffer_load_dword v26, v22, s[12:15], s65 offen
  buffer_load_dword v40, v23, s[8:11], s66 offen offset:0
  s_add_u32 s65, s65, s33
  buffer_load_dword v27, v22, s[12:15], s65 offen
  buffer_load_dword v41, v23, s[8:11], s66 offen offset:128
  s_add_u32 s65, s65, s33
  buffer_load_dword v28, v22, s[12:15], s65 offen
  buffer_load_dword v42, v23, s[8:11], s66 offen offset:256
  s_add_u32 s65, s65, s33
  s_mov_b64 exec, -1
  v_mov_b32 v17, v22
  v_mul_u32_u24 v18, 1280, v31
  s_mov_b32 s88, s65
  s_add_u32 s89, s66, 384
  s_lshl_b32 s64, s62, 8
  s_lshl_b32 s65, s43, 7
  s_add_u32 s64, s64, s65
  s_mul_i32 s20, s64, 1280
  s_lshl_b32 s41, s43, 14
  v_lshrrev_b32 v20, 3, v1
  v_and_b32 v21, 7, v1
  s_movk_i32 s66, 20480
  s_movk_i32 s67, 10240
  s_cmp_lg_u64 vcc, 0
  s_cselect_b32 s66, 2560, s66
  v_lshrrev_b32 v23, 4, v1
  v_xor_b32 v23, v23, v21
  v_bfe_u32 v24, v1, 5, 1
  v_lshlrev_b32 v24, 4, v24
  v_bfe_u32 v25, v1, 3, 1
  v_lshl_add_u32 v24, v25, 3, v24
  v_bfe_u32 v25, v1, 4, 1
  v_add_u32 v24, v24, v25
  v_cndmask_b32 v24, v20, v24, vcc
  v_mul_u32_u24 v24, 1280, v24
  v_lshl_add_u32 v4, v23, 4, v24
  s_cselect_b32 s67, 40960, s67
  v_xor_b32 v5, 64, v4
  v_add_u32 v5, s67, v5
  s_add_u32 s21, s20, s66
  s_add_u32 s22, s21, s66
  s_add_u32 s23, s22, s66
  s_add_u32 s24, s20, 81920
  s_add_u32 s25, s21, 81920
  s_add_u32 s26, s22, 81920
  s_add_u32 s27, s23, 81920
  s_mov_b32 s36, 0
  s_mov_b32 s37, s41
  s_mul_i32 s42, s43, 10240
  s_add_u32 s42, s42, 98304
  s_mov_b32 s30, s42
  s_add_u32 s31, s30, 5120
  s_cbranch_vccnz K1_LW_SSM
  s_mov_b32 s39, 110592
  s_mov_b32 s34, 0

  v_add_u32 v22, 0, v1
  v_mul_u32_u24 v23, 6554, v22
  v_lshrrev_b32 v23, 16, v23
  v_mul_u32_u24 v24, 10, v23
  v_sub_u32 v24, v22, v24
  v_and_b32 v25, 0x33, v23
  v_bfe_u32 v6, v23, 2, 1
  v_lshl_or_b32 v25, v6, 3, v25
  v_bfe_u32 v6, v23, 3, 1
  v_lshl_or_b32 v25, v6, 2, v25
  v_mul_u32_u24 v25, 3456, v25
  v_lshl_add_u32 v12, v24, 4, v25

  v_add_u32 v22, 64, v1
  v_mul_u32_u24 v23, 6554, v22
  v_lshrrev_b32 v23, 16, v23
  v_mul_u32_u24 v24, 10, v23
  v_sub_u32 v24, v22, v24
  v_and_b32 v25, 0x33, v23
  v_bfe_u32 v6, v23, 2, 1
  v_lshl_or_b32 v25, v6, 3, v25
  v_bfe_u32 v6, v23, 3, 1
  v_lshl_or_b32 v25, v6, 2, v25
  v_mul_u32_u24 v25, 3456, v25
  v_lshl_add_u32 v13, v24, 4, v25

  v_add_u32 v22, 128, v1
  v_mul_u32_u24 v23, 6554, v22
  v_lshrrev_b32 v23, 16, v23
  v_mul_u32_u24 v24, 10, v23
  v_sub_u32 v24, v22, v24
  v_and_b32 v25, 0x33, v23
  v_bfe_u32 v6, v23, 2, 1
  v_lshl_or_b32 v25, v6, 3, v25
  v_bfe_u32 v6, v23, 3, 1
  v_lshl_or_b32 v25, v6, 2, v25
  v_mul_u32_u24 v25, 3456, v25
  v_lshl_add_u32 v14, v24, 4, v25

  v_add_u32 v22, 192, v1
  v_mul_u32_u24 v23, 6554, v22
  v_lshrrev_b32 v23, 16, v23
  v_mul_u32_u24 v24, 10, v23
  v_sub_u32 v24, v22, v24
  v_and_b32 v25, 0x33, v23
  v_bfe_u32 v6, v23, 2, 1
  v_lshl_or_b32 v25, v6, 3, v25
  v_bfe_u32 v6, v23, 3, 1
  v_lshl_or_b32 v25, v6, 2, v25
  v_mul_u32_u24 v25, 3456, v25
  v_lshl_add_u32 v15, v24, 4, v25

  v_add_u32 v22, 256, v1
  v_mul_u32_u24 v23, 6554, v22
  v_lshrrev_b32 v23, 16, v23
  v_mul_u32_u24 v24, 10, v23
  v_sub_u32 v24, v22, v24
  v_and_b32 v25, 0x33, v23
  v_bfe_u32 v6, v23, 2, 1
  v_lshl_or_b32 v25, v6, 3, v25
  v_bfe_u32 v6, v23, 3, 1
  v_lshl_or_b32 v25, v6, 2, v25
  v_mul_u32_u24 v25, 3456, v25
  v_lshl_add_u32 v16, v24, 4, v25

  s_branch K1_LW_GO
K1_LW_SSM:
  s_mov_b32 s39, 40960
  s_mov_b32 s34, 0x40000000
  v_mul_u32_u24 v24, 1280, v20
  v_lshl_add_u32 v12, v23, 4, v24
  v_xor_b32 v13, 64, v12
  v_add_u32 v13, 10240, v13
  v_add_u32 v14, 20480, v12
  v_add_u32 v15, 20480, v13
  v_mov_b32 v16, v12

K1_LW_GO:
  s_load_dwordx4 s[80:83], s[0:1], 40
  s_load_dwordx2 s[84:85], s[0:1], 96
  s_waitcnt vmcnt(4)
  s_add_u32 m0, s37, 0
  s_add_u32 s68, s20, s36
  buffer_load_dwordx4 v4, s[8:11], s68 offen lds
  s_add_u32 m0, s37, 1024
  s_add_u32 s68, s20, s36
  buffer_load_dwordx4 v5, s[8:11], s68 offen lds
  s_add_u32 m0, s37, 2048
  s_add_u32 s68, s21, s36
  buffer_load_dwordx4 v4, s[8:11], s68 offen lds
  s_add_u32 m0, s37, 3072
  s_add_u32 s68, s21, s36
  buffer_load_dwordx4 v5, s[8:11], s68 offen lds
  s_add_u32 m0, s37, 4096
  s_add_u32 s68, s22, s36
  buffer_load_dwordx4 v4, s[8:11], s68 offen lds
  s_add_u32 m0, s37, 5120
  s_add_u32 s68, s22, s36
  buffer_load_dwordx4 v5, s[8:11], s68 offen lds
  s_add_u32 m0, s37, 6144
  s_add_u32 s68, s23, s36
  buffer_load_dwordx4 v4, s[8:11], s68 offen lds
  s_add_u32 m0, s37, 7168
  s_add_u32 s68, s23, s36
  buffer_load_dwordx4 v5, s[8:11], s68 offen lds
  s_add_u32 m0, s37, 8192
  s_add_u32 s68, s24, s36
  buffer_load_dwordx4 v4, s[8:11], s68 offen lds
  s_add_u32 m0, s37, 9216
  s_add_u32 s68, s24, s36
  buffer_load_dwordx4 v5, s[8:11], s68 offen lds
  s_add_u32 m0, s37, 10240
  s_add_u32 s68, s25, s36
  buffer_load_dwordx4 v4, s[8:11], s68 offen lds
  s_add_u32 m0, s37, 11264
  s_add_u32 s68, s25, s36
  buffer_load_dwordx4 v5, s[8:11], s68 offen lds
  s_add_u32 m0, s37, 12288
  s_add_u32 s68, s26, s36
  buffer_load_dwordx4 v4, s[8:11], s68 offen lds
  s_add_u32 m0, s37, 13312
  s_add_u32 s68, s26, s36
  buffer_load_dwordx4 v5, s[8:11], s68 offen lds
  s_add_u32 m0, s37, 14336
  s_add_u32 s68, s27, s36
  buffer_load_dwordx4 v4, s[8:11], s68 offen lds
  s_add_u32 m0, s37, 15360
  s_add_u32 s68, s27, s36
  buffer_load_dwordx4 v5, s[8:11], s68 offen lds
  s_mov_b32 s69, s40
  s_add_u32 m0, s30, 0
  s_nop 0
  buffer_load_dwordx4 v12, s[12:15], s69 offen lds
  s_add_u32 m0, s30, 1024
  s_nop 0
  buffer_load_dwordx4 v13, s[12:15], s69 offen lds
  s_add_u32 m0, s30, 2048
  s_nop 0
  buffer_load_dwordx4 v14, s[12:15], s69 offen lds
  s_add_u32 m0, s30, 3072
  s_nop 0
  buffer_load_dwordx4 v15, s[12:15], s69 offen lds
  s_add_u32 s69, s69, s34
  s_add_u32 m0, s30, 4096
  s_nop 0
  buffer_load_dwordx4 v16, s[12:15], s69 offen lds
  s_add_u32 s69, s40, s39
  s_add_u32 m0, s31, 0
  s_nop 0
  buffer_load_dwordx4 v12, s[12:15], s69 offen lds
  s_add_u32 m0, s31, 1024
  s_nop 0
  buffer_load_dwordx4 v13, s[12:15], s69 offen lds
  s_add_u32 m0, s31, 2048
  s_nop 0
  buffer_load_dwordx4 v14, s[12:15], s69 offen lds
  s_add_u32 m0, s31, 3072
  s_nop 0
  buffer_load_dwordx4 v15, s[12:15], s69 offen lds
  s_add_u32 s69, s69, s34
  s_add_u32 m0, s31, 4096
  s_nop 0
  buffer_load_dwordx4 v16, s[12:15], s69 offen lds
  s_add_u32 s40, s40, s33
  s_add_u32 s36, s36, 128
  s_add_u32 s37, s37, 32768
  s_add_u32 s30, s30, 20480
  s_cmp_ge_u32 s37, 98304
  s_cselect_b32 s37, s41, s37
  s_cselect_b32 s30, s42, s30
  s_add_u32 s31, s30, 5120

  s_waitcnt vmcnt(13)
  s_add_u32 m0, s37, 0
  s_add_u32 s68, s20, s36
  buffer_load_dwordx4 v4, s[8:11], s68 offen lds
  s_add_u32 m0, s37, 1024
  s_add_u32 s68, s20, s36
  buffer_load_dwordx4 v5, s[8:11], s68 offen lds
  s_add_u32 m0, s37, 2048
  s_add_u32 s68, s21, s36
  buffer_load_dwordx4 v4, s[8:11], s68 offen lds
  s_add_u32 m0, s37, 3072
  s_add_u32 s68, s21, s36
  buffer_load_dwordx4 v5, s[8:11], s68 offen lds
  s_add_u32 m0, s37, 4096
  s_add_u32 s68, s22, s36
  buffer_load_dwordx4 v4, s[8:11], s68 offen lds
  s_add_u32 m0, s37, 5120
  s_add_u32 s68, s22, s36
  buffer_load_dwordx4 v5, s[8:11], s68 offen lds
  s_add_u32 m0, s37, 6144
  s_add_u32 s68, s23, s36
  buffer_load_dwordx4 v4, s[8:11], s68 offen lds
  s_add_u32 m0, s37, 7168
  s_add_u32 s68, s23, s36
  buffer_load_dwordx4 v5, s[8:11], s68 offen lds
  s_add_u32 m0, s37, 8192
  s_add_u32 s68, s24, s36
  buffer_load_dwordx4 v4, s[8:11], s68 offen lds
  s_add_u32 m0, s37, 9216
  s_add_u32 s68, s24, s36
  buffer_load_dwordx4 v5, s[8:11], s68 offen lds
  s_add_u32 m0, s37, 10240
  s_add_u32 s68, s25, s36
  buffer_load_dwordx4 v4, s[8:11], s68 offen lds
  s_add_u32 m0, s37, 11264
  s_add_u32 s68, s25, s36
  buffer_load_dwordx4 v5, s[8:11], s68 offen lds
  s_add_u32 m0, s37, 12288
  s_add_u32 s68, s26, s36
  buffer_load_dwordx4 v4, s[8:11], s68 offen lds
  s_waitcnt vmcnt(13)
  s_mov_b32 s87, 0
  s_barrier
  s_add_u32 m0, s37, 13312
  s_add_u32 s68, s26, s36
  buffer_load_dwordx4 v5, s[8:11], s68 offen lds
  s_add_u32 m0, s37, 14336
  s_add_u32 s68, s27, s36
  buffer_load_dwordx4 v4, s[8:11], s68 offen lds
  s_add_u32 m0, s37, 15360
  s_add_u32 s68, s27, s36
  buffer_load_dwordx4 v5, s[8:11], s68 offen lds
  s_mov_b32 s69, s40
  s_add_u32 m0, s30, 0
  s_nop 0
  buffer_load_dwordx4 v12, s[12:15], s69 offen lds
  s_add_u32 m0, s30, 1024
  s_nop 0
  buffer_load_dwordx4 v13, s[12:15], s69 offen lds
  s_add_u32 m0, s30, 2048
  s_nop 0
  buffer_load_dwordx4 v14, s[12:15], s69 offen lds
  s_add_u32 m0, s30, 3072
  s_nop 0
  buffer_load_dwordx4 v15, s[12:15], s69 offen lds
  s_add_u32 s69, s69, s34
  s_add_u32 m0, s30, 4096
  s_nop 0
  buffer_load_dwordx4 v16, s[12:15], s69 offen lds
  s_add_u32 s69, s40, s39
  s_add_u32 m0, s31, 0
  s_nop 0
  buffer_load_dwordx4 v12, s[12:15], s69 offen lds
  s_add_u32 m0, s31, 1024
  s_nop 0
  buffer_load_dwordx4 v13, s[12:15], s69 offen lds
  s_add_u32 m0, s31, 2048
  s_nop 0
  buffer_load_dwordx4 v14, s[12:15], s69 offen lds
  s_add_u32 m0, s31, 3072
  s_nop 0
  buffer_load_dwordx4 v15, s[12:15], s69 offen lds
  s_add_u32 s69, s69, s34
  s_add_u32 m0, s31, 4096
  s_nop 0
  buffer_load_dwordx4 v16, s[12:15], s69 offen lds
  s_add_u32 s40, s40, s33
  s_add_u32 s36, s36, 128
  s_add_u32 s37, s37, 32768
  s_add_u32 s30, s30, 20480
  s_cmp_ge_u32 s37, 98304
  s_cselect_b32 s37, s41, s37
  s_cselect_b32 s30, s42, s30
  s_add_u32 s31, s30, 5120

  s_mov_b32 s69, s40
  s_add_u32 m0, s30, 3072
  s_nop 0
  buffer_load_dwordx4 v15, s[12:15], s69 offen lds
  s_add_u32 s69, s69, s34
  s_add_u32 m0, s30, 4096
  s_nop 0
  buffer_load_dwordx4 v16, s[12:15], s69 offen lds
  s_add_u32 s69, s40, s39
  s_add_u32 m0, s31, 0
  s_nop 0
  buffer_load_dwordx4 v12, s[12:15], s69 offen lds
  s_add_u32 m0, s31, 1024
  s_nop 0
  buffer_load_dwordx4 v13, s[12:15], s69 offen lds
  s_add_u32 m0, s31, 2048
  s_nop 0
  buffer_load_dwordx4 v14, s[12:15], s69 offen lds
  s_add_u32 m0, s31, 3072
  s_nop 0
  buffer_load_dwordx4 v15, s[12:15], s69 offen lds
  s_add_u32 s69, s69, s34
  s_add_u32 m0, s31, 4096
  s_nop 0
  buffer_load_dwordx4 v16, s[12:15], s69 offen lds
K1_LL:
  s_add_u32 m0, s37, 0
  s_add_u32 s68, s20, s36
  buffer_load_dwordx4 v4, s[8:11], s68 offen lds
  s_add_u32 m0, s37, 1024
  s_add_u32 s68, s20, s36
  buffer_load_dwordx4 v5, s[8:11], s68 offen lds
  s_add_u32 m0, s37, 2048
  s_add_u32 s68, s21, s36
  buffer_load_dwordx4 v4, s[8:11], s68 offen lds
  s_add_u32 m0, s37, 3072
  s_add_u32 s68, s21, s36
  buffer_load_dwordx4 v5, s[8:11], s68 offen lds
  s_add_u32 m0, s37, 4096
  s_add_u32 s68, s22, s36
  buffer_load_dwordx4 v4, s[8:11], s68 offen lds
  s_add_u32 m0, s37, 5120
  s_add_u32 s68, s22, s36
  buffer_load_dwordx4 v5, s[8:11], s68 offen lds
  s_add_u32 m0, s37, 6144
  s_add_u32 s68, s23, s36
  buffer_load_dwordx4 v4, s[8:11], s68 offen lds
  s_add_u32 m0, s37, 7168
  s_add_u32 s68, s23, s36
  buffer_load_dwordx4 v5, s[8:11], s68 offen lds
  s_add_u32 m0, s37, 8192
  s_add_u32 s68, s24, s36
  buffer_load_dwordx4 v4, s[8:11], s68 offen lds
  s_add_u32 m0, s37, 9216
  s_add_u32 s68, s24, s36
  buffer_load_dwordx4 v5, s[8:11], s68 offen lds
  s_add_u32 m0, s37, 10240
  s_add_u32 s68, s25, s36
  buffer_load_dwordx4 v4, s[8:11], s68 offen lds
  s_add_u32 m0, s37, 11264
  s_add_u32 s68, s25, s36
  buffer_load_dwordx4 v5, s[8:11], s68 offen lds
  s_add_u32 m0, s37, 12288
  s_add_u32 s68, s26, s36
  buffer_load_dwordx4 v4, s[8:11], s68 offen lds
  s_add_u32 m0, s37, 13312
  s_add_u32 s68, s26, s36
  buffer_load_dwordx4 v5, s[8:11], s68 offen lds
  s_add_u32 m0, s37, 14336
  s_add_u32 s68, s27, s36
  buffer_load_dwordx4 v4, s[8:11], s68 offen lds
  s_add_u32 m0, s37, 15360
  s_add_u32 s68, s27, s36
  buffer_load_dwordx4 v5, s[8:11], s68 offen lds
  s_mov_b32 s69, s40
  s_add_u32 m0, s30, 0
  s_nop 0
  buffer_load_dwordx4 v12, s[12:15], s69 offen lds
  s_add_u32 m0, s30, 1024
  s_nop 0
  buffer_load_dwordx4 v13, s[12:15], s69 offen lds
  s_add_u32 m0, s30, 2048
  s_nop 0
  buffer_load_dwordx4 v14, s[12:15], s69 offen lds
  s_add_u32 s40, s40, s33
  s_add_u32 s36, s36, 128
  s_add_u32 s37, s37, 32768
  s_add_u32 s30, s30, 20480
  s_cmp_ge_u32 s37, 98304
  s_cselect_b32 s37, s41, s37
  s_cselect_b32 s30, s42, s30
  s_add_u32 s31, s30, 5120

  s_cmp_lg_u32 s87, 6
  s_cbranch_scc1 K1_LNR
  s_waitcnt lgkmcnt(0)
  s_lshl_b32 s70, s35, 1
  s_add_u32 s70, s70, s43
  s_mul_i32 s65, s70, 40960
  s_mul_i32 s66, s62, 160
  s_add_u32 s65, s65, s66

  s_mov_b32 s72, s54
  s_mov_b32 s73, s55
  s_mov_b32 s74, 256
  s_mov_b32 s75, 0x20000
  v_mov_b32 v40, 0
  buffer_load_dword v46, v40, s[72:75], 0 offen sc1
  s_mov_b32 s72, s84
  s_mov_b32 s73, s85
  s_mov_b32 s74, 2211840
  s_mov_b32 s75, 0x20000
  v_add_u32 v40, 0, v1
  v_mul_u32_u24 v41, 6554, v40
  v_lshrrev_b32 v41, 16, v41
  v_mul_u32_u24 v42, 10, v41
  v_sub_u32 v42, v40, v42
  v_mul_u32_u24 v41, 1280, v41
  v_lshl_add_u32 v40, v42, 4, v41

  buffer_load_dwordx4 v[48:51], v40, s[72:75], s65 offen offset:0
  v_add_u32 v40, 64, v1
  v_mul_u32_u24 v41, 6554, v40
  v_lshrrev_b32 v41, 16, v41
  v_mul_u32_u24 v42, 10, v41
  v_sub_u32 v42, v40, v42
  v_mul_u32_u24 v41, 1280, v41
  v_lshl_add_u32 v40, v42, 4, v41

  buffer_load_dwordx4 v[52:55], v40, s[72:75], s65 offen offset:0
  v_add_u32 v40, 128, v1
  v_mul_u32_u24 v41, 6554, v40
  v_lshrrev_b32 v41, 16, v41
  v_mul_u32_u24 v42, 10, v41
  v_sub_u32 v42, v40, v42
  v_mul_u32_u24 v41, 1280, v41
  v_lshl_add_u32 v40, v42, 4, v41

  buffer_load_dwordx4 v[56:59], v40, s[72:75], s65 offen offset:0
  v_add_u32 v40, 192, v1
  v_mul_u32_u24 v41, 6554, v40
  v_lshrrev_b32 v41, 16, v41
  v_mul_u32_u24 v42, 10, v41
  v_sub_u32 v42, v40, v42
  v_mul_u32_u24 v41, 1280, v41
  v_lshl_add_u32 v40, v42, 4, v41

  buffer_load_dwordx4 v[60:63], v40, s[72:75], s65 offen offset:0
  v_add_u32 v40, 256, v1
  v_mul_u32_u24 v41, 6554, v40
  v_lshrrev_b32 v41, 16, v41
  v_mul_u32_u24 v42, 10, v41
  v_sub_u32 v42, v40, v42
  v_mul_u32_u24 v41, 1280, v41
  v_lshl_add_u32 v40, v42, 4, v41

  buffer_load_dwordx4 v[64:67], v40, s[72:75], s65 offen offset:0
  s_sub_u32 s71, 63, s70
  s_bitcmp1_b32 s71, 1
  s_cselect_b32 s76, s82, s80
  s_cselect_b32 s77, s83, s81
  s_mov_b32 s78, 819200
  s_mov_b32 s79, 0x20000
  s_lshr_b32 s65, s71, 2
  s_lshl_b32 s65, s65, 7
  s_and_b32 s66, s71, 1
  s_lshl_b32 s66, s66, 6
  s_add_u32 s65, s65, s66
  s_mul_i32 s66, s62, 102400
  s_add_u32 s65, s65, s66
  s_cmp_lt_u32 s71, 40
  s_cselect_b32 s65, s65, 0x40000000
  v_mul_u32_u24 v40, 1280, v31
  v_lshrrev_b32 v41, 4, v1
  v_lshl_add_u32 v40, v41, 4, v40

  buffer_load_dwordx4 v[88:91], v40, s[76:79], s65 offen
  s_add_u32 s65, s65, 20480
  buffer_load_dwordx4 v[92:95], v40, s[76:79], s65 offen
  s_add_u32 s65, s65, 20480
  buffer_load_dwordx4 v[96:99], v40, s[76:79], s65 offen
  s_add_u32 s65, s65, 20480
  buffer_load_dwordx4 v[100:103], v40, s[76:79], s65 offen
  s_add_u32 s65, s65, 20480
  buffer_load_dwordx4 v[104:107], v40, s[76:79], s65 offen
  s_add_u32 s65, s65, 20480
  s_add_u32 s87, s87, 1
  s_waitcnt vmcnt(30)
  s_branch K1_LW
K1_LNR:
  s_add_u32 s87, s87, 1
  s_waitcnt vmcnt(19)
K1_LW:
  s_barrier
  s_cmp_lt_u32 s87, 8
  s_cbranch_scc1 K1_LL
  s_waitcnt vmcnt(0)
  s_add_u32 s16, s4, 17825792
  s_addc_u32 s17, s5, 0
  s_mov_b32 s18, 3932160
  s_mov_b32 s19, 0x20000
  s_add_u32 s20, s4, 24510464
  s_addc_u32 s21, s5, 0
  s_mov_b32 s22, 16384
  s_mov_b32 s23, 0x20000
  s_mul_i32 s65, s43, 10240
  s_add_u32 s65, s65, 118784
  v_lshlrev_b32 v2, 4, v1
  v_add_u32 v3, s65, v2
  v_lshrrev_b32 v6, 4, v1
  v_bfe_u32 v4, v1, 2, 2
  v_lshl_add_u32 v4, v6, 2, v4
  v_mul_u32_u24 v4, 160, v4
  v_and_b32 v5, 3, v1
  v_lshl_add_u32 v4, v5, 3, v4
  v_add_u32 v4, s65, v4

  ds_write_b128 v3, v[48:51] offset:0
  ds_write_b128 v3, v[52:55] offset:1024
  ds_write_b128 v3, v[56:59] offset:2048
  ds_write_b128 v3, v[60:63] offset:3072
  ds_write_b128 v3, v[64:67] offset:4096
  s_mul_i32 s68, s62, 491520
  s_lshl_b32 s65, s71, 10
  s_add_u32 s65, s65, s68
  s_cmp_lt_u32 s71, 40
  s_cselect_b32 s65, s65, 0x40000000
  s_waitcnt lgkmcnt(0)

  ds_read_b64_tr_b16 v[48:49], v4 offset:0
  ds_read_b64_tr_b16 v[50:51], v4 offset:2560
  ds_read_b64_tr_b16 v[52:53], v4 offset:32
  ds_read_b64_tr_b16 v[54:55], v4 offset:2592
  ds_read_b64_tr_b16 v[56:57], v4 offset:64
  ds_read_b64_tr_b16 v[58:59], v4 offset:2624
  ds_read_b64_tr_b16 v[60:61], v4 offset:96
  ds_read_b64_tr_b16 v[62:63], v4 offset:2656
  ds_read_b64_tr_b16 v[64:65], v4 offset:128
  ds_read_b64_tr_b16 v[66:67], v4 offset:2688
  buffer_store_dwordx4 v[88:91], v2, s[16:19], s65 offen sc1
  s_add_u32 s65, s65, 98304
  buffer_store_dwordx4 v[92:95], v2, s[16:19], s65 offen sc1
  s_add_u32 s65, s65, 98304
  buffer_store_dwordx4 v[96:99], v2, s[16:19], s65 offen sc1
  s_add_u32 s65, s65, 98304
  buffer_store_dwordx4 v[100:103], v2, s[16:19], s65 offen sc1
  s_add_u32 s65, s65, 98304
  buffer_store_dwordx4 v[104:107], v2, s[16:19], s65 offen sc1
  s_add_u32 s65, s65, 98304
  s_mul_i32 s65, s70, 52429
  s_lshr_b32 s65, s65, 18
  s_mul_i32 s66, s65, 5
  s_sub_u32 s66, s70, s66
  s_add_u32 s67, s70, 2
  s_mul_i32 s67, s67, 52429
  s_lshr_b32 s67, s67, 18
  s_sub_u32 s67, s70, s67
  s_add_u32 s67, s67, 40
  s_add_u32 s65, s65, 84
  s_cmp_eq_u32 s66, 2
  s_cselect_b32 s65, s65, s67
  s_lshl_b32 s65, s65, 10
  s_add_u32 s65, s65, s68
  s_cmp_lt_u32 s70, 54
  s_cselect_b32 s65, s65, 0x40000000
  s_waitcnt lgkmcnt(0)

  buffer_store_dwordx4 v[48:51], v2, s[16:19], s65 offen sc1
  s_add_u32 s65, s65, 98304
  buffer_store_dwordx4 v[52:55], v2, s[16:19], s65 offen sc1
  s_add_u32 s65, s65, 98304
  buffer_store_dwordx4 v[56:59], v2, s[16:19], s65 offen sc1
  s_add_u32 s65, s65, 98304
  buffer_store_dwordx4 v[60:63], v2, s[16:19], s65 offen sc1
  s_add_u32 s65, s65, 98304
  buffer_store_dwordx4 v[64:67], v2, s[16:19], s65 offen sc1
  s_add_u32 s65, s65, 98304
  s_lshl_b32 s66, s70, 2
  s_lshl_b32 s67, s62, 8
  s_add_u32 s66, s66, s67
  s_add_u32 s66, s66, 8192
  v_mov_b32 v2, 0

  s_barrier
  s_mov_b64 exec, 1
  s_waitcnt vmcnt(0)
  buffer_store_dword v46, v2, s[20:23], s66 offen sc1

  s_mov_b64 exec, -1
  s_mov_b32 s47, 1
  s_setprio 0
  s_branch K1_P2
K1_NOTLOADER:
  s_cmp_lg_u32 s3, 3
  s_cbranch_scc1 K1_NOCPF
  s_getpc_b64 s[66:67]
  K1_PCREF:
  s_sub_u32 s66, s66, K1_PCREF-gemm1_kernel
  s_subb_u32 s67, s67, 0
  s_lshl_b32 s65, s61, 11
  v_lshlrev_b32 v14, 7, v1
  v_add_u32 v14, s65, v14
  v_cmp_gt_u32 vcc, CODE_END-gemm1_kernel, v14
  s_and_b64 exec, vcc, 0xffff
  s_cbranch_execz K1_CPFSKIP
  global_load_dword v16, v14, s[66:67]
  K1_CPFSKIP:
  s_mov_b64 exec, -1

  K1_NOCPF:
  s_add_u32 s16, s4, 4194304
  s_addc_u32 s17, s5, 0
  s_mov_b32 s18, 12582912
  s_mov_b32 s19, 0x20000
  s_add_u32 s76, s4, 22020096
  s_addc_u32 s77, s5, 0
  s_mov_b32 s78, 81920
  s_mov_b32 s79, 0x20000
  v_lshrrev_b32 v30, 4, v1
  v_and_b32 v31, 15, v1
  v_lshrrev_b32 v10, 1, v31
  v_xor_b32 v10, v10, v30
  v_lshlrev_b32 v11, 7, v31
  v_lshl_add_u32 v10, v10, 4, v11
  v_bfe_u32 v14, v1, 2, 2
  v_bfe_u32 v15, v1, 4, 1
  v_lshl_add_u32 v14, v15, 2, v14
  v_bfe_u32 v15, v1, 5, 1
  v_lshl_add_u32 v14, v15, 4, v14
  v_mul_u32_u24 v14, 160, v14
  v_and_b32 v15, 3, v1
  v_lshl_add_u32 v11, v15, 3, v14
  s_cmp_ge_u32 s3, 4
  s_cbranch_scc1 K1_HELPER

  s_lshl_b32 s65, s3, 13
  v_add_u32 v2, s65, v10
  v_xor_b32 v3, 64, v2
  v_add_u32 v4, 32768, v2
  v_add_u32 v5, 32768, v3
  v_add_u32 v6, 65536, v2
  v_add_u32 v7, 65536, v3
  s_lshl_b32 s64, s62, 4
  s_lshl_b32 s65, s3, 2
  s_add_u32 s64, s64, s65
  s_mul_i32 s64, s64, 98304
  v_lshlrev_b32 v12, 4, v1
  s_cmp_lt_u32 s63, 10
  s_cbranch_scc1 K1_SSM

  s_sub_u32 s63, s63, 10
  v_add_u32 v8, 98304, v11
  s_lshr_b32 s65, s63, 1
  s_and_b32 s66, s63, 1
  s_lshl_b32 s67, s65, 2
  s_lshl_b32 s68, s66, 1
  s_add_u32 s67, s67, s68
  s_add_u32 s67, s67, 40
  s_lshl_b32 s67, s67, 10
  s_add_u32 s70, s67, s64
  s_add_u32 s71, s70, 1024
  s_cmp_eq_u32 s63, 21
  s_cselect_b32 s71, 0x40000000, s71
  s_add_u32 s67, s65, 84
  s_lshl_b32 s67, s67, 10
  s_mul_i32 s68, s66, 98304
  s_add_u32 s67, s67, s68
  s_add_u32 s72, s67, s64

  s_cmp_eq_u32 s3, 0
  s_cselect_b32 s12, s56, s58
  s_cselect_b32 s13, s57, s59
  s_mov_b32 s14, 2211840
  s_mov_b32 s15, 0x20000
  s_mov_b32 s81, 221184
  s_lshr_b32 s82, s61, 3
  s_lshl_b32 s82, s82, 4

  s_mul_i32 s80, s82, 3456
  s_mul_i32 s82, s63, 160
  s_add_u32 s80, s80, s82
  v_mul_u32_u24 v14, 3456, v31
  v_bfe_u32 v15, v1, 4, 1
  v_mul_u32_u24 v15, 156, v15
  v_add_u32 v14, v14, v15
  s_mov_b32 s83, 32

  s_lshl_b32 s82, s62, 8
  s_and_b32 s84, s61, 7
  s_lshl_b32 s84, s84, 5
  s_add_u32 s82, s82, s84
  s_mul_i32 s82, s82, 1280
  v_mul_u32_u24 v15, 1280, v1
  s_cmp_eq_u32 s3, 2
  s_cselect_b32 s12, s8, s12
  s_cselect_b32 s13, s9, s13
  s_cselect_b32 s14, s10, s14
  s_cselect_b32 s80, s82, s80
  s_cselect_b32 s81, 128, s81
  s_cselect_b32 s83, 32, s83
  s_cselect_b64 vcc, -1, 0
  s_cmp_eq_u32 s3, 3
  s_cselect_b32 s83, 0, s83
  v_cndmask_b32 v14, v14, v15, vcc
  v_cmp_gt_u32 vcc, s83, v1
  v_mov_b32 v15, 0x40000000
  s_nop 0
  v_cndmask_b32 v14, v15, v14, vcc

  s_add_u32 s80, s80, s81
  s_add_u32 s80, s80, s81
  s_add_u32 s80, s80, s81
  buffer_load_dword v16, v14, s[12:15], s80 offen
  v_mov_b32 v32, 0
  v_mov_b32 v33, 0
  v_mov_b32 v34, 0
  v_mov_b32 v35, 0
  v_mov_b32 v36, 0
  v_mov_b32 v37, 0
  v_mov_b32 v38, 0
  v_mov_b32 v39, 0
  v_mov_b32 v40, 0
  v_mov_b32 v41, 0
  v_mov_b32 v42, 0
  v_mov_b32 v43, 0
  v_mov_b32 v44, 0
  v_mov_b32 v45, 0
  v_mov_b32 v46, 0
  v_mov_b32 v47, 0
  v_mov_b32 v48, 0
  v_mov_b32 v49, 0
  v_mov_b32 v50, 0
  v_mov_b32 v51, 0
  v_mov_b32 v52, 0
  v_mov_b32 v53, 0
  v_mov_b32 v54, 0
  v_mov_b32 v55, 0
  v_mov_b32 v56, 0
  v_mov_b32 v57, 0
  v_mov_b32 v58, 0
  v_mov_b32 v59, 0
  v_mov_b32 v60, 0
  v_mov_b32 v61, 0
  v_mov_b32 v62, 0
  v_mov_b32 v63, 0
  v_mov_b32 v64, 0
  v_mov_b32 v65, 0
  v_mov_b32 v66, 0
  v_mov_b32 v67, 0
  v_mov_b32 v68, 0
  v_mov_b32 v69, 0
  v_mov_b32 v70, 0
  v_mov_b32 v71, 0
  v_mov_b32 v72, 0
  v_mov_b32 v73, 0
  v_mov_b32 v74, 0
  v_mov_b32 v75, 0
  v_mov_b32 v76, 0
  v_mov_b32 v77, 0
  v_mov_b32 v78, 0
  v_mov_b32 v79, 0
  v_mov_b32 v80, 0
  v_mov_b32 v81, 0
  v_mov_b32 v82, 0
  v_mov_b32 v83, 0
  v_mov_b32 v84, 0
  v_mov_b32 v85, 0
  v_mov_b32 v86, 0
  v_mov_b32 v87, 0
  v_mov_b32 v88, 0
  v_mov_b32 v89, 0
  v_mov_b32 v90, 0
  v_mov_b32 v91, 0
  v_mov_b32 v92, 0
  v_mov_b32 v93, 0
  v_mov_b32 v94, 0
  v_mov_b32 v95, 0
  v_mov_b32 v96, 0
  v_mov_b32 v97, 0
  v_mov_b32 v98, 0
  v_mov_b32 v99, 0
  v_mov_b32 v100, 0
  v_mov_b32 v101, 0
  v_mov_b32 v102, 0
  v_mov_b32 v103, 0
  v_mov_b32 v104, 0
  v_mov_b32 v105, 0
  v_mov_b32 v106, 0
  v_mov_b32 v107, 0
  v_mov_b32 v108, 0
  v_mov_b32 v109, 0
  v_mov_b32 v110, 0
  v_mov_b32 v111, 0
  v_mov_b32 v112, 0
  v_mov_b32 v113, 0
  v_mov_b32 v114, 0
  v_mov_b32 v115, 0
  v_mov_b32 v116, 0
  v_mov_b32 v117, 0
  v_mov_b32 v118, 0
  v_mov_b32 v119, 0
  v_mov_b32 v120, 0
  v_mov_b32 v121, 0
  v_mov_b32 v122, 0
  v_mov_b32 v123, 0
  v_mov_b32 v124, 0
  v_mov_b32 v125, 0
  v_mov_b32 v126, 0
  v_mov_b32 v127, 0
  v_mov_b32 v128, 0
  v_mov_b32 v129, 0
  v_mov_b32 v130, 0
  v_mov_b32 v131, 0
  v_mov_b32 v132, 0
  v_mov_b32 v133, 0
  v_mov_b32 v134, 0
  v_mov_b32 v135, 0
  v_mov_b32 v136, 0
  v_mov_b32 v137, 0
  v_mov_b32 v138, 0
  v_mov_b32 v139, 0
  v_mov_b32 v140, 0
  v_mov_b32 v141, 0
  v_mov_b32 v142, 0
  v_mov_b32 v143, 0
  v_mov_b32 v144, 0
  v_mov_b32 v145, 0
  v_mov_b32 v146, 0
  v_mov_b32 v147, 0
  v_mov_b32 v148, 0
  v_mov_b32 v149, 0
  v_mov_b32 v150, 0
  v_mov_b32 v151, 0
  v_mov_b32 v152, 0
  v_mov_b32 v153, 0
  v_mov_b32 v154, 0
  v_mov_b32 v155, 0
  v_mov_b32 v156, 0
  v_mov_b32 v157, 0
  v_mov_b32 v158, 0
  v_mov_b32 v159, 0
  v_mov_b32 v160, 0
  v_mov_b32 v161, 0
  v_mov_b32 v162, 0
  v_mov_b32 v163, 0
  v_mov_b32 v164, 0
  v_mov_b32 v165, 0
  v_mov_b32 v166, 0
  v_mov_b32 v167, 0
  v_mov_b32 v168, 0
  v_mov_b32 v169, 0
  v_mov_b32 v170, 0
  v_mov_b32 v171, 0
  v_mov_b32 v172, 0
  v_mov_b32 v173, 0
  v_mov_b32 v174, 0
  v_mov_b32 v175, 0
  v_mov_b32 v176, 0
  v_mov_b32 v177, 0
  v_mov_b32 v178, 0
  v_mov_b32 v179, 0
  v_mov_b32 v180, 0
  v_mov_b32 v181, 0
  v_mov_b32 v182, 0
  v_mov_b32 v183, 0
  v_mov_b32 v184, 0
  v_mov_b32 v185, 0
  v_mov_b32 v186, 0
  v_mov_b32 v187, 0
  v_mov_b32 v188, 0
  v_mov_b32 v189, 0
  v_mov_b32 v190, 0
  v_mov_b32 v191, 0
  s_mov_b32 s87, 0
  s_barrier
  ds_read_b64_tr_b16 a[32:33], v8 offset:0
  ds_read_b64_tr_b16 a[34:35], v8 offset:1280
  ds_read_b128 a[0:3], v2 offset:0
  ds_read_b64_tr_b16 a[36:37], v8 offset:32
  ds_read_b64_tr_b16 a[38:39], v8 offset:1312
  ds_read_b128 a[4:7], v2 offset:2048
  ds_read_b64_tr_b16 a[40:41], v8 offset:64
  ds_read_b64_tr_b16 a[42:43], v8 offset:1344
  ds_read_b128 a[8:11], v2 offset:4096
  ds_read_b128 a[12:15], v2 offset:6144
  ds_read_b64_tr_b16 a[44:45], v8 offset:96
  ds_read_b64_tr_b16 a[46:47], v8 offset:1376
K1_CL_1:
  s_waitcnt lgkmcnt(2)
  v_mfma_f32_16x16x32_bf16 v[32:35], a[32:35], a[0:3], v[32:35]
  ds_read_b64_tr_b16 a[48:49], v8 offset:128
  ds_read_b64_tr_b16 a[50:51], v8 offset:1408
  v_mfma_f32_16x16x32_bf16 v[36:39], a[32:35], a[4:7], v[36:39]
  v_mfma_f32_16x16x32_bf16 v[40:43], a[32:35], a[8:11], v[40:43]
  v_mfma_f32_16x16x32_bf16 v[44:47], a[32:35], a[12:15], v[44:47]
  v_mfma_f32_16x16x32_bf16 v[48:51], a[36:39], a[0:3], v[48:51]
  ds_read_b64_tr_b16 a[52:53], v8 offset:10240
  ds_read_b64_tr_b16 a[54:55], v8 offset:11520
  v_mfma_f32_16x16x32_bf16 v[52:55], a[36:39], a[4:7], v[52:55]
  v_mfma_f32_16x16x32_bf16 v[56:59], a[36:39], a[8:11], v[56:59]
  v_mfma_f32_16x16x32_bf16 v[60:63], a[36:39], a[12:15], v[60:63]
  v_mfma_f32_16x16x32_bf16 v[64:67], a[40:43], a[0:3], v[64:67]
  ds_read_b64_tr_b16 a[32:33], v8 offset:10272
  ds_read_b64_tr_b16 a[34:35], v8 offset:11552
  v_mfma_f32_16x16x32_bf16 v[68:71], a[40:43], a[4:7], v[68:71]
  ds_read_b128 a[16:19], v3 offset:0
  v_mfma_f32_16x16x32_bf16 v[72:75], a[40:43], a[8:11], v[72:75]
  v_mfma_f32_16x16x32_bf16 v[76:79], a[40:43], a[12:15], v[76:79]
  s_waitcnt lgkmcnt(7)
  v_mfma_f32_16x16x32_bf16 v[80:83], a[44:47], a[0:3], v[80:83]
  ds_read_b64_tr_b16 a[36:37], v8 offset:10304
  ds_read_b64_tr_b16 a[38:39], v8 offset:11584
  v_mfma_f32_16x16x32_bf16 v[84:87], a[44:47], a[4:7], v[84:87]
  ds_read_b128 a[20:23], v3 offset:2048
  v_mfma_f32_16x16x32_bf16 v[88:91], a[44:47], a[8:11], v[88:91]
  v_mfma_f32_16x16x32_bf16 v[92:95], a[44:47], a[12:15], v[92:95]
  s_waitcnt lgkmcnt(8)
  v_mfma_f32_16x16x32_bf16 v[96:99], a[48:51], a[0:3], v[96:99]
  ds_read_b64_tr_b16 a[40:41], v8 offset:10336
  ds_read_b64_tr_b16 a[42:43], v8 offset:11616
  v_mfma_f32_16x16x32_bf16 v[100:103], a[48:51], a[4:7], v[100:103]
  ds_read_b128 a[24:27], v3 offset:4096
  v_mfma_f32_16x16x32_bf16 v[104:107], a[48:51], a[8:11], v[104:107]
  v_mfma_f32_16x16x32_bf16 v[108:111], a[48:51], a[12:15], v[108:111]
  s_waitcnt lgkmcnt(9)
  v_mfma_f32_16x16x32_bf16 v[112:115], a[52:55], a[0:3], v[112:115]
  ds_read_b64_tr_b16 a[44:45], v8 offset:10368
  ds_read_b64_tr_b16 a[46:47], v8 offset:11648
  v_mfma_f32_16x16x32_bf16 v[116:119], a[52:55], a[4:7], v[116:119]
  ds_read_b128 a[28:31], v3 offset:6144
  v_mfma_f32_16x16x32_bf16 v[120:123], a[52:55], a[8:11], v[120:123]
  v_mfma_f32_16x16x32_bf16 v[124:127], a[52:55], a[12:15], v[124:127]
  s_waitcnt lgkmcnt(10)
  v_mfma_f32_16x16x32_bf16 v[128:131], a[32:35], a[0:3], v[128:131]
  ds_read_b64_tr_b16 a[48:49], v8 offset:5120
  ds_read_b64_tr_b16 a[50:51], v8 offset:6400
  v_mfma_f32_16x16x32_bf16 v[132:135], a[32:35], a[4:7], v[132:135]
  v_mfma_f32_16x16x32_bf16 v[136:139], a[32:35], a[8:11], v[136:139]
  v_mfma_f32_16x16x32_bf16 v[140:143], a[32:35], a[12:15], v[140:143]
  s_waitcnt lgkmcnt(9)
  v_mfma_f32_16x16x32_bf16 v[144:147], a[36:39], a[0:3], v[144:147]
  ds_read_b64_tr_b16 a[52:53], v8 offset:5152
  ds_read_b64_tr_b16 a[54:55], v8 offset:6432
  v_mfma_f32_16x16x32_bf16 v[148:151], a[36:39], a[4:7], v[148:151]
  v_mfma_f32_16x16x32_bf16 v[152:155], a[36:39], a[8:11], v[152:155]
  v_mfma_f32_16x16x32_bf16 v[156:159], a[36:39], a[12:15], v[156:159]
  s_waitcnt lgkmcnt(8)
  v_mfma_f32_16x16x32_bf16 v[160:163], a[40:43], a[0:3], v[160:163]
  ds_read_b64_tr_b16 a[32:33], v8 offset:5184
  ds_read_b64_tr_b16 a[34:35], v8 offset:6464
  v_mfma_f32_16x16x32_bf16 v[164:167], a[40:43], a[4:7], v[164:167]
  v_mfma_f32_16x16x32_bf16 v[168:171], a[40:43], a[8:11], v[168:171]
  v_mfma_f32_16x16x32_bf16 v[172:175], a[40:43], a[12:15], v[172:175]
  s_waitcnt lgkmcnt(7)
  v_mfma_f32_16x16x32_bf16 v[176:179], a[44:47], a[0:3], v[176:179]
  ds_read_b64_tr_b16 a[36:37], v8 offset:5216
  ds_read_b64_tr_b16 a[38:39], v8 offset:6496
  v_mfma_f32_16x16x32_bf16 v[180:183], a[44:47], a[4:7], v[180:183]
  v_mfma_f32_16x16x32_bf16 v[184:187], a[44:47], a[8:11], v[184:187]
  v_mfma_f32_16x16x32_bf16 v[188:191], a[44:47], a[12:15], v[188:191]
  s_cmp_ge_u32 s87, 2
  s_cbranch_scc1 K1_CT_2
  s_add_u32 s80, s80, s81
  buffer_load_dword v16, v14, s[12:15], s80 offen
  s_add_u32 s80, s80, s81
  buffer_load_dword v16, v14, s[12:15], s80 offen
  s_add_u32 s80, s80, s81
  buffer_load_dword v16, v14, s[12:15], s80 offen
K1_CT_2:
  s_waitcnt lgkmcnt(6)
  v_mfma_f32_16x16x32_bf16 v[32:35], a[48:51], a[16:19], v[32:35]
  ds_read_b64_tr_b16 a[40:41], v8 offset:5248
  ds_read_b64_tr_b16 a[42:43], v8 offset:6528
  v_mfma_f32_16x16x32_bf16 v[36:39], a[48:51], a[20:23], v[36:39]
  v_mfma_f32_16x16x32_bf16 v[40:43], a[48:51], a[24:27], v[40:43]
  v_mfma_f32_16x16x32_bf16 v[44:47], a[48:51], a[28:31], v[44:47]
  s_waitcnt lgkmcnt(6)
  v_mfma_f32_16x16x32_bf16 v[48:51], a[52:55], a[16:19], v[48:51]
  ds_read_b64_tr_b16 a[44:45], v8 offset:15360
  ds_read_b64_tr_b16 a[46:47], v8 offset:16640
  v_mfma_f32_16x16x32_bf16 v[52:55], a[52:55], a[20:23], v[52:55]
  v_mfma_f32_16x16x32_bf16 v[56:59], a[52:55], a[24:27], v[56:59]
  v_mfma_f32_16x16x32_bf16 v[60:63], a[52:55], a[28:31], v[60:63]
  s_waitcnt lgkmcnt(6)
  v_mfma_f32_16x16x32_bf16 v[64:67], a[32:35], a[16:19], v[64:67]
  ds_read_b64_tr_b16 a[48:49], v8 offset:15392
  ds_read_b64_tr_b16 a[50:51], v8 offset:16672
  v_mfma_f32_16x16x32_bf16 v[68:71], a[32:35], a[20:23], v[68:71]
  v_mfma_f32_16x16x32_bf16 v[72:75], a[32:35], a[24:27], v[72:75]
  v_mfma_f32_16x16x32_bf16 v[76:79], a[32:35], a[28:31], v[76:79]
  s_waitcnt lgkmcnt(6)
  v_mfma_f32_16x16x32_bf16 v[80:83], a[36:39], a[16:19], v[80:83]
  ds_read_b64_tr_b16 a[52:53], v8 offset:15424
  ds_read_b64_tr_b16 a[54:55], v8 offset:16704
  v_mfma_f32_16x16x32_bf16 v[84:87], a[36:39], a[20:23], v[84:87]
  v_mfma_f32_16x16x32_bf16 v[88:91], a[36:39], a[24:27], v[88:91]
  v_mfma_f32_16x16x32_bf16 v[92:95], a[36:39], a[28:31], v[92:95]
  s_waitcnt lgkmcnt(6)
  v_mfma_f32_16x16x32_bf16 v[96:99], a[40:43], a[16:19], v[96:99]
  ds_read_b64_tr_b16 a[32:33], v8 offset:15456
  ds_read_b64_tr_b16 a[34:35], v8 offset:16736
  v_mfma_f32_16x16x32_bf16 v[100:103], a[40:43], a[20:23], v[100:103]
  v_mfma_f32_16x16x32_bf16 v[104:107], a[40:43], a[24:27], v[104:107]
  v_mfma_f32_16x16x32_bf16 v[108:111], a[40:43], a[28:31], v[108:111]
  s_waitcnt lgkmcnt(6)
  v_mfma_f32_16x16x32_bf16 v[112:115], a[44:47], a[16:19], v[112:115]
  ds_read_b64_tr_b16 a[36:37], v8 offset:15488
  ds_read_b64_tr_b16 a[38:39], v8 offset:16768
  v_mfma_f32_16x16x32_bf16 v[116:119], a[44:47], a[20:23], v[116:119]
  v_mfma_f32_16x16x32_bf16 v[120:123], a[44:47], a[24:27], v[120:123]
  v_mfma_f32_16x16x32_bf16 v[124:127], a[44:47], a[28:31], v[124:127]
  s_waitcnt lgkmcnt(6)
  v_mfma_f32_16x16x32_bf16 v[128:131], a[48:51], a[16:19], v[128:131]
  v_mfma_f32_16x16x32_bf16 v[132:135], a[48:51], a[20:23], v[132:135]
  v_mfma_f32_16x16x32_bf16 v[136:139], a[48:51], a[24:27], v[136:139]
  v_mfma_f32_16x16x32_bf16 v[140:143], a[48:51], a[28:31], v[140:143]
  s_waitcnt lgkmcnt(0)
  s_barrier
  v_mfma_f32_16x16x32_bf16 v[144:147], a[52:55], a[16:19], v[144:147]
  ds_read_b64_tr_b16 a[40:41], v8 offset:20480
  ds_read_b64_tr_b16 a[42:43], v8 offset:21760
  v_mfma_f32_16x16x32_bf16 v[148:151], a[52:55], a[20:23], v[148:151]
  ds_read_b128 a[0:3], v4 offset:0
  v_mfma_f32_16x16x32_bf16 v[152:155], a[52:55], a[24:27], v[152:155]
  ds_read_b64_tr_b16 a[44:45], v8 offset:20512
  ds_read_b64_tr_b16 a[46:47], v8 offset:21792
  v_mfma_f32_16x16x32_bf16 v[156:159], a[52:55], a[28:31], v[156:159]
  ds_read_b128 a[4:7], v4 offset:2048
  v_mfma_f32_16x16x32_bf16 v[160:163], a[32:35], a[16:19], v[160:163]
  ds_read_b64_tr_b16 a[48:49], v8 offset:20544
  ds_read_b64_tr_b16 a[50:51], v8 offset:21824
  v_mfma_f32_16x16x32_bf16 v[164:167], a[32:35], a[20:23], v[164:167]
  ds_read_b128 a[8:11], v4 offset:4096
  v_mfma_f32_16x16x32_bf16 v[168:171], a[32:35], a[24:27], v[168:171]
  ds_read_b128 a[12:15], v4 offset:6144
  v_mfma_f32_16x16x32_bf16 v[172:175], a[32:35], a[28:31], v[172:175]
  v_mfma_f32_16x16x32_bf16 v[176:179], a[36:39], a[16:19], v[176:179]
  ds_read_b64_tr_b16 a[52:53], v8 offset:20576
  ds_read_b64_tr_b16 a[54:55], v8 offset:21856
  v_mfma_f32_16x16x32_bf16 v[180:183], a[36:39], a[20:23], v[180:183]
  v_mfma_f32_16x16x32_bf16 v[184:187], a[36:39], a[24:27], v[184:187]
  v_mfma_f32_16x16x32_bf16 v[188:191], a[36:39], a[28:31], v[188:191]
  s_waitcnt lgkmcnt(2)
  v_mfma_f32_16x16x32_bf16 v[32:35], a[40:43], a[0:3], v[32:35]
  ds_read_b64_tr_b16 a[32:33], v8 offset:20608
  ds_read_b64_tr_b16 a[34:35], v8 offset:21888
  v_mfma_f32_16x16x32_bf16 v[36:39], a[40:43], a[4:7], v[36:39]
  v_mfma_f32_16x16x32_bf16 v[40:43], a[40:43], a[8:11], v[40:43]
  v_mfma_f32_16x16x32_bf16 v[44:47], a[40:43], a[12:15], v[44:47]
  v_mfma_f32_16x16x32_bf16 v[48:51], a[44:47], a[0:3], v[48:51]
  ds_read_b64_tr_b16 a[36:37], v8 offset:30720
  ds_read_b64_tr_b16 a[38:39], v8 offset:32000
  v_mfma_f32_16x16x32_bf16 v[52:55], a[44:47], a[4:7], v[52:55]
  v_mfma_f32_16x16x32_bf16 v[56:59], a[44:47], a[8:11], v[56:59]
  v_mfma_f32_16x16x32_bf16 v[60:63], a[44:47], a[12:15], v[60:63]
  v_mfma_f32_16x16x32_bf16 v[64:67], a[48:51], a[0:3], v[64:67]
  ds_read_b64_tr_b16 a[40:41], v8 offset:30752
  ds_read_b64_tr_b16 a[42:43], v8 offset:32032
  v_mfma_f32_16x16x32_bf16 v[68:71], a[48:51], a[4:7], v[68:71]
  ds_read_b128 a[16:19], v5 offset:0
  v_mfma_f32_16x16x32_bf16 v[72:75], a[48:51], a[8:11], v[72:75]
  v_mfma_f32_16x16x32_bf16 v[76:79], a[48:51], a[12:15], v[76:79]
  s_waitcnt lgkmcnt(7)
  v_mfma_f32_16x16x32_bf16 v[80:83], a[52:55], a[0:3], v[80:83]
  ds_read_b64_tr_b16 a[44:45], v8 offset:30784
  ds_read_b64_tr_b16 a[46:47], v8 offset:32064
  v_mfma_f32_16x16x32_bf16 v[84:87], a[52:55], a[4:7], v[84:87]
  ds_read_b128 a[20:23], v5 offset:2048
  v_mfma_f32_16x16x32_bf16 v[88:91], a[52:55], a[8:11], v[88:91]
  v_mfma_f32_16x16x32_bf16 v[92:95], a[52:55], a[12:15], v[92:95]
  s_waitcnt lgkmcnt(8)
  v_mfma_f32_16x16x32_bf16 v[96:99], a[32:35], a[0:3], v[96:99]
  ds_read_b64_tr_b16 a[48:49], v8 offset:30816
  ds_read_b64_tr_b16 a[50:51], v8 offset:32096
  v_mfma_f32_16x16x32_bf16 v[100:103], a[32:35], a[4:7], v[100:103]
  ds_read_b128 a[24:27], v5 offset:4096
  v_mfma_f32_16x16x32_bf16 v[104:107], a[32:35], a[8:11], v[104:107]
  v_mfma_f32_16x16x32_bf16 v[108:111], a[32:35], a[12:15], v[108:111]
  s_waitcnt lgkmcnt(9)
  v_mfma_f32_16x16x32_bf16 v[112:115], a[36:39], a[0:3], v[112:115]
  ds_read_b64_tr_b16 a[52:53], v8 offset:30848
  ds_read_b64_tr_b16 a[54:55], v8 offset:32128
  v_mfma_f32_16x16x32_bf16 v[116:119], a[36:39], a[4:7], v[116:119]
  ds_read_b128 a[28:31], v5 offset:6144
  v_mfma_f32_16x16x32_bf16 v[120:123], a[36:39], a[8:11], v[120:123]
  v_mfma_f32_16x16x32_bf16 v[124:127], a[36:39], a[12:15], v[124:127]
  s_waitcnt lgkmcnt(10)
  v_mfma_f32_16x16x32_bf16 v[128:131], a[40:43], a[0:3], v[128:131]
  ds_read_b64_tr_b16 a[32:33], v8 offset:25600
  ds_read_b64_tr_b16 a[34:35], v8 offset:26880
  v_mfma_f32_16x16x32_bf16 v[132:135], a[40:43], a[4:7], v[132:135]
  v_mfma_f32_16x16x32_bf16 v[136:139], a[40:43], a[8:11], v[136:139]
  v_mfma_f32_16x16x32_bf16 v[140:143], a[40:43], a[12:15], v[140:143]
  s_waitcnt lgkmcnt(9)
  v_mfma_f32_16x16x32_bf16 v[144:147], a[44:47], a[0:3], v[144:147]
  ds_read_b64_tr_b16 a[36:37], v8 offset:25632
  ds_read_b64_tr_b16 a[38:39], v8 offset:26912
  v_mfma_f32_16x16x32_bf16 v[148:151], a[44:47], a[4:7], v[148:151]
  v_mfma_f32_16x16x32_bf16 v[152:155], a[44:47], a[8:11], v[152:155]
  v_mfma_f32_16x16x32_bf16 v[156:159], a[44:47], a[12:15], v[156:159]
  s_waitcnt lgkmcnt(8)
  v_mfma_f32_16x16x32_bf16 v[160:163], a[48:51], a[0:3], v[160:163]
  ds_read_b64_tr_b16 a[40:41], v8 offset:25664
  ds_read_b64_tr_b16 a[42:43], v8 offset:26944
  v_mfma_f32_16x16x32_bf16 v[164:167], a[48:51], a[4:7], v[164:167]
  v_mfma_f32_16x16x32_bf16 v[168:171], a[48:51], a[8:11], v[168:171]
  v_mfma_f32_16x16x32_bf16 v[172:175], a[48:51], a[12:15], v[172:175]
  s_waitcnt lgkmcnt(7)
  v_mfma_f32_16x16x32_bf16 v[176:179], a[52:55], a[0:3], v[176:179]
  ds_read_b64_tr_b16 a[44:45], v8 offset:25696
  ds_read_b64_tr_b16 a[46:47], v8 offset:26976
  v_mfma_f32_16x16x32_bf16 v[180:183], a[52:55], a[4:7], v[180:183]
  v_mfma_f32_16x16x32_bf16 v[184:187], a[52:55], a[8:11], v[184:187]
  v_mfma_f32_16x16x32_bf16 v[188:191], a[52:55], a[12:15], v[188:191]
  s_waitcnt lgkmcnt(6)
  v_mfma_f32_16x16x32_bf16 v[32:35], a[32:35], a[16:19], v[32:35]
  ds_read_b64_tr_b16 a[48:49], v8 offset:25728
  ds_read_b64_tr_b16 a[50:51], v8 offset:27008
  v_mfma_f32_16x16x32_bf16 v[36:39], a[32:35], a[20:23], v[36:39]
  v_mfma_f32_16x16x32_bf16 v[40:43], a[32:35], a[24:27], v[40:43]
  v_mfma_f32_16x16x32_bf16 v[44:47], a[32:35], a[28:31], v[44:47]
  s_waitcnt lgkmcnt(6)
  v_mfma_f32_16x16x32_bf16 v[48:51], a[36:39], a[16:19], v[48:51]
  ds_read_b64_tr_b16 a[52:53], v8 offset:35840
  ds_read_b64_tr_b16 a[54:55], v8 offset:37120
  v_mfma_f32_16x16x32_bf16 v[52:55], a[36:39], a[20:23], v[52:55]
  v_mfma_f32_16x16x32_bf16 v[56:59], a[36:39], a[24:27], v[56:59]
  v_mfma_f32_16x16x32_bf16 v[60:63], a[36:39], a[28:31], v[60:63]
  s_waitcnt lgkmcnt(6)
  v_mfma_f32_16x16x32_bf16 v[64:67], a[40:43], a[16:19], v[64:67]
  ds_read_b64_tr_b16 a[32:33], v8 offset:35872
  ds_read_b64_tr_b16 a[34:35], v8 offset:37152
  v_mfma_f32_16x16x32_bf16 v[68:71], a[40:43], a[20:23], v[68:71]
  v_mfma_f32_16x16x32_bf16 v[72:75], a[40:43], a[24:27], v[72:75]
  v_mfma_f32_16x16x32_bf16 v[76:79], a[40:43], a[28:31], v[76:79]
  s_waitcnt lgkmcnt(6)
  v_mfma_f32_16x16x32_bf16 v[80:83], a[44:47], a[16:19], v[80:83]
  ds_read_b64_tr_b16 a[36:37], v8 offset:35904
  ds_read_b64_tr_b16 a[38:39], v8 offset:37184
  v_mfma_f32_16x16x32_bf16 v[84:87], a[44:47], a[20:23], v[84:87]
  v_mfma_f32_16x16x32_bf16 v[88:91], a[44:47], a[24:27], v[88:91]
  v_mfma_f32_16x16x32_bf16 v[92:95], a[44:47], a[28:31], v[92:95]
  s_waitcnt lgkmcnt(6)
  v_mfma_f32_16x16x32_bf16 v[96:99], a[48:51], a[16:19], v[96:99]
  ds_read_b64_tr_b16 a[40:41], v8 offset:35936
  ds_read_b64_tr_b16 a[42:43], v8 offset:37216
  v_mfma_f32_16x16x32_bf16 v[100:103], a[48:51], a[20:23], v[100:103]
  v_mfma_f32_16x16x32_bf16 v[104:107], a[48:51], a[24:27], v[104:107]
  v_mfma_f32_16x16x32_bf16 v[108:111], a[48:51], a[28:31], v[108:111]
  s_waitcnt lgkmcnt(6)
  v_mfma_f32_16x16x32_bf16 v[112:115], a[52:55], a[16:19], v[112:115]
  ds_read_b64_tr_b16 a[44:45], v8 offset:35968
  ds_read_b64_tr_b16 a[46:47], v8 offset:37248
  v_mfma_f32_16x16x32_bf16 v[116:119], a[52:55], a[20:23], v[116:119]
  v_mfma_f32_16x16x32_bf16 v[120:123], a[52:55], a[24:27], v[120:123]
  v_mfma_f32_16x16x32_bf16 v[124:127], a[52:55], a[28:31], v[124:127]
  s_waitcnt lgkmcnt(6)
  v_mfma_f32_16x16x32_bf16 v[128:131], a[32:35], a[16:19], v[128:131]
  v_mfma_f32_16x16x32_bf16 v[132:135], a[32:35], a[20:23], v[132:135]
  v_mfma_f32_16x16x32_bf16 v[136:139], a[32:35], a[24:27], v[136:139]
  v_mfma_f32_16x16x32_bf16 v[140:143], a[32:35], a[28:31], v[140:143]
  s_waitcnt lgkmcnt(0)
  s_barrier
  v_mfma_f32_16x16x32_bf16 v[144:147], a[36:39], a[16:19], v[144:147]
  ds_read_b64_tr_b16 a[48:49], v8 offset:40960
  ds_read_b64_tr_b16 a[50:51], v8 offset:42240
  v_mfma_f32_16x16x32_bf16 v[148:151], a[36:39], a[20:23], v[148:151]
  ds_read_b128 a[0:3], v6 offset:0
  v_mfma_f32_16x16x32_bf16 v[152:155], a[36:39], a[24:27], v[152:155]
  ds_read_b64_tr_b16 a[52:53], v8 offset:40992
  ds_read_b64_tr_b16 a[54:55], v8 offset:42272
  v_mfma_f32_16x16x32_bf16 v[156:159], a[36:39], a[28:31], v[156:159]
  ds_read_b128 a[4:7], v6 offset:2048
  v_mfma_f32_16x16x32_bf16 v[160:163], a[40:43], a[16:19], v[160:163]
  ds_read_b64_tr_b16 a[32:33], v8 offset:41024
  ds_read_b64_tr_b16 a[34:35], v8 offset:42304
  v_mfma_f32_16x16x32_bf16 v[164:167], a[40:43], a[20:23], v[164:167]
  ds_read_b128 a[8:11], v6 offset:4096
  v_mfma_f32_16x16x32_bf16 v[168:171], a[40:43], a[24:27], v[168:171]
  ds_read_b128 a[12:15], v6 offset:6144
  v_mfma_f32_16x16x32_bf16 v[172:175], a[40:43], a[28:31], v[172:175]
  v_mfma_f32_16x16x32_bf16 v[176:179], a[44:47], a[16:19], v[176:179]
  ds_read_b64_tr_b16 a[36:37], v8 offset:41056
  ds_read_b64_tr_b16 a[38:39], v8 offset:42336
  v_mfma_f32_16x16x32_bf16 v[180:183], a[44:47], a[20:23], v[180:183]
  v_mfma_f32_16x16x32_bf16 v[184:187], a[44:47], a[24:27], v[184:187]
  v_mfma_f32_16x16x32_bf16 v[188:191], a[44:47], a[28:31], v[188:191]
  s_waitcnt lgkmcnt(2)
  v_mfma_f32_16x16x32_bf16 v[32:35], a[48:51], a[0:3], v[32:35]
  ds_read_b64_tr_b16 a[40:41], v8 offset:41088
  ds_read_b64_tr_b16 a[42:43], v8 offset:42368
  v_mfma_f32_16x16x32_bf16 v[36:39], a[48:51], a[4:7], v[36:39]
  v_mfma_f32_16x16x32_bf16 v[40:43], a[48:51], a[8:11], v[40:43]
  v_mfma_f32_16x16x32_bf16 v[44:47], a[48:51], a[12:15], v[44:47]
  v_mfma_f32_16x16x32_bf16 v[48:51], a[52:55], a[0:3], v[48:51]
  ds_read_b64_tr_b16 a[44:45], v8 offset:51200
  ds_read_b64_tr_b16 a[46:47], v8 offset:52480
  v_mfma_f32_16x16x32_bf16 v[52:55], a[52:55], a[4:7], v[52:55]
  v_mfma_f32_16x16x32_bf16 v[56:59], a[52:55], a[8:11], v[56:59]
  v_mfma_f32_16x16x32_bf16 v[60:63], a[52:55], a[12:15], v[60:63]
  v_mfma_f32_16x16x32_bf16 v[64:67], a[32:35], a[0:3], v[64:67]
  ds_read_b64_tr_b16 a[48:49], v8 offset:51232
  ds_read_b64_tr_b16 a[50:51], v8 offset:52512
  v_mfma_f32_16x16x32_bf16 v[68:71], a[32:35], a[4:7], v[68:71]
  ds_read_b128 a[16:19], v7 offset:0
  v_mfma_f32_16x16x32_bf16 v[72:75], a[32:35], a[8:11], v[72:75]
  v_mfma_f32_16x16x32_bf16 v[76:79], a[32:35], a[12:15], v[76:79]
  s_waitcnt lgkmcnt(7)
  v_mfma_f32_16x16x32_bf16 v[80:83], a[36:39], a[0:3], v[80:83]
  ds_read_b64_tr_b16 a[52:53], v8 offset:51264
  ds_read_b64_tr_b16 a[54:55], v8 offset:52544
  v_mfma_f32_16x16x32_bf16 v[84:87], a[36:39], a[4:7], v[84:87]
  ds_read_b128 a[20:23], v7 offset:2048
  v_mfma_f32_16x16x32_bf16 v[88:91], a[36:39], a[8:11], v[88:91]
  v_mfma_f32_16x16x32_bf16 v[92:95], a[36:39], a[12:15], v[92:95]
  s_waitcnt lgkmcnt(8)
  v_mfma_f32_16x16x32_bf16 v[96:99], a[40:43], a[0:3], v[96:99]
  ds_read_b64_tr_b16 a[32:33], v8 offset:51296
  ds_read_b64_tr_b16 a[34:35], v8 offset:52576
  v_mfma_f32_16x16x32_bf16 v[100:103], a[40:43], a[4:7], v[100:103]
  ds_read_b128 a[24:27], v7 offset:4096
  v_mfma_f32_16x16x32_bf16 v[104:107], a[40:43], a[8:11], v[104:107]
  v_mfma_f32_16x16x32_bf16 v[108:111], a[40:43], a[12:15], v[108:111]
  s_waitcnt lgkmcnt(9)
  v_mfma_f32_16x16x32_bf16 v[112:115], a[44:47], a[0:3], v[112:115]
  ds_read_b64_tr_b16 a[36:37], v8 offset:51328
  ds_read_b64_tr_b16 a[38:39], v8 offset:52608
  v_mfma_f32_16x16x32_bf16 v[116:119], a[44:47], a[4:7], v[116:119]
  ds_read_b128 a[28:31], v7 offset:6144
  v_mfma_f32_16x16x32_bf16 v[120:123], a[44:47], a[8:11], v[120:123]
  v_mfma_f32_16x16x32_bf16 v[124:127], a[44:47], a[12:15], v[124:127]
  s_waitcnt lgkmcnt(10)
  v_mfma_f32_16x16x32_bf16 v[128:131], a[48:51], a[0:3], v[128:131]
  ds_read_b64_tr_b16 a[40:41], v8 offset:46080
  ds_read_b64_tr_b16 a[42:43], v8 offset:47360
  v_mfma_f32_16x16x32_bf16 v[132:135], a[48:51], a[4:7], v[132:135]
  v_mfma_f32_16x16x32_bf16 v[136:139], a[48:51], a[8:11], v[136:139]
  v_mfma_f32_16x16x32_bf16 v[140:143], a[48:51], a[12:15], v[140:143]
  s_waitcnt lgkmcnt(9)
  v_mfma_f32_16x16x32_bf16 v[144:147], a[52:55], a[0:3], v[144:147]
  ds_read_b64_tr_b16 a[44:45], v8 offset:46112
  ds_read_b64_tr_b16 a[46:47], v8 offset:47392
  v_mfma_f32_16x16x32_bf16 v[148:151], a[52:55], a[4:7], v[148:151]
  v_mfma_f32_16x16x32_bf16 v[152:155], a[52:55], a[8:11], v[152:155]
  v_mfma_f32_16x16x32_bf16 v[156:159], a[52:55], a[12:15], v[156:159]
  s_waitcnt lgkmcnt(8)
  v_mfma_f32_16x16x32_bf16 v[160:163], a[32:35], a[0:3], v[160:163]
  ds_read_b64_tr_b16 a[48:49], v8 offset:46144
  ds_read_b64_tr_b16 a[50:51], v8 offset:47424
  v_mfma_f32_16x16x32_bf16 v[164:167], a[32:35], a[4:7], v[164:167]
  v_mfma_f32_16x16x32_bf16 v[168:171], a[32:35], a[8:11], v[168:171]
  v_mfma_f32_16x16x32_bf16 v[172:175], a[32:35], a[12:15], v[172:175]
  s_waitcnt lgkmcnt(7)
  v_mfma_f32_16x16x32_bf16 v[176:179], a[36:39], a[0:3], v[176:179]
  ds_read_b64_tr_b16 a[52:53], v8 offset:46176
  ds_read_b64_tr_b16 a[54:55], v8 offset:47456
  v_mfma_f32_16x16x32_bf16 v[180:183], a[36:39], a[4:7], v[180:183]
  v_mfma_f32_16x16x32_bf16 v[184:187], a[36:39], a[8:11], v[184:187]
  v_mfma_f32_16x16x32_bf16 v[188:191], a[36:39], a[12:15], v[188:191]
  s_waitcnt lgkmcnt(6)
  v_mfma_f32_16x16x32_bf16 v[32:35], a[40:43], a[16:19], v[32:35]
  ds_read_b64_tr_b16 a[32:33], v8 offset:46208
  ds_read_b64_tr_b16 a[34:35], v8 offset:47488
  v_mfma_f32_16x16x32_bf16 v[36:39], a[40:43], a[20:23], v[36:39]
  v_mfma_f32_16x16x32_bf16 v[40:43], a[40:43], a[24:27], v[40:43]
  v_mfma_f32_16x16x32_bf16 v[44:47], a[40:43], a[28:31], v[44:47]
  s_waitcnt lgkmcnt(6)
  v_mfma_f32_16x16x32_bf16 v[48:51], a[44:47], a[16:19], v[48:51]
  ds_read_b64_tr_b16 a[36:37], v8 offset:56320
  ds_read_b64_tr_b16 a[38:39], v8 offset:57600
  v_mfma_f32_16x16x32_bf16 v[52:55], a[44:47], a[20:23], v[52:55]
  v_mfma_f32_16x16x32_bf16 v[56:59], a[44:47], a[24:27], v[56:59]
  v_mfma_f32_16x16x32_bf16 v[60:63], a[44:47], a[28:31], v[60:63]
  s_waitcnt lgkmcnt(6)
  v_mfma_f32_16x16x32_bf16 v[64:67], a[48:51], a[16:19], v[64:67]
  ds_read_b64_tr_b16 a[40:41], v8 offset:56352
  ds_read_b64_tr_b16 a[42:43], v8 offset:57632
  v_mfma_f32_16x16x32_bf16 v[68:71], a[48:51], a[20:23], v[68:71]
  v_mfma_f32_16x16x32_bf16 v[72:75], a[48:51], a[24:27], v[72:75]
  v_mfma_f32_16x16x32_bf16 v[76:79], a[48:51], a[28:31], v[76:79]
  s_waitcnt lgkmcnt(6)
  v_mfma_f32_16x16x32_bf16 v[80:83], a[52:55], a[16:19], v[80:83]
  ds_read_b64_tr_b16 a[44:45], v8 offset:56384
  ds_read_b64_tr_b16 a[46:47], v8 offset:57664
  v_mfma_f32_16x16x32_bf16 v[84:87], a[52:55], a[20:23], v[84:87]
  v_mfma_f32_16x16x32_bf16 v[88:91], a[52:55], a[24:27], v[88:91]
  v_mfma_f32_16x16x32_bf16 v[92:95], a[52:55], a[28:31], v[92:95]
  s_waitcnt lgkmcnt(6)
  v_mfma_f32_16x16x32_bf16 v[96:99], a[32:35], a[16:19], v[96:99]
  ds_read_b64_tr_b16 a[48:49], v8 offset:56416
  ds_read_b64_tr_b16 a[50:51], v8 offset:57696
  v_mfma_f32_16x16x32_bf16 v[100:103], a[32:35], a[20:23], v[100:103]
  v_mfma_f32_16x16x32_bf16 v[104:107], a[32:35], a[24:27], v[104:107]
  v_mfma_f32_16x16x32_bf16 v[108:111], a[32:35], a[28:31], v[108:111]
  s_waitcnt lgkmcnt(6)
  v_mfma_f32_16x16x32_bf16 v[112:115], a[36:39], a[16:19], v[112:115]
  ds_read_b64_tr_b16 a[52:53], v8 offset:56448
  ds_read_b64_tr_b16 a[54:55], v8 offset:57728
  v_mfma_f32_16x16x32_bf16 v[116:119], a[36:39], a[20:23], v[116:119]
  v_mfma_f32_16x16x32_bf16 v[120:123], a[36:39], a[24:27], v[120:123]
  v_mfma_f32_16x16x32_bf16 v[124:127], a[36:39], a[28:31], v[124:127]
  s_waitcnt lgkmcnt(6)
  v_mfma_f32_16x16x32_bf16 v[128:131], a[40:43], a[16:19], v[128:131]
  v_mfma_f32_16x16x32_bf16 v[132:135], a[40:43], a[20:23], v[132:135]
  v_mfma_f32_16x16x32_bf16 v[136:139], a[40:43], a[24:27], v[136:139]
  v_mfma_f32_16x16x32_bf16 v[140:143], a[40:43], a[28:31], v[140:143]
  s_waitcnt lgkmcnt(0)
  s_barrier
  v_mfma_f32_16x16x32_bf16 v[144:147], a[44:47], a[16:19], v[144:147]
  ds_read_b64_tr_b16 a[32:33], v8 offset:0
  ds_read_b64_tr_b16 a[34:35], v8 offset:1280
  v_mfma_f32_16x16x32_bf16 v[148:151], a[44:47], a[20:23], v[148:151]
  ds_read_b128 a[0:3], v2 offset:0
  v_mfma_f32_16x16x32_bf16 v[152:155], a[44:47], a[24:27], v[152:155]
  ds_read_b64_tr_b16 a[36:37], v8 offset:32
  ds_read_b64_tr_b16 a[38:39], v8 offset:1312
  v_mfma_f32_16x16x32_bf16 v[156:159], a[44:47], a[28:31], v[156:159]
  ds_read_b128 a[4:7], v2 offset:2048
  v_mfma_f32_16x16x32_bf16 v[160:163], a[48:51], a[16:19], v[160:163]
  ds_read_b64_tr_b16 a[40:41], v8 offset:64
  ds_read_b64_tr_b16 a[42:43], v8 offset:1344
  v_mfma_f32_16x16x32_bf16 v[164:167], a[48:51], a[20:23], v[164:167]
  ds_read_b128 a[8:11], v2 offset:4096
  v_mfma_f32_16x16x32_bf16 v[168:171], a[48:51], a[24:27], v[168:171]
  ds_read_b128 a[12:15], v2 offset:6144
  v_mfma_f32_16x16x32_bf16 v[172:175], a[48:51], a[28:31], v[172:175]
  v_mfma_f32_16x16x32_bf16 v[176:179], a[52:55], a[16:19], v[176:179]
  ds_read_b64_tr_b16 a[44:45], v8 offset:96
  ds_read_b64_tr_b16 a[46:47], v8 offset:1376
  v_mfma_f32_16x16x32_bf16 v[180:183], a[52:55], a[20:23], v[180:183]
  v_mfma_f32_16x16x32_bf16 v[184:187], a[52:55], a[24:27], v[184:187]
  v_mfma_f32_16x16x32_bf16 v[188:191], a[52:55], a[28:31], v[188:191]
  s_add_u32 s87, s87, 1
  s_cmp_lt_u32 s87, 3
  s_cbranch_scc1 K1_CL_1
  s_waitcnt lgkmcnt(2)
  v_mfma_f32_16x16x32_bf16 v[32:35], a[32:35], a[0:3], v[32:35]
  ds_read_b64_tr_b16 a[48:49], v8 offset:128
  ds_read_b64_tr_b16 a[50:51], v8 offset:1408
  v_mfma_f32_16x16x32_bf16 v[36:39], a[32:35], a[4:7], v[36:39]
  v_mfma_f32_16x16x32_bf16 v[40:43], a[32:35], a[8:11], v[40:43]
  v_mfma_f32_16x16x32_bf16 v[44:47], a[32:35], a[12:15], v[44:47]
  v_mfma_f32_16x16x32_bf16 v[48:51], a[36:39], a[0:3], v[48:51]
  ds_read_b64_tr_b16 a[52:53], v8 offset:10240
  ds_read_b64_tr_b16 a[54:55], v8 offset:11520
  v_mfma_f32_16x16x32_bf16 v[52:55], a[36:39], a[4:7], v[52:55]
  v_mfma_f32_16x16x32_bf16 v[56:59], a[36:39], a[8:11], v[56:59]
  v_mfma_f32_16x16x32_bf16 v[60:63], a[36:39], a[12:15], v[60:63]
  v_mfma_f32_16x16x32_bf16 v[64:67], a[40:43], a[0:3], v[64:67]
  ds_read_b64_tr_b16 a[32:33], v8 offset:10272
  ds_read_b64_tr_b16 a[34:35], v8 offset:11552
  v_mfma_f32_16x16x32_bf16 v[68:71], a[40:43], a[4:7], v[68:71]
  ds_read_b128 a[16:19], v3 offset:0
  v_mfma_f32_16x16x32_bf16 v[72:75], a[40:43], a[8:11], v[72:75]
  v_mfma_f32_16x16x32_bf16 v[76:79], a[40:43], a[12:15], v[76:79]
  s_waitcnt lgkmcnt(7)
  v_mfma_f32_16x16x32_bf16 v[80:83], a[44:47], a[0:3], v[80:83]
  ds_read_b64_tr_b16 a[36:37], v8 offset:10304
  ds_read_b64_tr_b16 a[38:39], v8 offset:11584
  v_mfma_f32_16x16x32_bf16 v[84:87], a[44:47], a[4:7], v[84:87]
  ds_read_b128 a[20:23], v3 offset:2048
  v_mfma_f32_16x16x32_bf16 v[88:91], a[44:47], a[8:11], v[88:91]
  v_mfma_f32_16x16x32_bf16 v[92:95], a[44:47], a[12:15], v[92:95]
  s_waitcnt lgkmcnt(8)
  v_mfma_f32_16x16x32_bf16 v[96:99], a[48:51], a[0:3], v[96:99]
  ds_read_b64_tr_b16 a[40:41], v8 offset:10336
  ds_read_b64_tr_b16 a[42:43], v8 offset:11616
  v_mfma_f32_16x16x32_bf16 v[100:103], a[48:51], a[4:7], v[100:103]
  ds_read_b128 a[24:27], v3 offset:4096
  v_mfma_f32_16x16x32_bf16 v[104:107], a[48:51], a[8:11], v[104:107]
  v_mfma_f32_16x16x32_bf16 v[108:111], a[48:51], a[12:15], v[108:111]
  s_waitcnt lgkmcnt(9)
  v_mfma_f32_16x16x32_bf16 v[112:115], a[52:55], a[0:3], v[112:115]
  ds_read_b64_tr_b16 a[44:45], v8 offset:10368
  ds_read_b64_tr_b16 a[46:47], v8 offset:11648
  v_mfma_f32_16x16x32_bf16 v[116:119], a[52:55], a[4:7], v[116:119]
  ds_read_b128 a[28:31], v3 offset:6144
  v_mfma_f32_16x16x32_bf16 v[120:123], a[52:55], a[8:11], v[120:123]
  v_mfma_f32_16x16x32_bf16 v[124:127], a[52:55], a[12:15], v[124:127]
  s_waitcnt lgkmcnt(10)
  v_mfma_f32_16x16x32_bf16 v[128:131], a[32:35], a[0:3], v[128:131]
  ds_read_b64_tr_b16 a[48:49], v8 offset:5120
  ds_read_b64_tr_b16 a[50:51], v8 offset:6400
  v_mfma_f32_16x16x32_bf16 v[132:135], a[32:35], a[4:7], v[132:135]
  v_mfma_f32_16x16x32_bf16 v[136:139], a[32:35], a[8:11], v[136:139]
  v_mfma_f32_16x16x32_bf16 v[140:143], a[32:35], a[12:15], v[140:143]
  s_waitcnt lgkmcnt(9)
  v_mfma_f32_16x16x32_bf16 v[144:147], a[36:39], a[0:3], v[144:147]
  ds_read_b64_tr_b16 a[52:53], v8 offset:5152
  ds_read_b64_tr_b16 a[54:55], v8 offset:6432
  v_mfma_f32_16x16x32_bf16 v[148:151], a[36:39], a[4:7], v[148:151]
  v_mfma_f32_16x16x32_bf16 v[152:155], a[36:39], a[8:11], v[152:155]
  v_mfma_f32_16x16x32_bf16 v[156:159], a[36:39], a[12:15], v[156:159]
  s_waitcnt lgkmcnt(8)
  v_mfma_f32_16x16x32_bf16 v[160:163], a[40:43], a[0:3], v[160:163]
  ds_read_b64_tr_b16 a[32:33], v8 offset:5184
  ds_read_b64_tr_b16 a[34:35], v8 offset:6464
  v_mfma_f32_16x16x32_bf16 v[164:167], a[40:43], a[4:7], v[164:167]
  v_mfma_f32_16x16x32_bf16 v[168:171], a[40:43], a[8:11], v[168:171]
  v_mfma_f32_16x16x32_bf16 v[172:175], a[40:43], a[12:15], v[172:175]
  s_waitcnt lgkmcnt(7)
  v_mfma_f32_16x16x32_bf16 v[176:179], a[44:47], a[0:3], v[176:179]
  ds_read_b64_tr_b16 a[36:37], v8 offset:5216
  ds_read_b64_tr_b16 a[38:39], v8 offset:6496
  v_mfma_f32_16x16x32_bf16 v[180:183], a[44:47], a[4:7], v[180:183]
  v_mfma_f32_16x16x32_bf16 v[184:187], a[44:47], a[8:11], v[184:187]
  v_mfma_f32_16x16x32_bf16 v[188:191], a[44:47], a[12:15], v[188:191]
  s_waitcnt lgkmcnt(6)
  v_mfma_f32_16x16x32_bf16 v[32:35], a[48:51], a[16:19], v[32:35]
  ds_read_b64_tr_b16 a[40:41], v8 offset:5248
  ds_read_b64_tr_b16 a[42:43], v8 offset:6528
  v_mfma_f32_16x16x32_bf16 v[36:39], a[48:51], a[20:23], v[36:39]
  v_mfma_f32_16x16x32_bf16 v[40:43], a[48:51], a[24:27], v[40:43]
  v_mfma_f32_16x16x32_bf16 v[44:47], a[48:51], a[28:31], v[44:47]
  s_waitcnt lgkmcnt(6)
  v_mfma_f32_16x16x32_bf16 v[48:51], a[52:55], a[16:19], v[48:51]
  ds_read_b64_tr_b16 a[44:45], v8 offset:15360
  ds_read_b64_tr_b16 a[46:47], v8 offset:16640
  v_mfma_f32_16x16x32_bf16 v[52:55], a[52:55], a[20:23], v[52:55]
  v_mfma_f32_16x16x32_bf16 v[56:59], a[52:55], a[24:27], v[56:59]
  v_mfma_f32_16x16x32_bf16 v[60:63], a[52:55], a[28:31], v[60:63]
  s_waitcnt lgkmcnt(6)
  v_mfma_f32_16x16x32_bf16 v[64:67], a[32:35], a[16:19], v[64:67]
  ds_read_b64_tr_b16 a[48:49], v8 offset:15392
  ds_read_b64_tr_b16 a[50:51], v8 offset:16672
  v_mfma_f32_16x16x32_bf16 v[68:71], a[32:35], a[20:23], v[68:71]
  v_mfma_f32_16x16x32_bf16 v[72:75], a[32:35], a[24:27], v[72:75]
  v_mfma_f32_16x16x32_bf16 v[76:79], a[32:35], a[28:31], v[76:79]
  s_waitcnt lgkmcnt(6)
  v_mfma_f32_16x16x32_bf16 v[80:83], a[36:39], a[16:19], v[80:83]
  ds_read_b64_tr_b16 a[52:53], v8 offset:15424
  ds_read_b64_tr_b16 a[54:55], v8 offset:16704
  v_mfma_f32_16x16x32_bf16 v[84:87], a[36:39], a[20:23], v[84:87]
  v_mfma_f32_16x16x32_bf16 v[88:91], a[36:39], a[24:27], v[88:91]
  v_mfma_f32_16x16x32_bf16 v[92:95], a[36:39], a[28:31], v[92:95]
  s_waitcnt lgkmcnt(6)
  v_mfma_f32_16x16x32_bf16 v[96:99], a[40:43], a[16:19], v[96:99]
  ds_read_b64_tr_b16 a[32:33], v8 offset:15456
  ds_read_b64_tr_b16 a[34:35], v8 offset:16736
  v_mfma_f32_16x16x32_bf16 v[100:103], a[40:43], a[20:23], v[100:103]
  v_mfma_f32_16x16x32_bf16 v[104:107], a[40:43], a[24:27], v[104:107]
  v_mfma_f32_16x16x32_bf16 v[108:111], a[40:43], a[28:31], v[108:111]
  s_waitcnt lgkmcnt(6)
  v_mfma_f32_16x16x32_bf16 v[112:115], a[44:47], a[16:19], v[112:115]
  ds_read_b64_tr_b16 a[36:37], v8 offset:15488
  ds_read_b64_tr_b16 a[38:39], v8 offset:16768
  v_mfma_f32_16x16x32_bf16 v[116:119], a[44:47], a[20:23], v[116:119]
  v_mfma_f32_16x16x32_bf16 v[120:123], a[44:47], a[24:27], v[120:123]
  v_mfma_f32_16x16x32_bf16 v[124:127], a[44:47], a[28:31], v[124:127]
  s_waitcnt lgkmcnt(6)
  v_mfma_f32_16x16x32_bf16 v[128:131], a[48:51], a[16:19], v[128:131]
  v_mfma_f32_16x16x32_bf16 v[132:135], a[48:51], a[20:23], v[132:135]
  v_mfma_f32_16x16x32_bf16 v[136:139], a[48:51], a[24:27], v[136:139]
  v_mfma_f32_16x16x32_bf16 v[140:143], a[48:51], a[28:31], v[140:143]
  s_waitcnt lgkmcnt(4)
  v_mfma_f32_16x16x32_bf16 v[144:147], a[52:55], a[16:19], v[144:147]
  v_mfma_f32_16x16x32_bf16 v[148:151], a[52:55], a[20:23], v[148:151]
  v_mfma_f32_16x16x32_bf16 v[152:155], a[52:55], a[24:27], v[152:155]
  v_mfma_f32_16x16x32_bf16 v[156:159], a[52:55], a[28:31], v[156:159]
  s_waitcnt lgkmcnt(2)
  v_mfma_f32_16x16x32_bf16 v[160:163], a[32:35], a[16:19], v[160:163]
  v_mfma_f32_16x16x32_bf16 v[164:167], a[32:35], a[20:23], v[164:167]
  v_mfma_f32_16x16x32_bf16 v[168:171], a[32:35], a[24:27], v[168:171]
  v_mfma_f32_16x16x32_bf16 v[172:175], a[32:35], a[28:31], v[172:175]
  s_waitcnt lgkmcnt(0)
  v_mfma_f32_16x16x32_bf16 v[176:179], a[36:39], a[16:19], v[176:179]
  v_mfma_f32_16x16x32_bf16 v[180:183], a[36:39], a[20:23], v[180:183]
  v_mfma_f32_16x16x32_bf16 v[184:187], a[36:39], a[24:27], v[184:187]
  v_mfma_f32_16x16x32_bf16 v[188:191], a[36:39], a[28:31], v[188:191]
  s_waitcnt vmcnt(0)
  s_setprio 3
  s_barrier
  s_lshl_b32 s65, s3, 8
  v_lshlrev_b32 v2, 2, v31
  v_add_u32 v2, s65, v2
  v_add_u32 v2, 160768, v2
  v_lshlrev_b32 v3, 4, v30
  v_add_u32 v3, 162816, v3

  ds_read_b32 v4, v2 offset:0
  ds_read_b32 v8, v2 offset:1024
  ds_read_b32 v5, v2 offset:64
  ds_read_b32 v9, v2 offset:1088
  ds_read_b32 v6, v2 offset:128
  ds_read_b32 v10, v2 offset:1152
  ds_read_b32 v7, v2 offset:192
  ds_read_b32 v11, v2 offset:1216
  v_mov_b32 v15, 158720
  ds_read_b32 v14, v15
  s_cmp_eq_u32 s66, 1
  s_waitcnt lgkmcnt(0)
  v_readfirstlane_b32 s95, v14
  v_mul_f32 v4, v4, v4
  v_mul_f32 v5, v5, v5
  v_mul_f32 v6, v6, v6
  v_mul_f32 v7, v7, v7
  s_cbranch_scc1 K1_GLU_ODD
  ds_read_b128 v[14:17], v3 offset:256
  ds_read_b128 v[18:21], v3 offset:576
  s_waitcnt lgkmcnt(0)
  v_pk_fma_f32 v[96:97], v[14:15], v[8:9], v[96:97] op_sel:[0,0,0] op_sel_hi:[1,0,1] neg_lo:[0,1,0] neg_hi:[0,1,0]
  v_pk_fma_f32 v[176:177], v[18:19], v[8:9], v[176:177] op_sel:[0,0,0] op_sel_hi:[1,0,1] neg_lo:[0,1,0] neg_hi:[0,1,0]
  v_pk_fma_f32 v[98:99], v[16:17], v[8:9], v[98:99] op_sel:[0,0,0] op_sel_hi:[1,0,1] neg_lo:[0,1,0] neg_hi:[0,1,0]
  v_pk_fma_f32 v[178:179], v[20:21], v[8:9], v[178:179] op_sel:[0,0,0] op_sel_hi:[1,0,1] neg_lo:[0,1,0] neg_hi:[0,1,0]
  v_pk_mul_f32 v[96:97], v[96:97], v[176:177]
  v_pk_mul_f32 v[98:99], v[98:99], v[178:179]
  v_pk_mul_f32 v[96:97], v[96:97], v[4:5] op_sel:[0,0] op_sel_hi:[1,0]
  v_pk_mul_f32 v[98:99], v[98:99], v[4:5] op_sel:[0,0] op_sel_hi:[1,0]
  v_cvt_pk_bf16_f32 v176, v96, v97
  v_cvt_pk_bf16_f32 v177, v98, v99
  v_pk_fma_f32 v[100:101], v[14:15], v[8:9], v[100:101] op_sel:[0,1,0] op_sel_hi:[1,1,1] neg_lo:[0,1,0] neg_hi:[0,1,0]
  v_pk_fma_f32 v[180:181], v[18:19], v[8:9], v[180:181] op_sel:[0,1,0] op_sel_hi:[1,1,1] neg_lo:[0,1,0] neg_hi:[0,1,0]
  v_pk_fma_f32 v[102:103], v[16:17], v[8:9], v[102:103] op_sel:[0,1,0] op_sel_hi:[1,1,1] neg_lo:[0,1,0] neg_hi:[0,1,0]
  v_pk_fma_f32 v[182:183], v[20:21], v[8:9], v[182:183] op_sel:[0,1,0] op_sel_hi:[1,1,1] neg_lo:[0,1,0] neg_hi:[0,1,0]
  v_pk_mul_f32 v[100:101], v[100:101], v[180:181]
  v_pk_mul_f32 v[102:103], v[102:103], v[182:183]
  v_pk_mul_f32 v[100:101], v[100:101], v[4:5] op_sel:[0,1] op_sel_hi:[1,1]
  v_pk_mul_f32 v[102:103], v[102:103], v[4:5] op_sel:[0,1] op_sel_hi:[1,1]
  v_cvt_pk_bf16_f32 v178, v100, v101
  v_cvt_pk_bf16_f32 v179, v102, v103
  s_add_u32 s75, s72, 0
  buffer_store_dwordx4 v[176:179], v12, s[16:19], s75 offen sc1
  v_pk_fma_f32 v[104:105], v[14:15], v[10:11], v[104:105] op_sel:[0,0,0] op_sel_hi:[1,0,1] neg_lo:[0,1,0] neg_hi:[0,1,0]
  v_pk_fma_f32 v[184:185], v[18:19], v[10:11], v[184:185] op_sel:[0,0,0] op_sel_hi:[1,0,1] neg_lo:[0,1,0] neg_hi:[0,1,0]
  v_pk_fma_f32 v[106:107], v[16:17], v[10:11], v[106:107] op_sel:[0,0,0] op_sel_hi:[1,0,1] neg_lo:[0,1,0] neg_hi:[0,1,0]
  v_pk_fma_f32 v[186:187], v[20:21], v[10:11], v[186:187] op_sel:[0,0,0] op_sel_hi:[1,0,1] neg_lo:[0,1,0] neg_hi:[0,1,0]
  v_pk_mul_f32 v[104:105], v[104:105], v[184:185]
  v_pk_mul_f32 v[106:107], v[106:107], v[186:187]
  v_pk_mul_f32 v[104:105], v[104:105], v[6:7] op_sel:[0,0] op_sel_hi:[1,0]
  v_pk_mul_f32 v[106:107], v[106:107], v[6:7] op_sel:[0,0] op_sel_hi:[1,0]
  v_cvt_pk_bf16_f32 v184, v104, v105
  v_cvt_pk_bf16_f32 v185, v106, v107
  v_pk_fma_f32 v[108:109], v[14:15], v[10:11], v[108:109] op_sel:[0,1,0] op_sel_hi:[1,1,1] neg_lo:[0,1,0] neg_hi:[0,1,0]
  v_pk_fma_f32 v[188:189], v[18:19], v[10:11], v[188:189] op_sel:[0,1,0] op_sel_hi:[1,1,1] neg_lo:[0,1,0] neg_hi:[0,1,0]
  v_pk_fma_f32 v[110:111], v[16:17], v[10:11], v[110:111] op_sel:[0,1,0] op_sel_hi:[1,1,1] neg_lo:[0,1,0] neg_hi:[0,1,0]
  v_pk_fma_f32 v[190:191], v[20:21], v[10:11], v[190:191] op_sel:[0,1,0] op_sel_hi:[1,1,1] neg_lo:[0,1,0] neg_hi:[0,1,0]
  v_pk_mul_f32 v[108:109], v[108:109], v[188:189]
  v_pk_mul_f32 v[110:111], v[110:111], v[190:191]
  v_pk_mul_f32 v[108:109], v[108:109], v[6:7] op_sel:[0,1] op_sel_hi:[1,1]
  v_pk_mul_f32 v[110:111], v[110:111], v[6:7] op_sel:[0,1] op_sel_hi:[1,1]
  v_cvt_pk_bf16_f32 v186, v108, v109
  v_cvt_pk_bf16_f32 v187, v110, v111
  s_add_u32 s75, s72, 196608
  buffer_store_dwordx4 v[184:187], v12, s[16:19], s75 offen sc1
  ds_read_b128 v[14:17], v3 offset:0
  ds_read_b128 v[18:21], v3 offset:320
  ds_read_b128 v[22:25], v3 offset:64
  ds_read_b128 v[26:29], v3 offset:384
  s_waitcnt lgkmcnt(0)
  v_pk_fma_f32 v[32:33], v[14:15], v[8:9], v[32:33] op_sel:[0,0,0] op_sel_hi:[1,0,1] neg_lo:[0,1,0] neg_hi:[0,1,0]
  v_pk_fma_f32 v[112:113], v[18:19], v[8:9], v[112:113] op_sel:[0,0,0] op_sel_hi:[1,0,1] neg_lo:[0,1,0] neg_hi:[0,1,0]
  v_pk_fma_f32 v[34:35], v[16:17], v[8:9], v[34:35] op_sel:[0,0,0] op_sel_hi:[1,0,1] neg_lo:[0,1,0] neg_hi:[0,1,0]
  v_pk_fma_f32 v[114:115], v[20:21], v[8:9], v[114:115] op_sel:[0,0,0] op_sel_hi:[1,0,1] neg_lo:[0,1,0] neg_hi:[0,1,0]
  v_pk_mul_f32 v[32:33], v[32:33], v[112:113]
  v_pk_mul_f32 v[34:35], v[34:35], v[114:115]
  v_pk_mul_f32 v[32:33], v[32:33], v[4:5] op_sel:[0,0] op_sel_hi:[1,0]
  v_pk_mul_f32 v[34:35], v[34:35], v[4:5] op_sel:[0,0] op_sel_hi:[1,0]
  v_pk_fma_f32 v[48:49], v[22:23], v[8:9], v[48:49] op_sel:[0,0,0] op_sel_hi:[1,0,1] neg_lo:[0,1,0] neg_hi:[0,1,0]
  v_pk_fma_f32 v[128:129], v[26:27], v[8:9], v[128:129] op_sel:[0,0,0] op_sel_hi:[1,0,1] neg_lo:[0,1,0] neg_hi:[0,1,0]
  v_pk_fma_f32 v[50:51], v[24:25], v[8:9], v[50:51] op_sel:[0,0,0] op_sel_hi:[1,0,1] neg_lo:[0,1,0] neg_hi:[0,1,0]
  v_pk_fma_f32 v[130:131], v[28:29], v[8:9], v[130:131] op_sel:[0,0,0] op_sel_hi:[1,0,1] neg_lo:[0,1,0] neg_hi:[0,1,0]
  v_pk_mul_f32 v[48:49], v[48:49], v[128:129]
  v_pk_mul_f32 v[50:51], v[50:51], v[130:131]
  v_pk_mul_f32 v[48:49], v[48:49], v[4:5] op_sel:[0,0] op_sel_hi:[1,0]
  v_pk_mul_f32 v[50:51], v[50:51], v[4:5] op_sel:[0,0] op_sel_hi:[1,0]
  v_cvt_pk_bf16_f32 v112, v32, v33
  v_cvt_pk_bf16_f32 v113, v34, v35
  v_cvt_pk_bf16_f32 v114, v48, v49
  v_cvt_pk_bf16_f32 v115, v50, v51
  s_add_u32 s75, s70, 0
  buffer_store_dwordx4 v[112:115], v12, s[16:19], s75 offen sc1
  v_pk_fma_f32 v[36:37], v[14:15], v[8:9], v[36:37] op_sel:[0,1,0] op_sel_hi:[1,1,1] neg_lo:[0,1,0] neg_hi:[0,1,0]
  v_pk_fma_f32 v[116:117], v[18:19], v[8:9], v[116:117] op_sel:[0,1,0] op_sel_hi:[1,1,1] neg_lo:[0,1,0] neg_hi:[0,1,0]
  v_pk_fma_f32 v[38:39], v[16:17], v[8:9], v[38:39] op_sel:[0,1,0] op_sel_hi:[1,1,1] neg_lo:[0,1,0] neg_hi:[0,1,0]
  v_pk_fma_f32 v[118:119], v[20:21], v[8:9], v[118:119] op_sel:[0,1,0] op_sel_hi:[1,1,1] neg_lo:[0,1,0] neg_hi:[0,1,0]
  v_pk_mul_f32 v[36:37], v[36:37], v[116:117]
  v_pk_mul_f32 v[38:39], v[38:39], v[118:119]
  v_pk_mul_f32 v[36:37], v[36:37], v[4:5] op_sel:[0,1] op_sel_hi:[1,1]
  v_pk_mul_f32 v[38:39], v[38:39], v[4:5] op_sel:[0,1] op_sel_hi:[1,1]
  v_pk_fma_f32 v[52:53], v[22:23], v[8:9], v[52:53] op_sel:[0,1,0] op_sel_hi:[1,1,1] neg_lo:[0,1,0] neg_hi:[0,1,0]
  v_pk_fma_f32 v[132:133], v[26:27], v[8:9], v[132:133] op_sel:[0,1,0] op_sel_hi:[1,1,1] neg_lo:[0,1,0] neg_hi:[0,1,0]
  v_pk_fma_f32 v[54:55], v[24:25], v[8:9], v[54:55] op_sel:[0,1,0] op_sel_hi:[1,1,1] neg_lo:[0,1,0] neg_hi:[0,1,0]
  v_pk_fma_f32 v[134:135], v[28:29], v[8:9], v[134:135] op_sel:[0,1,0] op_sel_hi:[1,1,1] neg_lo:[0,1,0] neg_hi:[0,1,0]
  v_pk_mul_f32 v[52:53], v[52:53], v[132:133]
  v_pk_mul_f32 v[54:55], v[54:55], v[134:135]
  v_pk_mul_f32 v[52:53], v[52:53], v[4:5] op_sel:[0,1] op_sel_hi:[1,1]
  v_pk_mul_f32 v[54:55], v[54:55], v[4:5] op_sel:[0,1] op_sel_hi:[1,1]
  v_cvt_pk_bf16_f32 v116, v36, v37
  v_cvt_pk_bf16_f32 v117, v38, v39
  v_cvt_pk_bf16_f32 v118, v52, v53
  v_cvt_pk_bf16_f32 v119, v54, v55
  s_add_u32 s75, s70, 98304
  buffer_store_dwordx4 v[116:119], v12, s[16:19], s75 offen sc1
  v_pk_fma_f32 v[40:41], v[14:15], v[10:11], v[40:41] op_sel:[0,0,0] op_sel_hi:[1,0,1] neg_lo:[0,1,0] neg_hi:[0,1,0]
  v_pk_fma_f32 v[120:121], v[18:19], v[10:11], v[120:121] op_sel:[0,0,0] op_sel_hi:[1,0,1] neg_lo:[0,1,0] neg_hi:[0,1,0]
  v_pk_fma_f32 v[42:43], v[16:17], v[10:11], v[42:43] op_sel:[0,0,0] op_sel_hi:[1,0,1] neg_lo:[0,1,0] neg_hi:[0,1,0]
  v_pk_fma_f32 v[122:123], v[20:21], v[10:11], v[122:123] op_sel:[0,0,0] op_sel_hi:[1,0,1] neg_lo:[0,1,0] neg_hi:[0,1,0]
  v_pk_mul_f32 v[40:41], v[40:41], v[120:121]
  v_pk_mul_f32 v[42:43], v[42:43], v[122:123]
  v_pk_mul_f32 v[40:41], v[40:41], v[6:7] op_sel:[0,0] op_sel_hi:[1,0]
  v_pk_mul_f32 v[42:43], v[42:43], v[6:7] op_sel:[0,0] op_sel_hi:[1,0]
  v_pk_fma_f32 v[56:57], v[22:23], v[10:11], v[56:57] op_sel:[0,0,0] op_sel_hi:[1,0,1] neg_lo:[0,1,0] neg_hi:[0,1,0]
  v_pk_fma_f32 v[136:137], v[26:27], v[10:11], v[136:137] op_sel:[0,0,0] op_sel_hi:[1,0,1] neg_lo:[0,1,0] neg_hi:[0,1,0]
  v_pk_fma_f32 v[58:59], v[24:25], v[10:11], v[58:59] op_sel:[0,0,0] op_sel_hi:[1,0,1] neg_lo:[0,1,0] neg_hi:[0,1,0]
  v_pk_fma_f32 v[138:139], v[28:29], v[10:11], v[138:139] op_sel:[0,0,0] op_sel_hi:[1,0,1] neg_lo:[0,1,0] neg_hi:[0,1,0]
  v_pk_mul_f32 v[56:57], v[56:57], v[136:137]
  v_pk_mul_f32 v[58:59], v[58:59], v[138:139]
  v_pk_mul_f32 v[56:57], v[56:57], v[6:7] op_sel:[0,0] op_sel_hi:[1,0]
  v_pk_mul_f32 v[58:59], v[58:59], v[6:7] op_sel:[0,0] op_sel_hi:[1,0]
  v_cvt_pk_bf16_f32 v120, v40, v41
  v_cvt_pk_bf16_f32 v121, v42, v43
  v_cvt_pk_bf16_f32 v122, v56, v57
  v_cvt_pk_bf16_f32 v123, v58, v59
  s_add_u32 s75, s70, 196608
  buffer_store_dwordx4 v[120:123], v12, s[16:19], s75 offen sc1
  v_pk_fma_f32 v[44:45], v[14:15], v[10:11], v[44:45] op_sel:[0,1,0] op_sel_hi:[1,1,1] neg_lo:[0,1,0] neg_hi:[0,1,0]
  v_pk_fma_f32 v[124:125], v[18:19], v[10:11], v[124:125] op_sel:[0,1,0] op_sel_hi:[1,1,1] neg_lo:[0,1,0] neg_hi:[0,1,0]
  v_pk_fma_f32 v[46:47], v[16:17], v[10:11], v[46:47] op_sel:[0,1,0] op_sel_hi:[1,1,1] neg_lo:[0,1,0] neg_hi:[0,1,0]
  v_pk_fma_f32 v[126:127], v[20:21], v[10:11], v[126:127] op_sel:[0,1,0] op_sel_hi:[1,1,1] neg_lo:[0,1,0] neg_hi:[0,1,0]
  v_pk_mul_f32 v[44:45], v[44:45], v[124:125]
  v_pk_mul_f32 v[46:47], v[46:47], v[126:127]
  v_pk_mul_f32 v[44:45], v[44:45], v[6:7] op_sel:[0,1] op_sel_hi:[1,1]
  v_pk_mul_f32 v[46:47], v[46:47], v[6:7] op_sel:[0,1] op_sel_hi:[1,1]
  v_pk_fma_f32 v[60:61], v[22:23], v[10:11], v[60:61] op_sel:[0,1,0] op_sel_hi:[1,1,1] neg_lo:[0,1,0] neg_hi:[0,1,0]
  v_pk_fma_f32 v[140:141], v[26:27], v[10:11], v[140:141] op_sel:[0,1,0] op_sel_hi:[1,1,1] neg_lo:[0,1,0] neg_hi:[0,1,0]
  v_pk_fma_f32 v[62:63], v[24:25], v[10:11], v[62:63] op_sel:[0,1,0] op_sel_hi:[1,1,1] neg_lo:[0,1,0] neg_hi:[0,1,0]
  v_pk_fma_f32 v[142:143], v[28:29], v[10:11], v[142:143] op_sel:[0,1,0] op_sel_hi:[1,1,1] neg_lo:[0,1,0] neg_hi:[0,1,0]
  v_pk_mul_f32 v[60:61], v[60:61], v[140:141]
  v_pk_mul_f32 v[62:63], v[62:63], v[142:143]
  v_pk_mul_f32 v[60:61], v[60:61], v[6:7] op_sel:[0,1] op_sel_hi:[1,1]
  v_pk_mul_f32 v[62:63], v[62:63], v[6:7] op_sel:[0,1] op_sel_hi:[1,1]
  v_cvt_pk_bf16_f32 v124, v44, v45
  v_cvt_pk_bf16_f32 v125, v46, v47
  v_cvt_pk_bf16_f32 v126, v60, v61
  v_cvt_pk_bf16_f32 v127, v62, v63
  s_add_u32 s75, s70, 294912
  buffer_store_dwordx4 v[124:127], v12, s[16:19], s75 offen sc1
  ds_read_b128 v[14:17], v3 offset:128
  ds_read_b128 v[18:21], v3 offset:448
  ds_read_b128 v[22:25], v3 offset:192
  ds_read_b128 v[26:29], v3 offset:512
  s_waitcnt lgkmcnt(0)
  v_pk_fma_f32 v[64:65], v[14:15], v[8:9], v[64:65] op_sel:[0,0,0] op_sel_hi:[1,0,1] neg_lo:[0,1,0] neg_hi:[0,1,0]
  v_pk_fma_f32 v[144:145], v[18:19], v[8:9], v[144:145] op_sel:[0,0,0] op_sel_hi:[1,0,1] neg_lo:[0,1,0] neg_hi:[0,1,0]
  v_pk_fma_f32 v[66:67], v[16:17], v[8:9], v[66:67] op_sel:[0,0,0] op_sel_hi:[1,0,1] neg_lo:[0,1,0] neg_hi:[0,1,0]
  v_pk_fma_f32 v[146:147], v[20:21], v[8:9], v[146:147] op_sel:[0,0,0] op_sel_hi:[1,0,1] neg_lo:[0,1,0] neg_hi:[0,1,0]
  v_pk_mul_f32 v[64:65], v[64:65], v[144:145]
  v_pk_mul_f32 v[66:67], v[66:67], v[146:147]
  v_pk_mul_f32 v[64:65], v[64:65], v[4:5] op_sel:[0,0] op_sel_hi:[1,0]
  v_pk_mul_f32 v[66:67], v[66:67], v[4:5] op_sel:[0,0] op_sel_hi:[1,0]
  v_pk_fma_f32 v[80:81], v[22:23], v[8:9], v[80:81] op_sel:[0,0,0] op_sel_hi:[1,0,1] neg_lo:[0,1,0] neg_hi:[0,1,0]
  v_pk_fma_f32 v[160:161], v[26:27], v[8:9], v[160:161] op_sel:[0,0,0] op_sel_hi:[1,0,1] neg_lo:[0,1,0] neg_hi:[0,1,0]
  v_pk_fma_f32 v[82:83], v[24:25], v[8:9], v[82:83] op_sel:[0,0,0] op_sel_hi:[1,0,1] neg_lo:[0,1,0] neg_hi:[0,1,0]
  v_pk_fma_f32 v[162:163], v[28:29], v[8:9], v[162:163] op_sel:[0,0,0] op_sel_hi:[1,0,1] neg_lo:[0,1,0] neg_hi:[0,1,0]
  v_pk_mul_f32 v[80:81], v[80:81], v[160:161]
  v_pk_mul_f32 v[82:83], v[82:83], v[162:163]
  v_pk_mul_f32 v[80:81], v[80:81], v[4:5] op_sel:[0,0] op_sel_hi:[1,0]
  v_pk_mul_f32 v[82:83], v[82:83], v[4:5] op_sel:[0,0] op_sel_hi:[1,0]
  v_cvt_pk_bf16_f32 v144, v64, v65
  v_cvt_pk_bf16_f32 v145, v66, v67
  v_cvt_pk_bf16_f32 v146, v80, v81
  v_cvt_pk_bf16_f32 v147, v82, v83
  s_add_u32 s75, s71, 0
  buffer_store_dwordx4 v[144:147], v12, s[16:19], s75 offen sc1
  v_pk_fma_f32 v[68:69], v[14:15], v[8:9], v[68:69] op_sel:[0,1,0] op_sel_hi:[1,1,1] neg_lo:[0,1,0] neg_hi:[0,1,0]
  v_pk_fma_f32 v[148:149], v[18:19], v[8:9], v[148:149] op_sel:[0,1,0] op_sel_hi:[1,1,1] neg_lo:[0,1,0] neg_hi:[0,1,0]
  v_pk_fma_f32 v[70:71], v[16:17], v[8:9], v[70:71] op_sel:[0,1,0] op_sel_hi:[1,1,1] neg_lo:[0,1,0] neg_hi:[0,1,0]
  v_pk_fma_f32 v[150:151], v[20:21], v[8:9], v[150:151] op_sel:[0,1,0] op_sel_hi:[1,1,1] neg_lo:[0,1,0] neg_hi:[0,1,0]
  v_pk_mul_f32 v[68:69], v[68:69], v[148:149]
  v_pk_mul_f32 v[70:71], v[70:71], v[150:151]
  v_pk_mul_f32 v[68:69], v[68:69], v[4:5] op_sel:[0,1] op_sel_hi:[1,1]
  v_pk_mul_f32 v[70:71], v[70:71], v[4:5] op_sel:[0,1] op_sel_hi:[1,1]
  v_pk_fma_f32 v[84:85], v[22:23], v[8:9], v[84:85] op_sel:[0,1,0] op_sel_hi:[1,1,1] neg_lo:[0,1,0] neg_hi:[0,1,0]
  v_pk_fma_f32 v[164:165], v[26:27], v[8:9], v[164:165] op_sel:[0,1,0] op_sel_hi:[1,1,1] neg_lo:[0,1,0] neg_hi:[0,1,0]
  v_pk_fma_f32 v[86:87], v[24:25], v[8:9], v[86:87] op_sel:[0,1,0] op_sel_hi:[1,1,1] neg_lo:[0,1,0] neg_hi:[0,1,0]
  v_pk_fma_f32 v[166:167], v[28:29], v[8:9], v[166:167] op_sel:[0,1,0] op_sel_hi:[1,1,1] neg_lo:[0,1,0] neg_hi:[0,1,0]
  v_pk_mul_f32 v[84:85], v[84:85], v[164:165]
  v_pk_mul_f32 v[86:87], v[86:87], v[166:167]
  v_pk_mul_f32 v[84:85], v[84:85], v[4:5] op_sel:[0,1] op_sel_hi:[1,1]
  v_pk_mul_f32 v[86:87], v[86:87], v[4:5] op_sel:[0,1] op_sel_hi:[1,1]
  v_cvt_pk_bf16_f32 v148, v68, v69
  v_cvt_pk_bf16_f32 v149, v70, v71
  v_cvt_pk_bf16_f32 v150, v84, v85
  v_cvt_pk_bf16_f32 v151, v86, v87
  s_add_u32 s75, s71, 98304
  buffer_store_dwordx4 v[148:151], v12, s[16:19], s75 offen sc1
  v_pk_fma_f32 v[72:73], v[14:15], v[10:11], v[72:73] op_sel:[0,0,0] op_sel_hi:[1,0,1] neg_lo:[0,1,0] neg_hi:[0,1,0]
  v_pk_fma_f32 v[152:153], v[18:19], v[10:11], v[152:153] op_sel:[0,0,0] op_sel_hi:[1,0,1] neg_lo:[0,1,0] neg_hi:[0,1,0]
  v_pk_fma_f32 v[74:75], v[16:17], v[10:11], v[74:75] op_sel:[0,0,0] op_sel_hi:[1,0,1] neg_lo:[0,1,0] neg_hi:[0,1,0]
  v_pk_fma_f32 v[154:155], v[20:21], v[10:11], v[154:155] op_sel:[0,0,0] op_sel_hi:[1,0,1] neg_lo:[0,1,0] neg_hi:[0,1,0]
  v_pk_mul_f32 v[72:73], v[72:73], v[152:153]
  v_pk_mul_f32 v[74:75], v[74:75], v[154:155]
  v_pk_mul_f32 v[72:73], v[72:73], v[6:7] op_sel:[0,0] op_sel_hi:[1,0]
  v_pk_mul_f32 v[74:75], v[74:75], v[6:7] op_sel:[0,0] op_sel_hi:[1,0]
  v_pk_fma_f32 v[88:89], v[22:23], v[10:11], v[88:89] op_sel:[0,0,0] op_sel_hi:[1,0,1] neg_lo:[0,1,0] neg_hi:[0,1,0]
  v_pk_fma_f32 v[168:169], v[26:27], v[10:11], v[168:169] op_sel:[0,0,0] op_sel_hi:[1,0,1] neg_lo:[0,1,0] neg_hi:[0,1,0]
  v_pk_fma_f32 v[90:91], v[24:25], v[10:11], v[90:91] op_sel:[0,0,0] op_sel_hi:[1,0,1] neg_lo:[0,1,0] neg_hi:[0,1,0]
  v_pk_fma_f32 v[170:171], v[28:29], v[10:11], v[170:171] op_sel:[0,0,0] op_sel_hi:[1,0,1] neg_lo:[0,1,0] neg_hi:[0,1,0]
  v_pk_mul_f32 v[88:89], v[88:89], v[168:169]
  v_pk_mul_f32 v[90:91], v[90:91], v[170:171]
  v_pk_mul_f32 v[88:89], v[88:89], v[6:7] op_sel:[0,0] op_sel_hi:[1,0]
  v_pk_mul_f32 v[90:91], v[90:91], v[6:7] op_sel:[0,0] op_sel_hi:[1,0]
  v_cvt_pk_bf16_f32 v152, v72, v73
  v_cvt_pk_bf16_f32 v153, v74, v75
  v_cvt_pk_bf16_f32 v154, v88, v89
  v_cvt_pk_bf16_f32 v155, v90, v91
  s_add_u32 s75, s71, 196608
  buffer_store_dwordx4 v[152:155], v12, s[16:19], s75 offen sc1
  v_pk_fma_f32 v[76:77], v[14:15], v[10:11], v[76:77] op_sel:[0,1,0] op_sel_hi:[1,1,1] neg_lo:[0,1,0] neg_hi:[0,1,0]
  v_pk_fma_f32 v[156:157], v[18:19], v[10:11], v[156:157] op_sel:[0,1,0] op_sel_hi:[1,1,1] neg_lo:[0,1,0] neg_hi:[0,1,0]
  v_pk_fma_f32 v[78:79], v[16:17], v[10:11], v[78:79] op_sel:[0,1,0] op_sel_hi:[1,1,1] neg_lo:[0,1,0] neg_hi:[0,1,0]
  v_pk_fma_f32 v[158:159], v[20:21], v[10:11], v[158:159] op_sel:[0,1,0] op_sel_hi:[1,1,1] neg_lo:[0,1,0] neg_hi:[0,1,0]
  v_pk_mul_f32 v[76:77], v[76:77], v[156:157]
  v_pk_mul_f32 v[78:79], v[78:79], v[158:159]
  v_pk_mul_f32 v[76:77], v[76:77], v[6:7] op_sel:[0,1] op_sel_hi:[1,1]
  v_pk_mul_f32 v[78:79], v[78:79], v[6:7] op_sel:[0,1] op_sel_hi:[1,1]
  v_pk_fma_f32 v[92:93], v[22:23], v[10:11], v[92:93] op_sel:[0,1,0] op_sel_hi:[1,1,1] neg_lo:[0,1,0] neg_hi:[0,1,0]
  v_pk_fma_f32 v[172:173], v[26:27], v[10:11], v[172:173] op_sel:[0,1,0] op_sel_hi:[1,1,1] neg_lo:[0,1,0] neg_hi:[0,1,0]
  v_pk_fma_f32 v[94:95], v[24:25], v[10:11], v[94:95] op_sel:[0,1,0] op_sel_hi:[1,1,1] neg_lo:[0,1,0] neg_hi:[0,1,0]
  v_pk_fma_f32 v[174:175], v[28:29], v[10:11], v[174:175] op_sel:[0,1,0] op_sel_hi:[1,1,1] neg_lo:[0,1,0] neg_hi:[0,1,0]
  v_pk_mul_f32 v[92:93], v[92:93], v[172:173]
  v_pk_mul_f32 v[94:95], v[94:95], v[174:175]
  v_pk_mul_f32 v[92:93], v[92:93], v[6:7] op_sel:[0,1] op_sel_hi:[1,1]
  v_pk_mul_f32 v[94:95], v[94:95], v[6:7] op_sel:[0,1] op_sel_hi:[1,1]
  v_cvt_pk_bf16_f32 v156, v76, v77
  v_cvt_pk_bf16_f32 v157, v78, v79
  v_cvt_pk_bf16_f32 v158, v92, v93
  v_cvt_pk_bf16_f32 v159, v94, v95
  s_add_u32 s75, s71, 294912
  buffer_store_dwordx4 v[156:159], v12, s[16:19], s75 offen sc1
  s_branch K1_CFLAG
K1_GLU_ODD:
  ds_read_b128 v[14:17], v3 offset:0
  ds_read_b128 v[18:21], v3 offset:320
  s_waitcnt lgkmcnt(0)
  v_pk_fma_f32 v[32:33], v[14:15], v[8:9], v[32:33] op_sel:[0,0,0] op_sel_hi:[1,0,1] neg_lo:[0,1,0] neg_hi:[0,1,0]
  v_pk_fma_f32 v[112:113], v[18:19], v[8:9], v[112:113] op_sel:[0,0,0] op_sel_hi:[1,0,1] neg_lo:[0,1,0] neg_hi:[0,1,0]
  v_pk_fma_f32 v[34:35], v[16:17], v[8:9], v[34:35] op_sel:[0,0,0] op_sel_hi:[1,0,1] neg_lo:[0,1,0] neg_hi:[0,1,0]
  v_pk_fma_f32 v[114:115], v[20:21], v[8:9], v[114:115] op_sel:[0,0,0] op_sel_hi:[1,0,1] neg_lo:[0,1,0] neg_hi:[0,1,0]
  v_pk_mul_f32 v[32:33], v[32:33], v[112:113]
  v_pk_mul_f32 v[34:35], v[34:35], v[114:115]
  v_pk_mul_f32 v[32:33], v[32:33], v[4:5] op_sel:[0,0] op_sel_hi:[1,0]
  v_pk_mul_f32 v[34:35], v[34:35], v[4:5] op_sel:[0,0] op_sel_hi:[1,0]
  v_cvt_pk_bf16_f32 v112, v32, v33
  v_cvt_pk_bf16_f32 v113, v34, v35
  v_pk_fma_f32 v[36:37], v[14:15], v[8:9], v[36:37] op_sel:[0,1,0] op_sel_hi:[1,1,1] neg_lo:[0,1,0] neg_hi:[0,1,0]
  v_pk_fma_f32 v[116:117], v[18:19], v[8:9], v[116:117] op_sel:[0,1,0] op_sel_hi:[1,1,1] neg_lo:[0,1,0] neg_hi:[0,1,0]
  v_pk_fma_f32 v[38:39], v[16:17], v[8:9], v[38:39] op_sel:[0,1,0] op_sel_hi:[1,1,1] neg_lo:[0,1,0] neg_hi:[0,1,0]
  v_pk_fma_f32 v[118:119], v[20:21], v[8:9], v[118:119] op_sel:[0,1,0] op_sel_hi:[1,1,1] neg_lo:[0,1,0] neg_hi:[0,1,0]
  v_pk_mul_f32 v[36:37], v[36:37], v[116:117]
  v_pk_mul_f32 v[38:39], v[38:39], v[118:119]
  v_pk_mul_f32 v[36:37], v[36:37], v[4:5] op_sel:[0,1] op_sel_hi:[1,1]
  v_pk_mul_f32 v[38:39], v[38:39], v[4:5] op_sel:[0,1] op_sel_hi:[1,1]
  v_cvt_pk_bf16_f32 v114, v36, v37
  v_cvt_pk_bf16_f32 v115, v38, v39
  s_add_u32 s75, s72, 0
  buffer_store_dwordx4 v[112:115], v12, s[16:19], s75 offen sc1
  v_pk_fma_f32 v[40:41], v[14:15], v[10:11], v[40:41] op_sel:[0,0,0] op_sel_hi:[1,0,1] neg_lo:[0,1,0] neg_hi:[0,1,0]
  v_pk_fma_f32 v[120:121], v[18:19], v[10:11], v[120:121] op_sel:[0,0,0] op_sel_hi:[1,0,1] neg_lo:[0,1,0] neg_hi:[0,1,0]
  v_pk_fma_f32 v[42:43], v[16:17], v[10:11], v[42:43] op_sel:[0,0,0] op_sel_hi:[1,0,1] neg_lo:[0,1,0] neg_hi:[0,1,0]
  v_pk_fma_f32 v[122:123], v[20:21], v[10:11], v[122:123] op_sel:[0,0,0] op_sel_hi:[1,0,1] neg_lo:[0,1,0] neg_hi:[0,1,0]
  v_pk_mul_f32 v[40:41], v[40:41], v[120:121]
  v_pk_mul_f32 v[42:43], v[42:43], v[122:123]
  v_pk_mul_f32 v[40:41], v[40:41], v[6:7] op_sel:[0,0] op_sel_hi:[1,0]
  v_pk_mul_f32 v[42:43], v[42:43], v[6:7] op_sel:[0,0] op_sel_hi:[1,0]
  v_cvt_pk_bf16_f32 v120, v40, v41
  v_cvt_pk_bf16_f32 v121, v42, v43
  v_pk_fma_f32 v[44:45], v[14:15], v[10:11], v[44:45] op_sel:[0,1,0] op_sel_hi:[1,1,1] neg_lo:[0,1,0] neg_hi:[0,1,0]
  v_pk_fma_f32 v[124:125], v[18:19], v[10:11], v[124:125] op_sel:[0,1,0] op_sel_hi:[1,1,1] neg_lo:[0,1,0] neg_hi:[0,1,0]
  v_pk_fma_f32 v[46:47], v[16:17], v[10:11], v[46:47] op_sel:[0,1,0] op_sel_hi:[1,1,1] neg_lo:[0,1,0] neg_hi:[0,1,0]
  v_pk_fma_f32 v[126:127], v[20:21], v[10:11], v[126:127] op_sel:[0,1,0] op_sel_hi:[1,1,1] neg_lo:[0,1,0] neg_hi:[0,1,0]
  v_pk_mul_f32 v[44:45], v[44:45], v[124:125]
  v_pk_mul_f32 v[46:47], v[46:47], v[126:127]
  v_pk_mul_f32 v[44:45], v[44:45], v[6:7] op_sel:[0,1] op_sel_hi:[1,1]
  v_pk_mul_f32 v[46:47], v[46:47], v[6:7] op_sel:[0,1] op_sel_hi:[1,1]
  v_cvt_pk_bf16_f32 v122, v44, v45
  v_cvt_pk_bf16_f32 v123, v46, v47
  s_add_u32 s75, s72, 196608
  buffer_store_dwordx4 v[120:123], v12, s[16:19], s75 offen sc1
  ds_read_b128 v[14:17], v3 offset:64
  ds_read_b128 v[18:21], v3 offset:384
  ds_read_b128 v[22:25], v3 offset:128
  ds_read_b128 v[26:29], v3 offset:448
  s_waitcnt lgkmcnt(0)
  v_pk_fma_f32 v[48:49], v[14:15], v[8:9], v[48:49] op_sel:[0,0,0] op_sel_hi:[1,0,1] neg_lo:[0,1,0] neg_hi:[0,1,0]
  v_pk_fma_f32 v[128:129], v[18:19], v[8:9], v[128:129] op_sel:[0,0,0] op_sel_hi:[1,0,1] neg_lo:[0,1,0] neg_hi:[0,1,0]
  v_pk_fma_f32 v[50:51], v[16:17], v[8:9], v[50:51] op_sel:[0,0,0] op_sel_hi:[1,0,1] neg_lo:[0,1,0] neg_hi:[0,1,0]
  v_pk_fma_f32 v[130:131], v[20:21], v[8:9], v[130:131] op_sel:[0,0,0] op_sel_hi:[1,0,1] neg_lo:[0,1,0] neg_hi:[0,1,0]
  v_pk_mul_f32 v[48:49], v[48:49], v[128:129]
  v_pk_mul_f32 v[50:51], v[50:51], v[130:131]
  v_pk_mul_f32 v[48:49], v[48:49], v[4:5] op_sel:[0,0] op_sel_hi:[1,0]
  v_pk_mul_f32 v[50:51], v[50:51], v[4:5] op_sel:[0,0] op_sel_hi:[1,0]
  v_pk_fma_f32 v[64:65], v[22:23], v[8:9], v[64:65] op_sel:[0,0,0] op_sel_hi:[1,0,1] neg_lo:[0,1,0] neg_hi:[0,1,0]
  v_pk_fma_f32 v[144:145], v[26:27], v[8:9], v[144:145] op_sel:[0,0,0] op_sel_hi:[1,0,1] neg_lo:[0,1,0] neg_hi:[0,1,0]
  v_pk_fma_f32 v[66:67], v[24:25], v[8:9], v[66:67] op_sel:[0,0,0] op_sel_hi:[1,0,1] neg_lo:[0,1,0] neg_hi:[0,1,0]
  v_pk_fma_f32 v[146:147], v[28:29], v[8:9], v[146:147] op_sel:[0,0,0] op_sel_hi:[1,0,1] neg_lo:[0,1,0] neg_hi:[0,1,0]
  v_pk_mul_f32 v[64:65], v[64:65], v[144:145]
  v_pk_mul_f32 v[66:67], v[66:67], v[146:147]
  v_pk_mul_f32 v[64:65], v[64:65], v[4:5] op_sel:[0,0] op_sel_hi:[1,0]
  v_pk_mul_f32 v[66:67], v[66:67], v[4:5] op_sel:[0,0] op_sel_hi:[1,0]
  v_cvt_pk_bf16_f32 v128, v48, v49
  v_cvt_pk_bf16_f32 v129, v50, v51
  v_cvt_pk_bf16_f32 v130, v64, v65
  v_cvt_pk_bf16_f32 v131, v66, v67
  s_add_u32 s75, s70, 0
  buffer_store_dwordx4 v[128:131], v12, s[16:19], s75 offen sc1
  v_pk_fma_f32 v[52:53], v[14:15], v[8:9], v[52:53] op_sel:[0,1,0] op_sel_hi:[1,1,1] neg_lo:[0,1,0] neg_hi:[0,1,0]
  v_pk_fma_f32 v[132:133], v[18:19], v[8:9], v[132:133] op_sel:[0,1,0] op_sel_hi:[1,1,1] neg_lo:[0,1,0] neg_hi:[0,1,0]
  v_pk_fma_f32 v[54:55], v[16:17], v[8:9], v[54:55] op_sel:[0,1,0] op_sel_hi:[1,1,1] neg_lo:[0,1,0] neg_hi:[0,1,0]
  v_pk_fma_f32 v[134:135], v[20:21], v[8:9], v[134:135] op_sel:[0,1,0] op_sel_hi:[1,1,1] neg_lo:[0,1,0] neg_hi:[0,1,0]
  v_pk_mul_f32 v[52:53], v[52:53], v[132:133]
  v_pk_mul_f32 v[54:55], v[54:55], v[134:135]
  v_pk_mul_f32 v[52:53], v[52:53], v[4:5] op_sel:[0,1] op_sel_hi:[1,1]
  v_pk_mul_f32 v[54:55], v[54:55], v[4:5] op_sel:[0,1] op_sel_hi:[1,1]
  v_pk_fma_f32 v[68:69], v[22:23], v[8:9], v[68:69] op_sel:[0,1,0] op_sel_hi:[1,1,1] neg_lo:[0,1,0] neg_hi:[0,1,0]
  v_pk_fma_f32 v[148:149], v[26:27], v[8:9], v[148:149] op_sel:[0,1,0] op_sel_hi:[1,1,1] neg_lo:[0,1,0] neg_hi:[0,1,0]
  v_pk_fma_f32 v[70:71], v[24:25], v[8:9], v[70:71] op_sel:[0,1,0] op_sel_hi:[1,1,1] neg_lo:[0,1,0] neg_hi:[0,1,0]
  v_pk_fma_f32 v[150:151], v[28:29], v[8:9], v[150:151] op_sel:[0,1,0] op_sel_hi:[1,1,1] neg_lo:[0,1,0] neg_hi:[0,1,0]
  v_pk_mul_f32 v[68:69], v[68:69], v[148:149]
  v_pk_mul_f32 v[70:71], v[70:71], v[150:151]
  v_pk_mul_f32 v[68:69], v[68:69], v[4:5] op_sel:[0,1] op_sel_hi:[1,1]
  v_pk_mul_f32 v[70:71], v[70:71], v[4:5] op_sel:[0,1] op_sel_hi:[1,1]
  v_cvt_pk_bf16_f32 v132, v52, v53
  v_cvt_pk_bf16_f32 v133, v54, v55
  v_cvt_pk_bf16_f32 v134, v68, v69
  v_cvt_pk_bf16_f32 v135, v70, v71
  s_add_u32 s75, s70, 98304
  buffer_store_dwordx4 v[132:135], v12, s[16:19], s75 offen sc1
  v_pk_fma_f32 v[56:57], v[14:15], v[10:11], v[56:57] op_sel:[0,0,0] op_sel_hi:[1,0,1] neg_lo:[0,1,0] neg_hi:[0,1,0]
  v_pk_fma_f32 v[136:137], v[18:19], v[10:11], v[136:137] op_sel:[0,0,0] op_sel_hi:[1,0,1] neg_lo:[0,1,0] neg_hi:[0,1,0]
  v_pk_fma_f32 v[58:59], v[16:17], v[10:11], v[58:59] op_sel:[0,0,0] op_sel_hi:[1,0,1] neg_lo:[0,1,0] neg_hi:[0,1,0]
  v_pk_fma_f32 v[138:139], v[20:21], v[10:11], v[138:139] op_sel:[0,0,0] op_sel_hi:[1,0,1] neg_lo:[0,1,0] neg_hi:[0,1,0]
  v_pk_mul_f32 v[56:57], v[56:57], v[136:137]
  v_pk_mul_f32 v[58:59], v[58:59], v[138:139]
  v_pk_mul_f32 v[56:57], v[56:57], v[6:7] op_sel:[0,0] op_sel_hi:[1,0]
  v_pk_mul_f32 v[58:59], v[58:59], v[6:7] op_sel:[0,0] op_sel_hi:[1,0]
  v_pk_fma_f32 v[72:73], v[22:23], v[10:11], v[72:73] op_sel:[0,0,0] op_sel_hi:[1,0,1] neg_lo:[0,1,0] neg_hi:[0,1,0]
  v_pk_fma_f32 v[152:153], v[26:27], v[10:11], v[152:153] op_sel:[0,0,0] op_sel_hi:[1,0,1] neg_lo:[0,1,0] neg_hi:[0,1,0]
  v_pk_fma_f32 v[74:75], v[24:25], v[10:11], v[74:75] op_sel:[0,0,0] op_sel_hi:[1,0,1] neg_lo:[0,1,0] neg_hi:[0,1,0]
  v_pk_fma_f32 v[154:155], v[28:29], v[10:11], v[154:155] op_sel:[0,0,0] op_sel_hi:[1,0,1] neg_lo:[0,1,0] neg_hi:[0,1,0]
  v_pk_mul_f32 v[72:73], v[72:73], v[152:153]
  v_pk_mul_f32 v[74:75], v[74:75], v[154:155]
  v_pk_mul_f32 v[72:73], v[72:73], v[6:7] op_sel:[0,0] op_sel_hi:[1,0]
  v_pk_mul_f32 v[74:75], v[74:75], v[6:7] op_sel:[0,0] op_sel_hi:[1,0]
  v_cvt_pk_bf16_f32 v136, v56, v57
  v_cvt_pk_bf16_f32 v137, v58, v59
  v_cvt_pk_bf16_f32 v138, v72, v73
  v_cvt_pk_bf16_f32 v139, v74, v75
  s_add_u32 s75, s70, 196608
  buffer_store_dwordx4 v[136:139], v12, s[16:19], s75 offen sc1
  v_pk_fma_f32 v[60:61], v[14:15], v[10:11], v[60:61] op_sel:[0,1,0] op_sel_hi:[1,1,1] neg_lo:[0,1,0] neg_hi:[0,1,0]
  v_pk_fma_f32 v[140:141], v[18:19], v[10:11], v[140:141] op_sel:[0,1,0] op_sel_hi:[1,1,1] neg_lo:[0,1,0] neg_hi:[0,1,0]
  v_pk_fma_f32 v[62:63], v[16:17], v[10:11], v[62:63] op_sel:[0,1,0] op_sel_hi:[1,1,1] neg_lo:[0,1,0] neg_hi:[0,1,0]
  v_pk_fma_f32 v[142:143], v[20:21], v[10:11], v[142:143] op_sel:[0,1,0] op_sel_hi:[1,1,1] neg_lo:[0,1,0] neg_hi:[0,1,0]
  v_pk_mul_f32 v[60:61], v[60:61], v[140:141]
  v_pk_mul_f32 v[62:63], v[62:63], v[142:143]
  v_pk_mul_f32 v[60:61], v[60:61], v[6:7] op_sel:[0,1] op_sel_hi:[1,1]
  v_pk_mul_f32 v[62:63], v[62:63], v[6:7] op_sel:[0,1] op_sel_hi:[1,1]
  v_pk_fma_f32 v[76:77], v[22:23], v[10:11], v[76:77] op_sel:[0,1,0] op_sel_hi:[1,1,1] neg_lo:[0,1,0] neg_hi:[0,1,0]
  v_pk_fma_f32 v[156:157], v[26:27], v[10:11], v[156:157] op_sel:[0,1,0] op_sel_hi:[1,1,1] neg_lo:[0,1,0] neg_hi:[0,1,0]
  v_pk_fma_f32 v[78:79], v[24:25], v[10:11], v[78:79] op_sel:[0,1,0] op_sel_hi:[1,1,1] neg_lo:[0,1,0] neg_hi:[0,1,0]
  v_pk_fma_f32 v[158:159], v[28:29], v[10:11], v[158:159] op_sel:[0,1,0] op_sel_hi:[1,1,1] neg_lo:[0,1,0] neg_hi:[0,1,0]
  v_pk_mul_f32 v[76:77], v[76:77], v[156:157]
  v_pk_mul_f32 v[78:79], v[78:79], v[158:159]
  v_pk_mul_f32 v[76:77], v[76:77], v[6:7] op_sel:[0,1] op_sel_hi:[1,1]
  v_pk_mul_f32 v[78:79], v[78:79], v[6:7] op_sel:[0,1] op_sel_hi:[1,1]
  v_cvt_pk_bf16_f32 v140, v60, v61
  v_cvt_pk_bf16_f32 v141, v62, v63
  v_cvt_pk_bf16_f32 v142, v76, v77
  v_cvt_pk_bf16_f32 v143, v78, v79
  s_add_u32 s75, s70, 294912
  buffer_store_dwordx4 v[140:143], v12, s[16:19], s75 offen sc1
  ds_read_b128 v[14:17], v3 offset:192
  ds_read_b128 v[18:21], v3 offset:512
  ds_read_b128 v[22:25], v3 offset:256
  ds_read_b128 v[26:29], v3 offset:576
  s_waitcnt lgkmcnt(0)
  v_pk_fma_f32 v[80:81], v[14:15], v[8:9], v[80:81] op_sel:[0,0,0] op_sel_hi:[1,0,1] neg_lo:[0,1,0] neg_hi:[0,1,0]
  v_pk_fma_f32 v[160:161], v[18:19], v[8:9], v[160:161] op_sel:[0,0,0] op_sel_hi:[1,0,1] neg_lo:[0,1,0] neg_hi:[0,1,0]
  v_pk_fma_f32 v[82:83], v[16:17], v[8:9], v[82:83] op_sel:[0,0,0] op_sel_hi:[1,0,1] neg_lo:[0,1,0] neg_hi:[0,1,0]
  v_pk_fma_f32 v[162:163], v[20:21], v[8:9], v[162:163] op_sel:[0,0,0] op_sel_hi:[1,0,1] neg_lo:[0,1,0] neg_hi:[0,1,0]
  v_pk_mul_f32 v[80:81], v[80:81], v[160:161]
  v_pk_mul_f32 v[82:83], v[82:83], v[162:163]
  v_pk_mul_f32 v[80:81], v[80:81], v[4:5] op_sel:[0,0] op_sel_hi:[1,0]
  v_pk_mul_f32 v[82:83], v[82:83], v[4:5] op_sel:[0,0] op_sel_hi:[1,0]
  v_pk_fma_f32 v[96:97], v[22:23], v[8:9], v[96:97] op_sel:[0,0,0] op_sel_hi:[1,0,1] neg_lo:[0,1,0] neg_hi:[0,1,0]
  v_pk_fma_f32 v[176:177], v[26:27], v[8:9], v[176:177] op_sel:[0,0,0] op_sel_hi:[1,0,1] neg_lo:[0,1,0] neg_hi:[0,1,0]
  v_pk_fma_f32 v[98:99], v[24:25], v[8:9], v[98:99] op_sel:[0,0,0] op_sel_hi:[1,0,1] neg_lo:[0,1,0] neg_hi:[0,1,0]
  v_pk_fma_f32 v[178:179], v[28:29], v[8:9], v[178:179] op_sel:[0,0,0] op_sel_hi:[1,0,1] neg_lo:[0,1,0] neg_hi:[0,1,0]
  v_pk_mul_f32 v[96:97], v[96:97], v[176:177]
  v_pk_mul_f32 v[98:99], v[98:99], v[178:179]
  v_pk_mul_f32 v[96:97], v[96:97], v[4:5] op_sel:[0,0] op_sel_hi:[1,0]
  v_pk_mul_f32 v[98:99], v[98:99], v[4:5] op_sel:[0,0] op_sel_hi:[1,0]
  v_cvt_pk_bf16_f32 v160, v80, v81
  v_cvt_pk_bf16_f32 v161, v82, v83
  v_cvt_pk_bf16_f32 v162, v96, v97
  v_cvt_pk_bf16_f32 v163, v98, v99
  s_add_u32 s75, s71, 0
  buffer_store_dwordx4 v[160:163], v12, s[16:19], s75 offen sc1
  v_pk_fma_f32 v[84:85], v[14:15], v[8:9], v[84:85] op_sel:[0,1,0] op_sel_hi:[1,1,1] neg_lo:[0,1,0] neg_hi:[0,1,0]
  v_pk_fma_f32 v[164:165], v[18:19], v[8:9], v[164:165] op_sel:[0,1,0] op_sel_hi:[1,1,1] neg_lo:[0,1,0] neg_hi:[0,1,0]
  v_pk_fma_f32 v[86:87], v[16:17], v[8:9], v[86:87] op_sel:[0,1,0] op_sel_hi:[1,1,1] neg_lo:[0,1,0] neg_hi:[0,1,0]
  v_pk_fma_f32 v[166:167], v[20:21], v[8:9], v[166:167] op_sel:[0,1,0] op_sel_hi:[1,1,1] neg_lo:[0,1,0] neg_hi:[0,1,0]
  v_pk_mul_f32 v[84:85], v[84:85], v[164:165]
  v_pk_mul_f32 v[86:87], v[86:87], v[166:167]
  v_pk_mul_f32 v[84:85], v[84:85], v[4:5] op_sel:[0,1] op_sel_hi:[1,1]
  v_pk_mul_f32 v[86:87], v[86:87], v[4:5] op_sel:[0,1] op_sel_hi:[1,1]
  v_pk_fma_f32 v[100:101], v[22:23], v[8:9], v[100:101] op_sel:[0,1,0] op_sel_hi:[1,1,1] neg_lo:[0,1,0] neg_hi:[0,1,0]
  v_pk_fma_f32 v[180:181], v[26:27], v[8:9], v[180:181] op_sel:[0,1,0] op_sel_hi:[1,1,1] neg_lo:[0,1,0] neg_hi:[0,1,0]
  v_pk_fma_f32 v[102:103], v[24:25], v[8:9], v[102:103] op_sel:[0,1,0] op_sel_hi:[1,1,1] neg_lo:[0,1,0] neg_hi:[0,1,0]
  v_pk_fma_f32 v[182:183], v[28:29], v[8:9], v[182:183] op_sel:[0,1,0] op_sel_hi:[1,1,1] neg_lo:[0,1,0] neg_hi:[0,1,0]
  v_pk_mul_f32 v[100:101], v[100:101], v[180:181]
  v_pk_mul_f32 v[102:103], v[102:103], v[182:183]
  v_pk_mul_f32 v[100:101], v[100:101], v[4:5] op_sel:[0,1] op_sel_hi:[1,1]
  v_pk_mul_f32 v[102:103], v[102:103], v[4:5] op_sel:[0,1] op_sel_hi:[1,1]
  v_cvt_pk_bf16_f32 v164, v84, v85
  v_cvt_pk_bf16_f32 v165, v86, v87
  v_cvt_pk_bf16_f32 v166, v100, v101
  v_cvt_pk_bf16_f32 v167, v102, v103
  s_add_u32 s75, s71, 98304
  buffer_store_dwordx4 v[164:167], v12, s[16:19], s75 offen sc1
  v_pk_fma_f32 v[88:89], v[14:15], v[10:11], v[88:89] op_sel:[0,0,0] op_sel_hi:[1,0,1] neg_lo:[0,1,0] neg_hi:[0,1,0]
  v_pk_fma_f32 v[168:169], v[18:19], v[10:11], v[168:169] op_sel:[0,0,0] op_sel_hi:[1,0,1] neg_lo:[0,1,0] neg_hi:[0,1,0]
  v_pk_fma_f32 v[90:91], v[16:17], v[10:11], v[90:91] op_sel:[0,0,0] op_sel_hi:[1,0,1] neg_lo:[0,1,0] neg_hi:[0,1,0]
  v_pk_fma_f32 v[170:171], v[20:21], v[10:11], v[170:171] op_sel:[0,0,0] op_sel_hi:[1,0,1] neg_lo:[0,1,0] neg_hi:[0,1,0]
  v_pk_mul_f32 v[88:89], v[88:89], v[168:169]
  v_pk_mul_f32 v[90:91], v[90:91], v[170:171]
  v_pk_mul_f32 v[88:89], v[88:89], v[6:7] op_sel:[0,0] op_sel_hi:[1,0]
  v_pk_mul_f32 v[90:91], v[90:91], v[6:7] op_sel:[0,0] op_sel_hi:[1,0]
  v_pk_fma_f32 v[104:105], v[22:23], v[10:11], v[104:105] op_sel:[0,0,0] op_sel_hi:[1,0,1] neg_lo:[0,1,0] neg_hi:[0,1,0]
  v_pk_fma_f32 v[184:185], v[26:27], v[10:11], v[184:185] op_sel:[0,0,0] op_sel_hi:[1,0,1] neg_lo:[0,1,0] neg_hi:[0,1,0]
  v_pk_fma_f32 v[106:107], v[24:25], v[10:11], v[106:107] op_sel:[0,0,0] op_sel_hi:[1,0,1] neg_lo:[0,1,0] neg_hi:[0,1,0]
  v_pk_fma_f32 v[186:187], v[28:29], v[10:11], v[186:187] op_sel:[0,0,0] op_sel_hi:[1,0,1] neg_lo:[0,1,0] neg_hi:[0,1,0]
  v_pk_mul_f32 v[104:105], v[104:105], v[184:185]
  v_pk_mul_f32 v[106:107], v[106:107], v[186:187]
  v_pk_mul_f32 v[104:105], v[104:105], v[6:7] op_sel:[0,0] op_sel_hi:[1,0]
  v_pk_mul_f32 v[106:107], v[106:107], v[6:7] op_sel:[0,0] op_sel_hi:[1,0]
  v_cvt_pk_bf16_f32 v168, v88, v89
  v_cvt_pk_bf16_f32 v169, v90, v91
  v_cvt_pk_bf16_f32 v170, v104, v105
  v_cvt_pk_bf16_f32 v171, v106, v107
  s_add_u32 s75, s71, 196608
  buffer_store_dwordx4 v[168:171], v12, s[16:19], s75 offen sc1
  v_pk_fma_f32 v[92:93], v[14:15], v[10:11], v[92:93] op_sel:[0,1,0] op_sel_hi:[1,1,1] neg_lo:[0,1,0] neg_hi:[0,1,0]
  v_pk_fma_f32 v[172:173], v[18:19], v[10:11], v[172:173] op_sel:[0,1,0] op_sel_hi:[1,1,1] neg_lo:[0,1,0] neg_hi:[0,1,0]
  v_pk_fma_f32 v[94:95], v[16:17], v[10:11], v[94:95] op_sel:[0,1,0] op_sel_hi:[1,1,1] neg_lo:[0,1,0] neg_hi:[0,1,0]
  v_pk_fma_f32 v[174:175], v[20:21], v[10:11], v[174:175] op_sel:[0,1,0] op_sel_hi:[1,1,1] neg_lo:[0,1,0] neg_hi:[0,1,0]
  v_pk_mul_f32 v[92:93], v[92:93], v[172:173]
  v_pk_mul_f32 v[94:95], v[94:95], v[174:175]
  v_pk_mul_f32 v[92:93], v[92:93], v[6:7] op_sel:[0,1] op_sel_hi:[1,1]
  v_pk_mul_f32 v[94:95], v[94:95], v[6:7] op_sel:[0,1] op_sel_hi:[1,1]
  v_pk_fma_f32 v[108:109], v[22:23], v[10:11], v[108:109] op_sel:[0,1,0] op_sel_hi:[1,1,1] neg_lo:[0,1,0] neg_hi:[0,1,0]
  v_pk_fma_f32 v[188:189], v[26:27], v[10:11], v[188:189] op_sel:[0,1,0] op_sel_hi:[1,1,1] neg_lo:[0,1,0] neg_hi:[0,1,0]
  v_pk_fma_f32 v[110:111], v[24:25], v[10:11], v[110:111] op_sel:[0,1,0] op_sel_hi:[1,1,1] neg_lo:[0,1,0] neg_hi:[0,1,0]
  v_pk_fma_f32 v[190:191], v[28:29], v[10:11], v[190:191] op_sel:[0,1,0] op_sel_hi:[1,1,1] neg_lo:[0,1,0] neg_hi:[0,1,0]
  v_pk_mul_f32 v[108:109], v[108:109], v[188:189]
  v_pk_mul_f32 v[110:111], v[110:111], v[190:191]
  v_pk_mul_f32 v[108:109], v[108:109], v[6:7] op_sel:[0,1] op_sel_hi:[1,1]
  v_pk_mul_f32 v[110:111], v[110:111], v[6:7] op_sel:[0,1] op_sel_hi:[1,1]
  v_cvt_pk_bf16_f32 v172, v92, v93
  v_cvt_pk_bf16_f32 v173, v94, v95
  v_cvt_pk_bf16_f32 v174, v108, v109
  v_cvt_pk_bf16_f32 v175, v110, v111
  s_add_u32 s75, s71, 294912
  buffer_store_dwordx4 v[172:175], v12, s[16:19], s75 offen sc1
K1_CFLAG:
  s_add_u32 s20, s4, 24510464
  s_addc_u32 s21, s5, 0
  s_mov_b32 s22, 16384
  s_mov_b32 s23, 0x20000
  s_lshl_b32 s66, s62, 2
  s_add_u32 s66, s66, s3
  s_lshl_b32 s66, s66, 8
  s_lshl_b32 s67, s35, 2
  s_add_u32 s66, s66, s67
  v_mov_b32 v2, 0
  v_mov_b32 v3, s95
  v_mov_b32 v4, 158720
  v_mov_b32 v5, 1
  s_mov_b64 exec, 1
  ds_add_u32 v4, v5 offset:28
  s_mov_b32 s47, 0
  s_mov_b32 s67, 0

  s_waitcnt vmcnt(0)
  buffer_store_dword v3, v2, s[20:23], s66 offen sc1
  ds_add_u32 v4, v5 offset:12
  s_mov_b64 exec, -1
  s_setprio 0

K1_CW:
  ds_read_b32 v6, v4 offset:12
  s_add_u32 s67, s67, 1
  s_waitcnt lgkmcnt(0)
  v_readfirstlane_b32 s66, v6
  s_and_b32 s66, s66, 15
  s_cmp_ge_u32 s66, 4
  s_cbranch_scc1 K1_P2
  s_cmp_ge_u32 s67, 1000000
  s_cbranch_scc1 K1_P2
  s_sleep 1
  s_branch K1_CW

K1_SSM:
  v_add_u32 v8, 98304, v10
  v_xor_b32 v9, 64, v8
  s_lshl_b32 s65, s63, 12
  s_add_u32 s64, s64, s65

  s_cmp_eq_u32 s3, 0
  s_cselect_b32 s12, s48, s50
  s_cselect_b32 s13, s49, s51
  s_mov_b32 s14, 819200
  s_mov_b32 s15, 0x20000
  s_mov_b32 s81, 128
  s_lshr_b32 s82, s61, 3
  s_lshl_b32 s82, s82, 4

  s_lshl_b32 s80, s63, 6
  s_add_u32 s80, s80, s82
  s_mul_i32 s80, s80, 1280
  v_mul_u32_u24 v14, 1280, v31
  s_mov_b32 s83, 16

  s_lshl_b32 s82, s62, 8
  s_and_b32 s84, s61, 7
  s_lshl_b32 s84, s84, 5
  s_add_u32 s82, s82, s84
  s_mul_i32 s82, s82, 1280
  v_mul_u32_u24 v15, 1280, v1
  s_cmp_eq_u32 s3, 2
  s_cselect_b32 s12, s8, s12
  s_cselect_b32 s13, s9, s13
  s_cselect_b32 s14, s10, s14
  s_cselect_b32 s80, s82, s80
  s_cselect_b32 s81, 128, s81
  s_cselect_b32 s83, 32, s83
  s_cselect_b64 vcc, -1, 0
  s_cmp_eq_u32 s3, 3
  s_cselect_b32 s83, 0, s83
  v_cndmask_b32 v14, v14, v15, vcc
  v_cmp_gt_u32 vcc, s83, v1
  v_mov_b32 v15, 0x40000000
  s_nop 0
  v_cndmask_b32 v14, v15, v14, vcc

  s_add_u32 s80, s80, s81
  s_add_u32 s80, s80, s81
  s_add_u32 s80, s80, s81
  buffer_load_dword v16, v14, s[12:15], s80 offen
  v_mov_b32 v32, 0
  v_mov_b32 v33, 0
  v_mov_b32 v34, 0
  v_mov_b32 v35, 0
  v_mov_b32 v36, 0
  v_mov_b32 v37, 0
  v_mov_b32 v38, 0
  v_mov_b32 v39, 0
  v_mov_b32 v40, 0
  v_mov_b32 v41, 0
  v_mov_b32 v42, 0
  v_mov_b32 v43, 0
  v_mov_b32 v44, 0
  v_mov_b32 v45, 0
  v_mov_b32 v46, 0
  v_mov_b32 v47, 0
  v_mov_b32 v48, 0
  v_mov_b32 v49, 0
  v_mov_b32 v50, 0
  v_mov_b32 v51, 0
  v_mov_b32 v52, 0
  v_mov_b32 v53, 0
  v_mov_b32 v54, 0
  v_mov_b32 v55, 0
  v_mov_b32 v56, 0
  v_mov_b32 v57, 0
  v_mov_b32 v58, 0
  v_mov_b32 v59, 0
  v_mov_b32 v60, 0
  v_mov_b32 v61, 0
  v_mov_b32 v62, 0
  v_mov_b32 v63, 0
  v_mov_b32 v64, 0
  v_mov_b32 v65, 0
  v_mov_b32 v66, 0
  v_mov_b32 v67, 0
  v_mov_b32 v68, 0
  v_mov_b32 v69, 0
  v_mov_b32 v70, 0
  v_mov_b32 v71, 0
  v_mov_b32 v72, 0
  v_mov_b32 v73, 0
  v_mov_b32 v74, 0
  v_mov_b32 v75, 0
  v_mov_b32 v76, 0
  v_mov_b32 v77, 0
  v_mov_b32 v78, 0
  v_mov_b32 v79, 0
  v_mov_b32 v80, 0
  v_mov_b32 v81, 0
  v_mov_b32 v82, 0
  v_mov_b32 v83, 0
  v_mov_b32 v84, 0
  v_mov_b32 v85, 0
  v_mov_b32 v86, 0
  v_mov_b32 v87, 0
  v_mov_b32 v88, 0
  v_mov_b32 v89, 0
  v_mov_b32 v90, 0
  v_mov_b32 v91, 0
  v_mov_b32 v92, 0
  v_mov_b32 v93, 0
  v_mov_b32 v94, 0
  v_mov_b32 v95, 0
  v_mov_b32 v96, 0
  v_mov_b32 v97, 0
  v_mov_b32 v98, 0
  v_mov_b32 v99, 0
  v_mov_b32 v100, 0
  v_mov_b32 v101, 0
  v_mov_b32 v102, 0
  v_mov_b32 v103, 0
  v_mov_b32 v104, 0
  v_mov_b32 v105, 0
  v_mov_b32 v106, 0
  v_mov_b32 v107, 0
  v_mov_b32 v108, 0
  v_mov_b32 v109, 0
  v_mov_b32 v110, 0
  v_mov_b32 v111, 0
  v_mov_b32 v112, 0
  v_mov_b32 v113, 0
  v_mov_b32 v114, 0
  v_mov_b32 v115, 0
  v_mov_b32 v116, 0
  v_mov_b32 v117, 0
  v_mov_b32 v118, 0
  v_mov_b32 v119, 0
  v_mov_b32 v120, 0
  v_mov_b32 v121, 0
  v_mov_b32 v122, 0
  v_mov_b32 v123, 0
  v_mov_b32 v124, 0
  v_mov_b32 v125, 0
  v_mov_b32 v126, 0
  v_mov_b32 v127, 0
  v_mov_b32 v128, 0
  v_mov_b32 v129, 0
  v_mov_b32 v130, 0
  v_mov_b32 v131, 0
  v_mov_b32 v132, 0
  v_mov_b32 v133, 0
  v_mov_b32 v134, 0
  v_mov_b32 v135, 0
  v_mov_b32 v136, 0
  v_mov_b32 v137, 0
  v_mov_b32 v138, 0
  v_mov_b32 v139, 0
  v_mov_b32 v140, 0
  v_mov_b32 v141, 0
  v_mov_b32 v142, 0
  v_mov_b32 v143, 0
  v_mov_b32 v144, 0
  v_mov_b32 v145, 0
  v_mov_b32 v146, 0
  v_mov_b32 v147, 0
  v_mov_b32 v148, 0
  v_mov_b32 v149, 0
  v_mov_b32 v150, 0
  v_mov_b32 v151, 0
  v_mov_b32 v152, 0
  v_mov_b32 v153, 0
  v_mov_b32 v154, 0
  v_mov_b32 v155, 0
  v_mov_b32 v156, 0
  v_mov_b32 v157, 0
  v_mov_b32 v158, 0
  v_mov_b32 v159, 0
  s_mov_b32 s87, 0
  s_barrier
  ds_read_b128 a[32:35], v8 offset:0
  ds_read_b128 a[0:3], v2 offset:0
  ds_read_b128 a[36:39], v8 offset:2048
  ds_read_b128 a[4:7], v2 offset:2048
  ds_read_b128 a[40:43], v8 offset:5120
  ds_read_b128 a[8:11], v2 offset:4096
  ds_read_b128 a[12:15], v2 offset:6144
  ds_read_b128 a[44:47], v8 offset:7168
K1_CL_3:
  s_waitcnt lgkmcnt(1)
  v_mfma_f32_16x16x32_bf16 v[32:35], a[0:3], a[32:35], v[32:35]
  ds_read_b128 a[48:51], v8 offset:10240
  v_mfma_f32_16x16x32_bf16 v[36:39], a[4:7], a[32:35], v[36:39]
  v_mfma_f32_16x16x32_bf16 v[40:43], a[8:11], a[32:35], v[40:43]
  v_mfma_f32_16x16x32_bf16 v[44:47], a[12:15], a[32:35], v[44:47]
  v_mfma_f32_16x16x32_bf16 v[48:51], a[0:3], a[36:39], v[48:51]
  ds_read_b128 a[52:55], v8 offset:12288
  v_mfma_f32_16x16x32_bf16 v[52:55], a[4:7], a[36:39], v[52:55]
  v_mfma_f32_16x16x32_bf16 v[56:59], a[8:11], a[36:39], v[56:59]
  v_mfma_f32_16x16x32_bf16 v[60:63], a[12:15], a[36:39], v[60:63]
  v_mfma_f32_16x16x32_bf16 v[64:67], a[0:3], a[40:43], v[64:67]
  ds_read_b128 a[32:35], v8 offset:15360
  v_mfma_f32_16x16x32_bf16 v[68:71], a[4:7], a[40:43], v[68:71]
  ds_read_b128 a[16:19], v3 offset:0
  v_mfma_f32_16x16x32_bf16 v[72:75], a[8:11], a[40:43], v[72:75]
  v_mfma_f32_16x16x32_bf16 v[76:79], a[12:15], a[40:43], v[76:79]
  s_waitcnt lgkmcnt(4)
  v_mfma_f32_16x16x32_bf16 v[80:83], a[0:3], a[44:47], v[80:83]
  ds_read_b128 a[36:39], v8 offset:17408
  v_mfma_f32_16x16x32_bf16 v[84:87], a[4:7], a[44:47], v[84:87]
  ds_read_b128 a[20:23], v3 offset:2048
  v_mfma_f32_16x16x32_bf16 v[88:91], a[8:11], a[44:47], v[88:91]
  v_mfma_f32_16x16x32_bf16 v[92:95], a[12:15], a[44:47], v[92:95]
  s_waitcnt lgkmcnt(5)
  v_mfma_f32_16x16x32_bf16 v[96:99], a[0:3], a[48:51], v[96:99]
  ds_read_b128 a[40:43], v9 offset:0
  v_mfma_f32_16x16x32_bf16 v[100:103], a[4:7], a[48:51], v[100:103]
  ds_read_b128 a[24:27], v3 offset:4096
  v_mfma_f32_16x16x32_bf16 v[104:107], a[8:11], a[48:51], v[104:107]
  v_mfma_f32_16x16x32_bf16 v[108:111], a[12:15], a[48:51], v[108:111]
  s_waitcnt lgkmcnt(6)
  v_mfma_f32_16x16x32_bf16 v[112:115], a[0:3], a[52:55], v[112:115]
  ds_read_b128 a[44:47], v9 offset:2048
  v_mfma_f32_16x16x32_bf16 v[116:119], a[4:7], a[52:55], v[116:119]
  ds_read_b128 a[28:31], v3 offset:6144
  v_mfma_f32_16x16x32_bf16 v[120:123], a[8:11], a[52:55], v[120:123]
  v_mfma_f32_16x16x32_bf16 v[124:127], a[12:15], a[52:55], v[124:127]
  s_waitcnt lgkmcnt(7)
  v_mfma_f32_16x16x32_bf16 v[128:131], a[0:3], a[32:35], v[128:131]
  ds_read_b128 a[48:51], v9 offset:5120
  v_mfma_f32_16x16x32_bf16 v[132:135], a[4:7], a[32:35], v[132:135]
  v_mfma_f32_16x16x32_bf16 v[136:139], a[8:11], a[32:35], v[136:139]
  v_mfma_f32_16x16x32_bf16 v[140:143], a[12:15], a[32:35], v[140:143]
  s_waitcnt lgkmcnt(6)
  v_mfma_f32_16x16x32_bf16 v[144:147], a[0:3], a[36:39], v[144:147]
  ds_read_b128 a[52:55], v9 offset:7168
  v_mfma_f32_16x16x32_bf16 v[148:151], a[4:7], a[36:39], v[148:151]
  v_mfma_f32_16x16x32_bf16 v[152:155], a[8:11], a[36:39], v[152:155]
  v_mfma_f32_16x16x32_bf16 v[156:159], a[12:15], a[36:39], v[156:159]
  s_cmp_ge_u32 s87, 2
  s_cbranch_scc1 K1_CT_4
  s_add_u32 s80, s80, s81
  buffer_load_dword v16, v14, s[12:15], s80 offen
  s_add_u32 s80, s80, s81
  buffer_load_dword v16, v14, s[12:15], s80 offen
  s_add_u32 s80, s80, s81
  buffer_load_dword v16, v14, s[12:15], s80 offen
K1_CT_4:
  s_waitcnt lgkmcnt(2)
  v_mfma_f32_16x16x32_bf16 v[32:35], a[16:19], a[40:43], v[32:35]
  ds_read_b128 a[32:35], v9 offset:10240
  v_mfma_f32_16x16x32_bf16 v[36:39], a[20:23], a[40:43], v[36:39]
  v_mfma_f32_16x16x32_bf16 v[40:43], a[24:27], a[40:43], v[40:43]
  v_mfma_f32_16x16x32_bf16 v[44:47], a[28:31], a[40:43], v[44:47]
  v_mfma_f32_16x16x32_bf16 v[48:51], a[16:19], a[44:47], v[48:51]
  ds_read_b128 a[36:39], v9 offset:12288
  v_mfma_f32_16x16x32_bf16 v[52:55], a[20:23], a[44:47], v[52:55]
  v_mfma_f32_16x16x32_bf16 v[56:59], a[24:27], a[44:47], v[56:59]
  v_mfma_f32_16x16x32_bf16 v[60:63], a[28:31], a[44:47], v[60:63]
  s_waitcnt lgkmcnt(3)
  v_mfma_f32_16x16x32_bf16 v[64:67], a[16:19], a[48:51], v[64:67]
  ds_read_b128 a[40:43], v9 offset:15360
  v_mfma_f32_16x16x32_bf16 v[68:71], a[20:23], a[48:51], v[68:71]
  v_mfma_f32_16x16x32_bf16 v[72:75], a[24:27], a[48:51], v[72:75]
  v_mfma_f32_16x16x32_bf16 v[76:79], a[28:31], a[48:51], v[76:79]
  s_waitcnt lgkmcnt(3)
  v_mfma_f32_16x16x32_bf16 v[80:83], a[16:19], a[52:55], v[80:83]
  ds_read_b128 a[44:47], v9 offset:17408
  v_mfma_f32_16x16x32_bf16 v[84:87], a[20:23], a[52:55], v[84:87]
  v_mfma_f32_16x16x32_bf16 v[88:91], a[24:27], a[52:55], v[88:91]
  v_mfma_f32_16x16x32_bf16 v[92:95], a[28:31], a[52:55], v[92:95]
  s_waitcnt lgkmcnt(3)
  v_mfma_f32_16x16x32_bf16 v[96:99], a[16:19], a[32:35], v[96:99]
  v_mfma_f32_16x16x32_bf16 v[100:103], a[20:23], a[32:35], v[100:103]
  v_mfma_f32_16x16x32_bf16 v[104:107], a[24:27], a[32:35], v[104:107]
  v_mfma_f32_16x16x32_bf16 v[108:111], a[28:31], a[32:35], v[108:111]
  s_waitcnt lgkmcnt(0)
  s_barrier
  v_mfma_f32_16x16x32_bf16 v[112:115], a[16:19], a[36:39], v[112:115]
  ds_read_b128 a[48:51], v8 offset:20480
  v_mfma_f32_16x16x32_bf16 v[116:119], a[20:23], a[36:39], v[116:119]
  ds_read_b128 a[0:3], v4 offset:0
  v_mfma_f32_16x16x32_bf16 v[120:123], a[24:27], a[36:39], v[120:123]
  ds_read_b128 a[52:55], v8 offset:22528
  v_mfma_f32_16x16x32_bf16 v[124:127], a[28:31], a[36:39], v[124:127]
  ds_read_b128 a[4:7], v4 offset:2048
  v_mfma_f32_16x16x32_bf16 v[128:131], a[16:19], a[40:43], v[128:131]
  ds_read_b128 a[32:35], v8 offset:25600
  v_mfma_f32_16x16x32_bf16 v[132:135], a[20:23], a[40:43], v[132:135]
  ds_read_b128 a[8:11], v4 offset:4096
  v_mfma_f32_16x16x32_bf16 v[136:139], a[24:27], a[40:43], v[136:139]
  ds_read_b128 a[12:15], v4 offset:6144
  v_mfma_f32_16x16x32_bf16 v[140:143], a[28:31], a[40:43], v[140:143]
  v_mfma_f32_16x16x32_bf16 v[144:147], a[16:19], a[44:47], v[144:147]
  ds_read_b128 a[36:39], v8 offset:27648
  v_mfma_f32_16x16x32_bf16 v[148:151], a[20:23], a[44:47], v[148:151]
  v_mfma_f32_16x16x32_bf16 v[152:155], a[24:27], a[44:47], v[152:155]
  v_mfma_f32_16x16x32_bf16 v[156:159], a[28:31], a[44:47], v[156:159]
  s_waitcnt lgkmcnt(1)
  v_mfma_f32_16x16x32_bf16 v[32:35], a[0:3], a[48:51], v[32:35]
  ds_read_b128 a[40:43], v8 offset:30720
  v_mfma_f32_16x16x32_bf16 v[36:39], a[4:7], a[48:51], v[36:39]
  v_mfma_f32_16x16x32_bf16 v[40:43], a[8:11], a[48:51], v[40:43]
  v_mfma_f32_16x16x32_bf16 v[44:47], a[12:15], a[48:51], v[44:47]
  v_mfma_f32_16x16x32_bf16 v[48:51], a[0:3], a[52:55], v[48:51]
  ds_read_b128 a[44:47], v8 offset:32768
  v_mfma_f32_16x16x32_bf16 v[52:55], a[4:7], a[52:55], v[52:55]
  v_mfma_f32_16x16x32_bf16 v[56:59], a[8:11], a[52:55], v[56:59]
  v_mfma_f32_16x16x32_bf16 v[60:63], a[12:15], a[52:55], v[60:63]
  v_mfma_f32_16x16x32_bf16 v[64:67], a[0:3], a[32:35], v[64:67]
  ds_read_b128 a[48:51], v8 offset:35840
  v_mfma_f32_16x16x32_bf16 v[68:71], a[4:7], a[32:35], v[68:71]
  ds_read_b128 a[16:19], v5 offset:0
  v_mfma_f32_16x16x32_bf16 v[72:75], a[8:11], a[32:35], v[72:75]
  v_mfma_f32_16x16x32_bf16 v[76:79], a[12:15], a[32:35], v[76:79]
  s_waitcnt lgkmcnt(4)
  v_mfma_f32_16x16x32_bf16 v[80:83], a[0:3], a[36:39], v[80:83]
  ds_read_b128 a[52:55], v8 offset:37888
  v_mfma_f32_16x16x32_bf16 v[84:87], a[4:7], a[36:39], v[84:87]
  ds_read_b128 a[20:23], v5 offset:2048
  v_mfma_f32_16x16x32_bf16 v[88:91], a[8:11], a[36:39], v[88:91]
  v_mfma_f32_16x16x32_bf16 v[92:95], a[12:15], a[36:39], v[92:95]
  s_waitcnt lgkmcnt(5)
  v_mfma_f32_16x16x32_bf16 v[96:99], a[0:3], a[40:43], v[96:99]
  ds_read_b128 a[32:35], v9 offset:20480
  v_mfma_f32_16x16x32_bf16 v[100:103], a[4:7], a[40:43], v[100:103]
  ds_read_b128 a[24:27], v5 offset:4096
  v_mfma_f32_16x16x32_bf16 v[104:107], a[8:11], a[40:43], v[104:107]
  v_mfma_f32_16x16x32_bf16 v[108:111], a[12:15], a[40:43], v[108:111]
  s_waitcnt lgkmcnt(6)
  v_mfma_f32_16x16x32_bf16 v[112:115], a[0:3], a[44:47], v[112:115]
  ds_read_b128 a[36:39], v9 offset:22528
  v_mfma_f32_16x16x32_bf16 v[116:119], a[4:7], a[44:47], v[116:119]
  ds_read_b128 a[28:31], v5 offset:6144
  v_mfma_f32_16x16x32_bf16 v[120:123], a[8:11], a[44:47], v[120:123]
  v_mfma_f32_16x16x32_bf16 v[124:127], a[12:15], a[44:47], v[124:127]
  s_waitcnt lgkmcnt(7)
  v_mfma_f32_16x16x32_bf16 v[128:131], a[0:3], a[48:51], v[128:131]
  ds_read_b128 a[40:43], v9 offset:25600
  v_mfma_f32_16x16x32_bf16 v[132:135], a[4:7], a[48:51], v[132:135]
  v_mfma_f32_16x16x32_bf16 v[136:139], a[8:11], a[48:51], v[136:139]
  v_mfma_f32_16x16x32_bf16 v[140:143], a[12:15], a[48:51], v[140:143]
  s_waitcnt lgkmcnt(6)
  v_mfma_f32_16x16x32_bf16 v[144:147], a[0:3], a[52:55], v[144:147]
  ds_read_b128 a[44:47], v9 offset:27648
  v_mfma_f32_16x16x32_bf16 v[148:151], a[4:7], a[52:55], v[148:151]
  v_mfma_f32_16x16x32_bf16 v[152:155], a[8:11], a[52:55], v[152:155]
  v_mfma_f32_16x16x32_bf16 v[156:159], a[12:15], a[52:55], v[156:159]
  s_waitcnt lgkmcnt(2)
  v_mfma_f32_16x16x32_bf16 v[32:35], a[16:19], a[32:35], v[32:35]
  ds_read_b128 a[48:51], v9 offset:30720
  v_mfma_f32_16x16x32_bf16 v[36:39], a[20:23], a[32:35], v[36:39]
  v_mfma_f32_16x16x32_bf16 v[40:43], a[24:27], a[32:35], v[40:43]
  v_mfma_f32_16x16x32_bf16 v[44:47], a[28:31], a[32:35], v[44:47]
  v_mfma_f32_16x16x32_bf16 v[48:51], a[16:19], a[36:39], v[48:51]
  ds_read_b128 a[52:55], v9 offset:32768
  v_mfma_f32_16x16x32_bf16 v[52:55], a[20:23], a[36:39], v[52:55]
  v_mfma_f32_16x16x32_bf16 v[56:59], a[24:27], a[36:39], v[56:59]
  v_mfma_f32_16x16x32_bf16 v[60:63], a[28:31], a[36:39], v[60:63]
  s_waitcnt lgkmcnt(3)
  v_mfma_f32_16x16x32_bf16 v[64:67], a[16:19], a[40:43], v[64:67]
  ds_read_b128 a[32:35], v9 offset:35840
  v_mfma_f32_16x16x32_bf16 v[68:71], a[20:23], a[40:43], v[68:71]
  v_mfma_f32_16x16x32_bf16 v[72:75], a[24:27], a[40:43], v[72:75]
  v_mfma_f32_16x16x32_bf16 v[76:79], a[28:31], a[40:43], v[76:79]
  s_waitcnt lgkmcnt(3)
  v_mfma_f32_16x16x32_bf16 v[80:83], a[16:19], a[44:47], v[80:83]
  ds_read_b128 a[36:39], v9 offset:37888
  v_mfma_f32_16x16x32_bf16 v[84:87], a[20:23], a[44:47], v[84:87]
  v_mfma_f32_16x16x32_bf16 v[88:91], a[24:27], a[44:47], v[88:91]
  v_mfma_f32_16x16x32_bf16 v[92:95], a[28:31], a[44:47], v[92:95]
  s_waitcnt lgkmcnt(3)
  v_mfma_f32_16x16x32_bf16 v[96:99], a[16:19], a[48:51], v[96:99]
  v_mfma_f32_16x16x32_bf16 v[100:103], a[20:23], a[48:51], v[100:103]
  v_mfma_f32_16x16x32_bf16 v[104:107], a[24:27], a[48:51], v[104:107]
  v_mfma_f32_16x16x32_bf16 v[108:111], a[28:31], a[48:51], v[108:111]
  s_waitcnt lgkmcnt(0)
  s_barrier
  v_mfma_f32_16x16x32_bf16 v[112:115], a[16:19], a[52:55], v[112:115]
  ds_read_b128 a[40:43], v8 offset:40960
  v_mfma_f32_16x16x32_bf16 v[116:119], a[20:23], a[52:55], v[116:119]
  ds_read_b128 a[0:3], v6 offset:0
  v_mfma_f32_16x16x32_bf16 v[120:123], a[24:27], a[52:55], v[120:123]
  ds_read_b128 a[44:47], v8 offset:43008
  v_mfma_f32_16x16x32_bf16 v[124:127], a[28:31], a[52:55], v[124:127]
  ds_read_b128 a[4:7], v6 offset:2048
  v_mfma_f32_16x16x32_bf16 v[128:131], a[16:19], a[32:35], v[128:131]
  ds_read_b128 a[48:51], v8 offset:46080
  v_mfma_f32_16x16x32_bf16 v[132:135], a[20:23], a[32:35], v[132:135]
  ds_read_b128 a[8:11], v6 offset:4096
  v_mfma_f32_16x16x32_bf16 v[136:139], a[24:27], a[32:35], v[136:139]
  ds_read_b128 a[12:15], v6 offset:6144
  v_mfma_f32_16x16x32_bf16 v[140:143], a[28:31], a[32:35], v[140:143]
  v_mfma_f32_16x16x32_bf16 v[144:147], a[16:19], a[36:39], v[144:147]
  ds_read_b128 a[52:55], v8 offset:48128
  v_mfma_f32_16x16x32_bf16 v[148:151], a[20:23], a[36:39], v[148:151]
  v_mfma_f32_16x16x32_bf16 v[152:155], a[24:27], a[36:39], v[152:155]
  v_mfma_f32_16x16x32_bf16 v[156:159], a[28:31], a[36:39], v[156:159]
  s_waitcnt lgkmcnt(1)
  v_mfma_f32_16x16x32_bf16 v[32:35], a[0:3], a[40:43], v[32:35]
  ds_read_b128 a[32:35], v8 offset:51200
  v_mfma_f32_16x16x32_bf16 v[36:39], a[4:7], a[40:43], v[36:39]
  v_mfma_f32_16x16x32_bf16 v[40:43], a[8:11], a[40:43], v[40:43]
  v_mfma_f32_16x16x32_bf16 v[44:47], a[12:15], a[40:43], v[44:47]
  v_mfma_f32_16x16x32_bf16 v[48:51], a[0:3], a[44:47], v[48:51]
  ds_read_b128 a[36:39], v8 offset:53248
  v_mfma_f32_16x16x32_bf16 v[52:55], a[4:7], a[44:47], v[52:55]
  v_mfma_f32_16x16x32_bf16 v[56:59], a[8:11], a[44:47], v[56:59]
  v_mfma_f32_16x16x32_bf16 v[60:63], a[12:15], a[44:47], v[60:63]
  v_mfma_f32_16x16x32_bf16 v[64:67], a[0:3], a[48:51], v[64:67]
  ds_read_b128 a[40:43], v8 offset:56320
  v_mfma_f32_16x16x32_bf16 v[68:71], a[4:7], a[48:51], v[68:71]
  ds_read_b128 a[16:19], v7 offset:0
  v_mfma_f32_16x16x32_bf16 v[72:75], a[8:11], a[48:51], v[72:75]
  v_mfma_f32_16x16x32_bf16 v[76:79], a[12:15], a[48:51], v[76:79]
  s_waitcnt lgkmcnt(4)
  v_mfma_f32_16x16x32_bf16 v[80:83], a[0:3], a[52:55], v[80:83]
  ds_read_b128 a[44:47], v8 offset:58368
  v_mfma_f32_16x16x32_bf16 v[84:87], a[4:7], a[52:55], v[84:87]
  ds_read_b128 a[20:23], v7 offset:2048
  v_mfma_f32_16x16x32_bf16 v[88:91], a[8:11], a[52:55], v[88:91]
  v_mfma_f32_16x16x32_bf16 v[92:95], a[12:15], a[52:55], v[92:95]
  s_waitcnt lgkmcnt(5)
  v_mfma_f32_16x16x32_bf16 v[96:99], a[0:3], a[32:35], v[96:99]
  ds_read_b128 a[48:51], v9 offset:40960
  v_mfma_f32_16x16x32_bf16 v[100:103], a[4:7], a[32:35], v[100:103]
  ds_read_b128 a[24:27], v7 offset:4096
  v_mfma_f32_16x16x32_bf16 v[104:107], a[8:11], a[32:35], v[104:107]
  v_mfma_f32_16x16x32_bf16 v[108:111], a[12:15], a[32:35], v[108:111]
  s_waitcnt lgkmcnt(6)
  v_mfma_f32_16x16x32_bf16 v[112:115], a[0:3], a[36:39], v[112:115]
  ds_read_b128 a[52:55], v9 offset:43008
  v_mfma_f32_16x16x32_bf16 v[116:119], a[4:7], a[36:39], v[116:119]
  ds_read_b128 a[28:31], v7 offset:6144
  v_mfma_f32_16x16x32_bf16 v[120:123], a[8:11], a[36:39], v[120:123]
  v_mfma_f32_16x16x32_bf16 v[124:127], a[12:15], a[36:39], v[124:127]
  s_waitcnt lgkmcnt(7)
  v_mfma_f32_16x16x32_bf16 v[128:131], a[0:3], a[40:43], v[128:131]
  ds_read_b128 a[32:35], v9 offset:46080
  v_mfma_f32_16x16x32_bf16 v[132:135], a[4:7], a[40:43], v[132:135]
  v_mfma_f32_16x16x32_bf16 v[136:139], a[8:11], a[40:43], v[136:139]
  v_mfma_f32_16x16x32_bf16 v[140:143], a[12:15], a[40:43], v[140:143]
  s_waitcnt lgkmcnt(6)
  v_mfma_f32_16x16x32_bf16 v[144:147], a[0:3], a[44:47], v[144:147]
  ds_read_b128 a[36:39], v9 offset:48128
  v_mfma_f32_16x16x32_bf16 v[148:151], a[4:7], a[44:47], v[148:151]
  v_mfma_f32_16x16x32_bf16 v[152:155], a[8:11], a[44:47], v[152:155]
  v_mfma_f32_16x16x32_bf16 v[156:159], a[12:15], a[44:47], v[156:159]
  s_waitcnt lgkmcnt(2)
  v_mfma_f32_16x16x32_bf16 v[32:35], a[16:19], a[48:51], v[32:35]
  ds_read_b128 a[40:43], v9 offset:51200
  v_mfma_f32_16x16x32_bf16 v[36:39], a[20:23], a[48:51], v[36:39]
  v_mfma_f32_16x16x32_bf16 v[40:43], a[24:27], a[48:51], v[40:43]
  v_mfma_f32_16x16x32_bf16 v[44:47], a[28:31], a[48:51], v[44:47]
  v_mfma_f32_16x16x32_bf16 v[48:51], a[16:19], a[52:55], v[48:51]
  ds_read_b128 a[44:47], v9 offset:53248
  v_mfma_f32_16x16x32_bf16 v[52:55], a[20:23], a[52:55], v[52:55]
  v_mfma_f32_16x16x32_bf16 v[56:59], a[24:27], a[52:55], v[56:59]
  v_mfma_f32_16x16x32_bf16 v[60:63], a[28:31], a[52:55], v[60:63]
  s_waitcnt lgkmcnt(3)
  v_mfma_f32_16x16x32_bf16 v[64:67], a[16:19], a[32:35], v[64:67]
  ds_read_b128 a[48:51], v9 offset:56320
  v_mfma_f32_16x16x32_bf16 v[68:71], a[20:23], a[32:35], v[68:71]
  v_mfma_f32_16x16x32_bf16 v[72:75], a[24:27], a[32:35], v[72:75]
  v_mfma_f32_16x16x32_bf16 v[76:79], a[28:31], a[32:35], v[76:79]
  s_waitcnt lgkmcnt(3)
  v_mfma_f32_16x16x32_bf16 v[80:83], a[16:19], a[36:39], v[80:83]
  ds_read_b128 a[52:55], v9 offset:58368
  v_mfma_f32_16x16x32_bf16 v[84:87], a[20:23], a[36:39], v[84:87]
  v_mfma_f32_16x16x32_bf16 v[88:91], a[24:27], a[36:39], v[88:91]
  v_mfma_f32_16x16x32_bf16 v[92:95], a[28:31], a[36:39], v[92:95]
  s_waitcnt lgkmcnt(3)
  v_mfma_f32_16x16x32_bf16 v[96:99], a[16:19], a[40:43], v[96:99]
  v_mfma_f32_16x16x32_bf16 v[100:103], a[20:23], a[40:43], v[100:103]
  v_mfma_f32_16x16x32_bf16 v[104:107], a[24:27], a[40:43], v[104:107]
  v_mfma_f32_16x16x32_bf16 v[108:111], a[28:31], a[40:43], v[108:111]
  s_waitcnt lgkmcnt(0)
  s_barrier
  v_mfma_f32_16x16x32_bf16 v[112:115], a[16:19], a[44:47], v[112:115]
  ds_read_b128 a[32:35], v8 offset:0
  v_mfma_f32_16x16x32_bf16 v[116:119], a[20:23], a[44:47], v[116:119]
  ds_read_b128 a[0:3], v2 offset:0
  v_mfma_f32_16x16x32_bf16 v[120:123], a[24:27], a[44:47], v[120:123]
  ds_read_b128 a[36:39], v8 offset:2048
  v_mfma_f32_16x16x32_bf16 v[124:127], a[28:31], a[44:47], v[124:127]
  ds_read_b128 a[4:7], v2 offset:2048
  v_mfma_f32_16x16x32_bf16 v[128:131], a[16:19], a[48:51], v[128:131]
  ds_read_b128 a[40:43], v8 offset:5120
  v_mfma_f32_16x16x32_bf16 v[132:135], a[20:23], a[48:51], v[132:135]
  ds_read_b128 a[8:11], v2 offset:4096
  v_mfma_f32_16x16x32_bf16 v[136:139], a[24:27], a[48:51], v[136:139]
  ds_read_b128 a[12:15], v2 offset:6144
  v_mfma_f32_16x16x32_bf16 v[140:143], a[28:31], a[48:51], v[140:143]
  v_mfma_f32_16x16x32_bf16 v[144:147], a[16:19], a[52:55], v[144:147]
  ds_read_b128 a[44:47], v8 offset:7168
  v_mfma_f32_16x16x32_bf16 v[148:151], a[20:23], a[52:55], v[148:151]
  v_mfma_f32_16x16x32_bf16 v[152:155], a[24:27], a[52:55], v[152:155]
  v_mfma_f32_16x16x32_bf16 v[156:159], a[28:31], a[52:55], v[156:159]
  s_add_u32 s87, s87, 1
  s_cmp_lt_u32 s87, 3
  s_cbranch_scc1 K1_CL_3
  s_waitcnt lgkmcnt(1)
  v_mfma_f32_16x16x32_bf16 v[32:35], a[0:3], a[32:35], v[32:35]
  ds_read_b128 a[48:51], v8 offset:10240
  v_mfma_f32_16x16x32_bf16 v[36:39], a[4:7], a[32:35], v[36:39]
  v_mfma_f32_16x16x32_bf16 v[40:43], a[8:11], a[32:35], v[40:43]
  v_mfma_f32_16x16x32_bf16 v[44:47], a[12:15], a[32:35], v[44:47]
  v_mfma_f32_16x16x32_bf16 v[48:51], a[0:3], a[36:39], v[48:51]
  ds_read_b128 a[52:55], v8 offset:12288
  v_mfma_f32_16x16x32_bf16 v[52:55], a[4:7], a[36:39], v[52:55]
  v_mfma_f32_16x16x32_bf16 v[56:59], a[8:11], a[36:39], v[56:59]
  v_mfma_f32_16x16x32_bf16 v[60:63], a[12:15], a[36:39], v[60:63]
  v_mfma_f32_16x16x32_bf16 v[64:67], a[0:3], a[40:43], v[64:67]
  ds_read_b128 a[32:35], v8 offset:15360
  v_mfma_f32_16x16x32_bf16 v[68:71], a[4:7], a[40:43], v[68:71]
  ds_read_b128 a[16:19], v3 offset:0
  v_mfma_f32_16x16x32_bf16 v[72:75], a[8:11], a[40:43], v[72:75]
  v_mfma_f32_16x16x32_bf16 v[76:79], a[12:15], a[40:43], v[76:79]
  s_waitcnt lgkmcnt(4)
  v_mfma_f32_16x16x32_bf16 v[80:83], a[0:3], a[44:47], v[80:83]
  ds_read_b128 a[36:39], v8 offset:17408
  v_mfma_f32_16x16x32_bf16 v[84:87], a[4:7], a[44:47], v[84:87]
  ds_read_b128 a[20:23], v3 offset:2048
  v_mfma_f32_16x16x32_bf16 v[88:91], a[8:11], a[44:47], v[88:91]
  v_mfma_f32_16x16x32_bf16 v[92:95], a[12:15], a[44:47], v[92:95]
  s_waitcnt lgkmcnt(5)
  v_mfma_f32_16x16x32_bf16 v[96:99], a[0:3], a[48:51], v[96:99]
  ds_read_b128 a[40:43], v9 offset:0
  v_mfma_f32_16x16x32_bf16 v[100:103], a[4:7], a[48:51], v[100:103]
  ds_read_b128 a[24:27], v3 offset:4096
  v_mfma_f32_16x16x32_bf16 v[104:107], a[8:11], a[48:51], v[104:107]
  v_mfma_f32_16x16x32_bf16 v[108:111], a[12:15], a[48:51], v[108:111]
  s_waitcnt lgkmcnt(6)
  v_mfma_f32_16x16x32_bf16 v[112:115], a[0:3], a[52:55], v[112:115]
  ds_read_b128 a[44:47], v9 offset:2048
  v_mfma_f32_16x16x32_bf16 v[116:119], a[4:7], a[52:55], v[116:119]
  ds_read_b128 a[28:31], v3 offset:6144
  v_mfma_f32_16x16x32_bf16 v[120:123], a[8:11], a[52:55], v[120:123]
  v_mfma_f32_16x16x32_bf16 v[124:127], a[12:15], a[52:55], v[124:127]
  s_waitcnt lgkmcnt(7)
  v_mfma_f32_16x16x32_bf16 v[128:131], a[0:3], a[32:35], v[128:131]
  ds_read_b128 a[48:51], v9 offset:5120
  v_mfma_f32_16x16x32_bf16 v[132:135], a[4:7], a[32:35], v[132:135]
  v_mfma_f32_16x16x32_bf16 v[136:139], a[8:11], a[32:35], v[136:139]
  v_mfma_f32_16x16x32_bf16 v[140:143], a[12:15], a[32:35], v[140:143]
  s_waitcnt lgkmcnt(6)
  v_mfma_f32_16x16x32_bf16 v[144:147], a[0:3], a[36:39], v[144:147]
  ds_read_b128 a[52:55], v9 offset:7168
  v_mfma_f32_16x16x32_bf16 v[148:151], a[4:7], a[36:39], v[148:151]
  v_mfma_f32_16x16x32_bf16 v[152:155], a[8:11], a[36:39], v[152:155]
  v_mfma_f32_16x16x32_bf16 v[156:159], a[12:15], a[36:39], v[156:159]
  s_waitcnt lgkmcnt(2)
  v_mfma_f32_16x16x32_bf16 v[32:35], a[16:19], a[40:43], v[32:35]
  ds_read_b128 a[32:35], v9 offset:10240
  v_mfma_f32_16x16x32_bf16 v[36:39], a[20:23], a[40:43], v[36:39]
  v_mfma_f32_16x16x32_bf16 v[40:43], a[24:27], a[40:43], v[40:43]
  v_mfma_f32_16x16x32_bf16 v[44:47], a[28:31], a[40:43], v[44:47]
  v_mfma_f32_16x16x32_bf16 v[48:51], a[16:19], a[44:47], v[48:51]
  ds_read_b128 a[36:39], v9 offset:12288
  v_mfma_f32_16x16x32_bf16 v[52:55], a[20:23], a[44:47], v[52:55]
  v_mfma_f32_16x16x32_bf16 v[56:59], a[24:27], a[44:47], v[56:59]
  v_mfma_f32_16x16x32_bf16 v[60:63], a[28:31], a[44:47], v[60:63]
  s_waitcnt lgkmcnt(3)
  v_mfma_f32_16x16x32_bf16 v[64:67], a[16:19], a[48:51], v[64:67]
  ds_read_b128 a[40:43], v9 offset:15360
  v_mfma_f32_16x16x32_bf16 v[68:71], a[20:23], a[48:51], v[68:71]
  v_mfma_f32_16x16x32_bf16 v[72:75], a[24:27], a[48:51], v[72:75]
  v_mfma_f32_16x16x32_bf16 v[76:79], a[28:31], a[48:51], v[76:79]
  s_waitcnt lgkmcnt(3)
  v_mfma_f32_16x16x32_bf16 v[80:83], a[16:19], a[52:55], v[80:83]
  ds_read_b128 a[44:47], v9 offset:17408
  v_mfma_f32_16x16x32_bf16 v[84:87], a[20:23], a[52:55], v[84:87]
  v_mfma_f32_16x16x32_bf16 v[88:91], a[24:27], a[52:55], v[88:91]
  v_mfma_f32_16x16x32_bf16 v[92:95], a[28:31], a[52:55], v[92:95]
  s_waitcnt lgkmcnt(3)
  v_mfma_f32_16x16x32_bf16 v[96:99], a[16:19], a[32:35], v[96:99]
  v_mfma_f32_16x16x32_bf16 v[100:103], a[20:23], a[32:35], v[100:103]
  v_mfma_f32_16x16x32_bf16 v[104:107], a[24:27], a[32:35], v[104:107]
  v_mfma_f32_16x16x32_bf16 v[108:111], a[28:31], a[32:35], v[108:111]
  s_waitcnt lgkmcnt(2)
  v_mfma_f32_16x16x32_bf16 v[112:115], a[16:19], a[36:39], v[112:115]
  v_mfma_f32_16x16x32_bf16 v[116:119], a[20:23], a[36:39], v[116:119]
  v_mfma_f32_16x16x32_bf16 v[120:123], a[24:27], a[36:39], v[120:123]
  v_mfma_f32_16x16x32_bf16 v[124:127], a[28:31], a[36:39], v[124:127]
  s_waitcnt lgkmcnt(1)
  v_mfma_f32_16x16x32_bf16 v[128:131], a[16:19], a[40:43], v[128:131]
  v_mfma_f32_16x16x32_bf16 v[132:135], a[20:23], a[40:43], v[132:135]
  v_mfma_f32_16x16x32_bf16 v[136:139], a[24:27], a[40:43], v[136:139]
  v_mfma_f32_16x16x32_bf16 v[140:143], a[28:31], a[40:43], v[140:143]
  s_waitcnt lgkmcnt(0)
  v_mfma_f32_16x16x32_bf16 v[144:147], a[16:19], a[44:47], v[144:147]
  v_mfma_f32_16x16x32_bf16 v[148:151], a[20:23], a[44:47], v[148:151]
  v_mfma_f32_16x16x32_bf16 v[152:155], a[24:27], a[44:47], v[152:155]
  v_mfma_f32_16x16x32_bf16 v[156:159], a[28:31], a[44:47], v[156:159]
  s_waitcnt vmcnt(0)
  s_setprio 3
  s_barrier
  v_lshlrev_b32 v13, 4, v31
  v_add_u32 v13, 159744, v13
  s_lshl_b32 s65, s3, 8
  v_lshlrev_b32 v2, 4, v30
  v_add_u32 v2, s65, v2
  v_add_u32 v2, 160768, v2
  v_lshlrev_b32 v3, 2, v31
  v_add_u32 v3, 162816, v3

  ds_read_b128 v[160:163], v2 offset:0
  ds_read_b128 v[176:179], v2 offset:1024
  ds_read_b128 v[164:167], v2 offset:64
  ds_read_b128 v[180:183], v2 offset:1088
  ds_read_b128 v[168:171], v2 offset:128
  ds_read_b128 v[184:187], v2 offset:1152
  ds_read_b128 v[172:175], v2 offset:192
  ds_read_b128 v[188:191], v2 offset:1216
  ds_read_b32 v4, v3 offset:0
  ds_read_b32 v5, v3 offset:64
  ds_read_b32 v6, v3 offset:128
  ds_read_b32 v7, v3 offset:192
  ds_read_b32 v8, v3 offset:256
  ds_read_b32 v9, v3 offset:320
  ds_read_b32 v10, v3 offset:384
  ds_read_b32 v11, v3 offset:448
  v_mov_b32 v15, 158720
  ds_read_b32 v14, v15
  s_waitcnt lgkmcnt(0)
  v_readfirstlane_b32 s95, v14
  ds_read_b128 v[14:17], v13 offset:0
  ds_read_b128 v[18:21], v13 offset:256
  ds_read_b128 v[22:25], v13 offset:512
  ds_read_b128 v[26:29], v13 offset:768
  v_pk_fma_f32 v[32:33], v[176:177], v[4:5], v[32:33] op_sel:[0,0,0] op_sel_hi:[1,0,1] neg_lo:[0,1,0] neg_hi:[0,1,0]
  v_pk_fma_f32 v[34:35], v[178:179], v[4:5], v[34:35] op_sel:[0,0,0] op_sel_hi:[1,0,1] neg_lo:[0,1,0] neg_hi:[0,1,0]
  v_pk_fma_f32 v[36:37], v[180:181], v[4:5], v[36:37] op_sel:[0,0,0] op_sel_hi:[1,0,1] neg_lo:[0,1,0] neg_hi:[0,1,0]
  v_pk_fma_f32 v[38:39], v[182:183], v[4:5], v[38:39] op_sel:[0,0,0] op_sel_hi:[1,0,1] neg_lo:[0,1,0] neg_hi:[0,1,0]
  v_pk_fma_f32 v[40:41], v[184:185], v[4:5], v[40:41] op_sel:[0,0,0] op_sel_hi:[1,0,1] neg_lo:[0,1,0] neg_hi:[0,1,0]
  v_pk_fma_f32 v[42:43], v[186:187], v[4:5], v[42:43] op_sel:[0,0,0] op_sel_hi:[1,0,1] neg_lo:[0,1,0] neg_hi:[0,1,0]
  v_pk_fma_f32 v[44:45], v[188:189], v[4:5], v[44:45] op_sel:[0,0,0] op_sel_hi:[1,0,1] neg_lo:[0,1,0] neg_hi:[0,1,0]
  v_pk_fma_f32 v[46:47], v[190:191], v[4:5], v[46:47] op_sel:[0,0,0] op_sel_hi:[1,0,1] neg_lo:[0,1,0] neg_hi:[0,1,0]
  v_pk_mul_f32 v[32:33], v[32:33], v[160:161]
  v_pk_mul_f32 v[34:35], v[34:35], v[162:163]
  v_pk_mul_f32 v[36:37], v[36:37], v[164:165]
  v_pk_mul_f32 v[38:39], v[38:39], v[166:167]
  v_pk_mul_f32 v[40:41], v[40:41], v[168:169]
  v_pk_mul_f32 v[42:43], v[42:43], v[170:171]
  v_pk_mul_f32 v[44:45], v[44:45], v[172:173]
  v_pk_mul_f32 v[46:47], v[46:47], v[174:175]
  v_pk_fma_f32 v[96:97], v[176:177], v[8:9], v[96:97] op_sel:[0,0,0] op_sel_hi:[1,0,1] neg_lo:[0,1,0] neg_hi:[0,1,0]
  v_pk_fma_f32 v[98:99], v[178:179], v[8:9], v[98:99] op_sel:[0,0,0] op_sel_hi:[1,0,1] neg_lo:[0,1,0] neg_hi:[0,1,0]
  v_pk_fma_f32 v[100:101], v[180:181], v[8:9], v[100:101] op_sel:[0,0,0] op_sel_hi:[1,0,1] neg_lo:[0,1,0] neg_hi:[0,1,0]
  v_pk_fma_f32 v[102:103], v[182:183], v[8:9], v[102:103] op_sel:[0,0,0] op_sel_hi:[1,0,1] neg_lo:[0,1,0] neg_hi:[0,1,0]
  v_pk_fma_f32 v[104:105], v[184:185], v[8:9], v[104:105] op_sel:[0,0,0] op_sel_hi:[1,0,1] neg_lo:[0,1,0] neg_hi:[0,1,0]
  v_pk_fma_f32 v[106:107], v[186:187], v[8:9], v[106:107] op_sel:[0,0,0] op_sel_hi:[1,0,1] neg_lo:[0,1,0] neg_hi:[0,1,0]
  v_pk_fma_f32 v[108:109], v[188:189], v[8:9], v[108:109] op_sel:[0,0,0] op_sel_hi:[1,0,1] neg_lo:[0,1,0] neg_hi:[0,1,0]
  v_pk_fma_f32 v[110:111], v[190:191], v[8:9], v[110:111] op_sel:[0,0,0] op_sel_hi:[1,0,1] neg_lo:[0,1,0] neg_hi:[0,1,0]
  v_pk_mul_f32 v[96:97], v[96:97], v[160:161]
  v_pk_mul_f32 v[98:99], v[98:99], v[162:163]
  v_pk_mul_f32 v[100:101], v[100:101], v[164:165]
  v_pk_mul_f32 v[102:103], v[102:103], v[166:167]
  v_pk_mul_f32 v[104:105], v[104:105], v[168:169]
  v_pk_mul_f32 v[106:107], v[106:107], v[170:171]
  v_pk_mul_f32 v[108:109], v[108:109], v[172:173]
  v_pk_mul_f32 v[110:111], v[110:111], v[174:175]
  v_pk_fma_f32 v[48:49], v[176:177], v[4:5], v[48:49] op_sel:[0,1,0] op_sel_hi:[1,1,1] neg_lo:[0,1,0] neg_hi:[0,1,0]
  v_pk_fma_f32 v[50:51], v[178:179], v[4:5], v[50:51] op_sel:[0,1,0] op_sel_hi:[1,1,1] neg_lo:[0,1,0] neg_hi:[0,1,0]
  v_pk_fma_f32 v[52:53], v[180:181], v[4:5], v[52:53] op_sel:[0,1,0] op_sel_hi:[1,1,1] neg_lo:[0,1,0] neg_hi:[0,1,0]
  v_pk_fma_f32 v[54:55], v[182:183], v[4:5], v[54:55] op_sel:[0,1,0] op_sel_hi:[1,1,1] neg_lo:[0,1,0] neg_hi:[0,1,0]
  v_pk_fma_f32 v[56:57], v[184:185], v[4:5], v[56:57] op_sel:[0,1,0] op_sel_hi:[1,1,1] neg_lo:[0,1,0] neg_hi:[0,1,0]
  v_pk_fma_f32 v[58:59], v[186:187], v[4:5], v[58:59] op_sel:[0,1,0] op_sel_hi:[1,1,1] neg_lo:[0,1,0] neg_hi:[0,1,0]
  v_pk_fma_f32 v[60:61], v[188:189], v[4:5], v[60:61] op_sel:[0,1,0] op_sel_hi:[1,1,1] neg_lo:[0,1,0] neg_hi:[0,1,0]
  v_pk_fma_f32 v[62:63], v[190:191], v[4:5], v[62:63] op_sel:[0,1,0] op_sel_hi:[1,1,1] neg_lo:[0,1,0] neg_hi:[0,1,0]
  v_pk_mul_f32 v[48:49], v[48:49], v[160:161]
  v_pk_mul_f32 v[50:51], v[50:51], v[162:163]
  v_pk_mul_f32 v[52:53], v[52:53], v[164:165]
  v_pk_mul_f32 v[54:55], v[54:55], v[166:167]
  v_pk_mul_f32 v[56:57], v[56:57], v[168:169]
  v_pk_mul_f32 v[58:59], v[58:59], v[170:171]
  v_pk_mul_f32 v[60:61], v[60:61], v[172:173]
  v_pk_mul_f32 v[62:63], v[62:63], v[174:175]
  v_pk_fma_f32 v[112:113], v[176:177], v[8:9], v[112:113] op_sel:[0,1,0] op_sel_hi:[1,1,1] neg_lo:[0,1,0] neg_hi:[0,1,0]
  v_pk_fma_f32 v[114:115], v[178:179], v[8:9], v[114:115] op_sel:[0,1,0] op_sel_hi:[1,1,1] neg_lo:[0,1,0] neg_hi:[0,1,0]
  v_pk_fma_f32 v[116:117], v[180:181], v[8:9], v[116:117] op_sel:[0,1,0] op_sel_hi:[1,1,1] neg_lo:[0,1,0] neg_hi:[0,1,0]
  v_pk_fma_f32 v[118:119], v[182:183], v[8:9], v[118:119] op_sel:[0,1,0] op_sel_hi:[1,1,1] neg_lo:[0,1,0] neg_hi:[0,1,0]
  v_pk_fma_f32 v[120:121], v[184:185], v[8:9], v[120:121] op_sel:[0,1,0] op_sel_hi:[1,1,1] neg_lo:[0,1,0] neg_hi:[0,1,0]
  v_pk_fma_f32 v[122:123], v[186:187], v[8:9], v[122:123] op_sel:[0,1,0] op_sel_hi:[1,1,1] neg_lo:[0,1,0] neg_hi:[0,1,0]
  v_pk_fma_f32 v[124:125], v[188:189], v[8:9], v[124:125] op_sel:[0,1,0] op_sel_hi:[1,1,1] neg_lo:[0,1,0] neg_hi:[0,1,0]
  v_pk_fma_f32 v[126:127], v[190:191], v[8:9], v[126:127] op_sel:[0,1,0] op_sel_hi:[1,1,1] neg_lo:[0,1,0] neg_hi:[0,1,0]
  v_pk_mul_f32 v[112:113], v[112:113], v[160:161]
  v_pk_mul_f32 v[114:115], v[114:115], v[162:163]
  v_pk_mul_f32 v[116:117], v[116:117], v[164:165]
  v_pk_mul_f32 v[118:119], v[118:119], v[166:167]
  v_pk_mul_f32 v[120:121], v[120:121], v[168:169]
  v_pk_mul_f32 v[122:123], v[122:123], v[170:171]
  v_pk_mul_f32 v[124:125], v[124:125], v[172:173]
  v_pk_mul_f32 v[126:127], v[126:127], v[174:175]
  v_pk_fma_f32 v[64:65], v[176:177], v[6:7], v[64:65] op_sel:[0,0,0] op_sel_hi:[1,0,1] neg_lo:[0,1,0] neg_hi:[0,1,0]
  v_pk_fma_f32 v[66:67], v[178:179], v[6:7], v[66:67] op_sel:[0,0,0] op_sel_hi:[1,0,1] neg_lo:[0,1,0] neg_hi:[0,1,0]
  v_pk_fma_f32 v[68:69], v[180:181], v[6:7], v[68:69] op_sel:[0,0,0] op_sel_hi:[1,0,1] neg_lo:[0,1,0] neg_hi:[0,1,0]
  v_pk_fma_f32 v[70:71], v[182:183], v[6:7], v[70:71] op_sel:[0,0,0] op_sel_hi:[1,0,1] neg_lo:[0,1,0] neg_hi:[0,1,0]
  v_pk_fma_f32 v[72:73], v[184:185], v[6:7], v[72:73] op_sel:[0,0,0] op_sel_hi:[1,0,1] neg_lo:[0,1,0] neg_hi:[0,1,0]
  v_pk_fma_f32 v[74:75], v[186:187], v[6:7], v[74:75] op_sel:[0,0,0] op_sel_hi:[1,0,1] neg_lo:[0,1,0] neg_hi:[0,1,0]
  v_pk_fma_f32 v[76:77], v[188:189], v[6:7], v[76:77] op_sel:[0,0,0] op_sel_hi:[1,0,1] neg_lo:[0,1,0] neg_hi:[0,1,0]
  v_pk_fma_f32 v[78:79], v[190:191], v[6:7], v[78:79] op_sel:[0,0,0] op_sel_hi:[1,0,1] neg_lo:[0,1,0] neg_hi:[0,1,0]
  v_pk_mul_f32 v[64:65], v[64:65], v[160:161]
  v_pk_mul_f32 v[66:67], v[66:67], v[162:163]
  v_pk_mul_f32 v[68:69], v[68:69], v[164:165]
  v_pk_mul_f32 v[70:71], v[70:71], v[166:167]
  v_pk_mul_f32 v[72:73], v[72:73], v[168:169]
  v_pk_mul_f32 v[74:75], v[74:75], v[170:171]
  v_pk_mul_f32 v[76:77], v[76:77], v[172:173]
  v_pk_mul_f32 v[78:79], v[78:79], v[174:175]
  v_pk_fma_f32 v[128:129], v[176:177], v[10:11], v[128:129] op_sel:[0,0,0] op_sel_hi:[1,0,1] neg_lo:[0,1,0] neg_hi:[0,1,0]
  v_pk_fma_f32 v[130:131], v[178:179], v[10:11], v[130:131] op_sel:[0,0,0] op_sel_hi:[1,0,1] neg_lo:[0,1,0] neg_hi:[0,1,0]
  v_pk_fma_f32 v[132:133], v[180:181], v[10:11], v[132:133] op_sel:[0,0,0] op_sel_hi:[1,0,1] neg_lo:[0,1,0] neg_hi:[0,1,0]
  v_pk_fma_f32 v[134:135], v[182:183], v[10:11], v[134:135] op_sel:[0,0,0] op_sel_hi:[1,0,1] neg_lo:[0,1,0] neg_hi:[0,1,0]
  v_pk_fma_f32 v[136:137], v[184:185], v[10:11], v[136:137] op_sel:[0,0,0] op_sel_hi:[1,0,1] neg_lo:[0,1,0] neg_hi:[0,1,0]
  v_pk_fma_f32 v[138:139], v[186:187], v[10:11], v[138:139] op_sel:[0,0,0] op_sel_hi:[1,0,1] neg_lo:[0,1,0] neg_hi:[0,1,0]
  v_pk_fma_f32 v[140:141], v[188:189], v[10:11], v[140:141] op_sel:[0,0,0] op_sel_hi:[1,0,1] neg_lo:[0,1,0] neg_hi:[0,1,0]
  v_pk_fma_f32 v[142:143], v[190:191], v[10:11], v[142:143] op_sel:[0,0,0] op_sel_hi:[1,0,1] neg_lo:[0,1,0] neg_hi:[0,1,0]
  v_pk_mul_f32 v[128:129], v[128:129], v[160:161]
  v_pk_mul_f32 v[130:131], v[130:131], v[162:163]
  v_pk_mul_f32 v[132:133], v[132:133], v[164:165]
  v_pk_mul_f32 v[134:135], v[134:135], v[166:167]
  v_pk_mul_f32 v[136:137], v[136:137], v[168:169]
  v_pk_mul_f32 v[138:139], v[138:139], v[170:171]
  v_pk_mul_f32 v[140:141], v[140:141], v[172:173]
  v_pk_mul_f32 v[142:143], v[142:143], v[174:175]
  v_pk_fma_f32 v[80:81], v[176:177], v[6:7], v[80:81] op_sel:[0,1,0] op_sel_hi:[1,1,1] neg_lo:[0,1,0] neg_hi:[0,1,0]
  v_pk_fma_f32 v[82:83], v[178:179], v[6:7], v[82:83] op_sel:[0,1,0] op_sel_hi:[1,1,1] neg_lo:[0,1,0] neg_hi:[0,1,0]
  v_pk_fma_f32 v[84:85], v[180:181], v[6:7], v[84:85] op_sel:[0,1,0] op_sel_hi:[1,1,1] neg_lo:[0,1,0] neg_hi:[0,1,0]
  v_pk_fma_f32 v[86:87], v[182:183], v[6:7], v[86:87] op_sel:[0,1,0] op_sel_hi:[1,1,1] neg_lo:[0,1,0] neg_hi:[0,1,0]
  v_pk_fma_f32 v[88:89], v[184:185], v[6:7], v[88:89] op_sel:[0,1,0] op_sel_hi:[1,1,1] neg_lo:[0,1,0] neg_hi:[0,1,0]
  v_pk_fma_f32 v[90:91], v[186:187], v[6:7], v[90:91] op_sel:[0,1,0] op_sel_hi:[1,1,1] neg_lo:[0,1,0] neg_hi:[0,1,0]
  v_pk_fma_f32 v[92:93], v[188:189], v[6:7], v[92:93] op_sel:[0,1,0] op_sel_hi:[1,1,1] neg_lo:[0,1,0] neg_hi:[0,1,0]
  v_pk_fma_f32 v[94:95], v[190:191], v[6:7], v[94:95] op_sel:[0,1,0] op_sel_hi:[1,1,1] neg_lo:[0,1,0] neg_hi:[0,1,0]
  v_pk_mul_f32 v[80:81], v[80:81], v[160:161]
  v_pk_mul_f32 v[82:83], v[82:83], v[162:163]
  v_pk_mul_f32 v[84:85], v[84:85], v[164:165]
  v_pk_mul_f32 v[86:87], v[86:87], v[166:167]
  v_pk_mul_f32 v[88:89], v[88:89], v[168:169]
  v_pk_mul_f32 v[90:91], v[90:91], v[170:171]
  v_pk_mul_f32 v[92:93], v[92:93], v[172:173]
  v_pk_mul_f32 v[94:95], v[94:95], v[174:175]
  v_pk_fma_f32 v[144:145], v[176:177], v[10:11], v[144:145] op_sel:[0,1,0] op_sel_hi:[1,1,1] neg_lo:[0,1,0] neg_hi:[0,1,0]
  v_pk_fma_f32 v[146:147], v[178:179], v[10:11], v[146:147] op_sel:[0,1,0] op_sel_hi:[1,1,1] neg_lo:[0,1,0] neg_hi:[0,1,0]
  v_pk_fma_f32 v[148:149], v[180:181], v[10:11], v[148:149] op_sel:[0,1,0] op_sel_hi:[1,1,1] neg_lo:[0,1,0] neg_hi:[0,1,0]
  v_pk_fma_f32 v[150:151], v[182:183], v[10:11], v[150:151] op_sel:[0,1,0] op_sel_hi:[1,1,1] neg_lo:[0,1,0] neg_hi:[0,1,0]
  v_pk_fma_f32 v[152:153], v[184:185], v[10:11], v[152:153] op_sel:[0,1,0] op_sel_hi:[1,1,1] neg_lo:[0,1,0] neg_hi:[0,1,0]
  v_pk_fma_f32 v[154:155], v[186:187], v[10:11], v[154:155] op_sel:[0,1,0] op_sel_hi:[1,1,1] neg_lo:[0,1,0] neg_hi:[0,1,0]
  v_pk_fma_f32 v[156:157], v[188:189], v[10:11], v[156:157] op_sel:[0,1,0] op_sel_hi:[1,1,1] neg_lo:[0,1,0] neg_hi:[0,1,0]
  v_pk_fma_f32 v[158:159], v[190:191], v[10:11], v[158:159] op_sel:[0,1,0] op_sel_hi:[1,1,1] neg_lo:[0,1,0] neg_hi:[0,1,0]
  v_pk_mul_f32 v[144:145], v[144:145], v[160:161]
  v_pk_mul_f32 v[146:147], v[146:147], v[162:163]
  v_pk_mul_f32 v[148:149], v[148:149], v[164:165]
  v_pk_mul_f32 v[150:151], v[150:151], v[166:167]
  v_pk_mul_f32 v[152:153], v[152:153], v[168:169]
  v_pk_mul_f32 v[154:155], v[154:155], v[170:171]
  v_pk_mul_f32 v[156:157], v[156:157], v[172:173]
  v_pk_mul_f32 v[158:159], v[158:159], v[174:175]
  s_lshl_b32 s65, s3, 2
  v_add_u32 v10, s65, v30
  v_lshlrev_b32 v10, 9, v10
  v_lshl_add_u32 v10, v31, 3, v10
  v_add_u32 v10, 73728, v10
  s_waitcnt lgkmcnt(0)

  v_pk_fma_f32 v[176:177], v[14:15], v[32:33], v[34:35] op_sel_hi:[0,1,1]
  v_pk_fma_f32 v[180:181], v[18:19], v[48:49], v[50:51] op_sel_hi:[0,1,1]
  v_pk_fma_f32 v[184:185], v[22:23], v[64:65], v[66:67] op_sel_hi:[0,1,1]
  v_pk_fma_f32 v[188:189], v[26:27], v[80:81], v[82:83] op_sel_hi:[0,1,1]
  v_pk_fma_f32 v[178:179], v[14:15], v[96:97], v[98:99] op_sel_hi:[0,1,1]
  v_pk_fma_f32 v[182:183], v[18:19], v[112:113], v[114:115] op_sel_hi:[0,1,1]
  v_pk_fma_f32 v[186:187], v[22:23], v[128:129], v[130:131] op_sel_hi:[0,1,1]
  v_pk_fma_f32 v[190:191], v[26:27], v[144:145], v[146:147] op_sel_hi:[0,1,1]
  v_pk_fma_f32 v[176:177], v[14:15], v[96:97], v[176:177] op_sel:[1,0,0] op_sel_hi:[1,1,1] neg_lo:[1,0,0] neg_hi:[1,0,0]
  v_pk_fma_f32 v[180:181], v[18:19], v[112:113], v[180:181] op_sel:[1,0,0] op_sel_hi:[1,1,1] neg_lo:[1,0,0] neg_hi:[1,0,0]
  v_pk_fma_f32 v[184:185], v[22:23], v[128:129], v[184:185] op_sel:[1,0,0] op_sel_hi:[1,1,1] neg_lo:[1,0,0] neg_hi:[1,0,0]
  v_pk_fma_f32 v[188:189], v[26:27], v[144:145], v[188:189] op_sel:[1,0,0] op_sel_hi:[1,1,1] neg_lo:[1,0,0] neg_hi:[1,0,0]
  v_pk_fma_f32 v[178:179], v[14:15], v[32:33], v[178:179] op_sel:[1,0,0] op_sel_hi:[1,1,1]
  v_pk_fma_f32 v[182:183], v[18:19], v[48:49], v[182:183] op_sel:[1,0,0] op_sel_hi:[1,1,1]
  v_pk_fma_f32 v[186:187], v[22:23], v[64:65], v[186:187] op_sel:[1,0,0] op_sel_hi:[1,1,1]
  v_pk_fma_f32 v[190:191], v[26:27], v[80:81], v[190:191] op_sel:[1,0,0] op_sel_hi:[1,1,1]
  v_pk_fma_f32 v[160:161], v[14:15], v[176:177], v[36:37] op_sel_hi:[0,1,1]
  v_pk_fma_f32 v[164:165], v[18:19], v[180:181], v[52:53] op_sel_hi:[0,1,1]
  v_pk_fma_f32 v[168:169], v[22:23], v[184:185], v[68:69] op_sel_hi:[0,1,1]
  v_pk_fma_f32 v[172:173], v[26:27], v[188:189], v[84:85] op_sel_hi:[0,1,1]
  v_pk_fma_f32 v[162:163], v[14:15], v[178:179], v[100:101] op_sel_hi:[0,1,1]
  v_pk_fma_f32 v[166:167], v[18:19], v[182:183], v[116:117] op_sel_hi:[0,1,1]
  v_pk_fma_f32 v[170:171], v[22:23], v[186:187], v[132:133] op_sel_hi:[0,1,1]
  v_pk_fma_f32 v[174:175], v[26:27], v[190:191], v[148:149] op_sel_hi:[0,1,1]
  v_pk_fma_f32 v[160:161], v[14:15], v[178:179], v[160:161] op_sel:[1,0,0] op_sel_hi:[1,1,1] neg_lo:[1,0,0] neg_hi:[1,0,0]
  v_pk_fma_f32 v[164:165], v[18:19], v[182:183], v[164:165] op_sel:[1,0,0] op_sel_hi:[1,1,1] neg_lo:[1,0,0] neg_hi:[1,0,0]
  v_pk_fma_f32 v[168:169], v[22:23], v[186:187], v[168:169] op_sel:[1,0,0] op_sel_hi:[1,1,1] neg_lo:[1,0,0] neg_hi:[1,0,0]
  v_pk_fma_f32 v[172:173], v[26:27], v[190:191], v[172:173] op_sel:[1,0,0] op_sel_hi:[1,1,1] neg_lo:[1,0,0] neg_hi:[1,0,0]
  v_pk_fma_f32 v[162:163], v[14:15], v[176:177], v[162:163] op_sel:[1,0,0] op_sel_hi:[1,1,1]
  v_pk_fma_f32 v[166:167], v[18:19], v[180:181], v[166:167] op_sel:[1,0,0] op_sel_hi:[1,1,1]
  v_pk_fma_f32 v[170:171], v[22:23], v[184:185], v[170:171] op_sel:[1,0,0] op_sel_hi:[1,1,1]
  v_pk_fma_f32 v[174:175], v[26:27], v[188:189], v[174:175] op_sel:[1,0,0] op_sel_hi:[1,1,1]
  v_pk_fma_f32 v[176:177], v[14:15], v[160:161], v[38:39] op_sel_hi:[0,1,1]
  v_pk_fma_f32 v[180:181], v[18:19], v[164:165], v[54:55] op_sel_hi:[0,1,1]
  v_pk_fma_f32 v[184:185], v[22:23], v[168:169], v[70:71] op_sel_hi:[0,1,1]
  v_pk_fma_f32 v[188:189], v[26:27], v[172:173], v[86:87] op_sel_hi:[0,1,1]
  v_pk_fma_f32 v[178:179], v[14:15], v[162:163], v[102:103] op_sel_hi:[0,1,1]
  v_pk_fma_f32 v[182:183], v[18:19], v[166:167], v[118:119] op_sel_hi:[0,1,1]
  v_pk_fma_f32 v[186:187], v[22:23], v[170:171], v[134:135] op_sel_hi:[0,1,1]
  v_pk_fma_f32 v[190:191], v[26:27], v[174:175], v[150:151] op_sel_hi:[0,1,1]
  v_pk_fma_f32 v[176:177], v[14:15], v[162:163], v[176:177] op_sel:[1,0,0] op_sel_hi:[1,1,1] neg_lo:[1,0,0] neg_hi:[1,0,0]
  v_pk_fma_f32 v[180:181], v[18:19], v[166:167], v[180:181] op_sel:[1,0,0] op_sel_hi:[1,1,1] neg_lo:[1,0,0] neg_hi:[1,0,0]
  v_pk_fma_f32 v[184:185], v[22:23], v[170:171], v[184:185] op_sel:[1,0,0] op_sel_hi:[1,1,1] neg_lo:[1,0,0] neg_hi:[1,0,0]
  v_pk_fma_f32 v[188:189], v[26:27], v[174:175], v[188:189] op_sel:[1,0,0] op_sel_hi:[1,1,1] neg_lo:[1,0,0] neg_hi:[1,0,0]
  v_pk_fma_f32 v[178:179], v[14:15], v[160:161], v[178:179] op_sel:[1,0,0] op_sel_hi:[1,1,1]
  v_pk_fma_f32 v[182:183], v[18:19], v[164:165], v[182:183] op_sel:[1,0,0] op_sel_hi:[1,1,1]
  v_pk_fma_f32 v[186:187], v[22:23], v[168:169], v[186:187] op_sel:[1,0,0] op_sel_hi:[1,1,1]
  v_pk_fma_f32 v[190:191], v[26:27], v[172:173], v[190:191] op_sel:[1,0,0] op_sel_hi:[1,1,1]
  v_pk_fma_f32 v[160:161], v[14:15], v[176:177], v[40:41] op_sel_hi:[0,1,1]
  v_pk_fma_f32 v[164:165], v[18:19], v[180:181], v[56:57] op_sel_hi:[0,1,1]
  v_pk_fma_f32 v[168:169], v[22:23], v[184:185], v[72:73] op_sel_hi:[0,1,1]
  v_pk_fma_f32 v[172:173], v[26:27], v[188:189], v[88:89] op_sel_hi:[0,1,1]
  v_pk_fma_f32 v[162:163], v[14:15], v[178:179], v[104:105] op_sel_hi:[0,1,1]
  v_pk_fma_f32 v[166:167], v[18:19], v[182:183], v[120:121] op_sel_hi:[0,1,1]
  v_pk_fma_f32 v[170:171], v[22:23], v[186:187], v[136:137] op_sel_hi:[0,1,1]
  v_pk_fma_f32 v[174:175], v[26:27], v[190:191], v[152:153] op_sel_hi:[0,1,1]
  v_pk_fma_f32 v[160:161], v[14:15], v[178:179], v[160:161] op_sel:[1,0,0] op_sel_hi:[1,1,1] neg_lo:[1,0,0] neg_hi:[1,0,0]
  v_pk_fma_f32 v[164:165], v[18:19], v[182:183], v[164:165] op_sel:[1,0,0] op_sel_hi:[1,1,1] neg_lo:[1,0,0] neg_hi:[1,0,0]
  v_pk_fma_f32 v[168:169], v[22:23], v[186:187], v[168:169] op_sel:[1,0,0] op_sel_hi:[1,1,1] neg_lo:[1,0,0] neg_hi:[1,0,0]
  v_pk_fma_f32 v[172:173], v[26:27], v[190:191], v[172:173] op_sel:[1,0,0] op_sel_hi:[1,1,1] neg_lo:[1,0,0] neg_hi:[1,0,0]
  v_pk_fma_f32 v[162:163], v[14:15], v[176:177], v[162:163] op_sel:[1,0,0] op_sel_hi:[1,1,1]
  v_pk_fma_f32 v[166:167], v[18:19], v[180:181], v[166:167] op_sel:[1,0,0] op_sel_hi:[1,1,1]
  v_pk_fma_f32 v[170:171], v[22:23], v[184:185], v[170:171] op_sel:[1,0,0] op_sel_hi:[1,1,1]
  v_pk_fma_f32 v[174:175], v[26:27], v[188:189], v[174:175] op_sel:[1,0,0] op_sel_hi:[1,1,1]
  v_pk_fma_f32 v[176:177], v[14:15], v[160:161], v[42:43] op_sel_hi:[0,1,1]
  v_pk_fma_f32 v[180:181], v[18:19], v[164:165], v[58:59] op_sel_hi:[0,1,1]
  v_pk_fma_f32 v[184:185], v[22:23], v[168:169], v[74:75] op_sel_hi:[0,1,1]
  v_pk_fma_f32 v[188:189], v[26:27], v[172:173], v[90:91] op_sel_hi:[0,1,1]
  v_pk_fma_f32 v[178:179], v[14:15], v[162:163], v[106:107] op_sel_hi:[0,1,1]
  v_pk_fma_f32 v[182:183], v[18:19], v[166:167], v[122:123] op_sel_hi:[0,1,1]
  v_pk_fma_f32 v[186:187], v[22:23], v[170:171], v[138:139] op_sel_hi:[0,1,1]
  v_pk_fma_f32 v[190:191], v[26:27], v[174:175], v[154:155] op_sel_hi:[0,1,1]
  v_pk_fma_f32 v[176:177], v[14:15], v[162:163], v[176:177] op_sel:[1,0,0] op_sel_hi:[1,1,1] neg_lo:[1,0,0] neg_hi:[1,0,0]
  v_pk_fma_f32 v[180:181], v[18:19], v[166:167], v[180:181] op_sel:[1,0,0] op_sel_hi:[1,1,1] neg_lo:[1,0,0] neg_hi:[1,0,0]
  v_pk_fma_f32 v[184:185], v[22:23], v[170:171], v[184:185] op_sel:[1,0,0] op_sel_hi:[1,1,1] neg_lo:[1,0,0] neg_hi:[1,0,0]
  v_pk_fma_f32 v[188:189], v[26:27], v[174:175], v[188:189] op_sel:[1,0,0] op_sel_hi:[1,1,1] neg_lo:[1,0,0] neg_hi:[1,0,0]
  v_pk_fma_f32 v[178:179], v[14:15], v[160:161], v[178:179] op_sel:[1,0,0] op_sel_hi:[1,1,1]
  v_pk_fma_f32 v[182:183], v[18:19], v[164:165], v[182:183] op_sel:[1,0,0] op_sel_hi:[1,1,1]
  v_pk_fma_f32 v[186:187], v[22:23], v[168:169], v[186:187] op_sel:[1,0,0] op_sel_hi:[1,1,1]
  v_pk_fma_f32 v[190:191], v[26:27], v[172:173], v[190:191] op_sel:[1,0,0] op_sel_hi:[1,1,1]
  v_pk_fma_f32 v[160:161], v[14:15], v[176:177], v[44:45] op_sel_hi:[0,1,1]
  v_pk_fma_f32 v[164:165], v[18:19], v[180:181], v[60:61] op_sel_hi:[0,1,1]
  v_pk_fma_f32 v[168:169], v[22:23], v[184:185], v[76:77] op_sel_hi:[0,1,1]
  v_pk_fma_f32 v[172:173], v[26:27], v[188:189], v[92:93] op_sel_hi:[0,1,1]
  v_pk_fma_f32 v[162:163], v[14:15], v[178:179], v[108:109] op_sel_hi:[0,1,1]
  v_pk_fma_f32 v[166:167], v[18:19], v[182:183], v[124:125] op_sel_hi:[0,1,1]
  v_pk_fma_f32 v[170:171], v[22:23], v[186:187], v[140:141] op_sel_hi:[0,1,1]
  v_pk_fma_f32 v[174:175], v[26:27], v[190:191], v[156:157] op_sel_hi:[0,1,1]
  v_pk_fma_f32 v[160:161], v[14:15], v[178:179], v[160:161] op_sel:[1,0,0] op_sel_hi:[1,1,1] neg_lo:[1,0,0] neg_hi:[1,0,0]
  v_pk_fma_f32 v[164:165], v[18:19], v[182:183], v[164:165] op_sel:[1,0,0] op_sel_hi:[1,1,1] neg_lo:[1,0,0] neg_hi:[1,0,0]
  v_pk_fma_f32 v[168:169], v[22:23], v[186:187], v[168:169] op_sel:[1,0,0] op_sel_hi:[1,1,1] neg_lo:[1,0,0] neg_hi:[1,0,0]
  v_pk_fma_f32 v[172:173], v[26:27], v[190:191], v[172:173] op_sel:[1,0,0] op_sel_hi:[1,1,1] neg_lo:[1,0,0] neg_hi:[1,0,0]
  v_pk_fma_f32 v[162:163], v[14:15], v[176:177], v[162:163] op_sel:[1,0,0] op_sel_hi:[1,1,1]
  v_pk_fma_f32 v[166:167], v[18:19], v[180:181], v[166:167] op_sel:[1,0,0] op_sel_hi:[1,1,1]
  v_pk_fma_f32 v[170:171], v[22:23], v[184:185], v[170:171] op_sel:[1,0,0] op_sel_hi:[1,1,1]
  v_pk_fma_f32 v[174:175], v[26:27], v[188:189], v[174:175] op_sel:[1,0,0] op_sel_hi:[1,1,1]
  v_pk_fma_f32 v[176:177], v[14:15], v[160:161], v[46:47] op_sel_hi:[0,1,1]
  v_pk_fma_f32 v[180:181], v[18:19], v[164:165], v[62:63] op_sel_hi:[0,1,1]
  v_pk_fma_f32 v[184:185], v[22:23], v[168:169], v[78:79] op_sel_hi:[0,1,1]
  v_pk_fma_f32 v[188:189], v[26:27], v[172:173], v[94:95] op_sel_hi:[0,1,1]
  v_pk_fma_f32 v[178:179], v[14:15], v[162:163], v[110:111] op_sel_hi:[0,1,1]
  v_pk_fma_f32 v[182:183], v[18:19], v[166:167], v[126:127] op_sel_hi:[0,1,1]
  v_pk_fma_f32 v[186:187], v[22:23], v[170:171], v[142:143] op_sel_hi:[0,1,1]
  v_pk_fma_f32 v[190:191], v[26:27], v[174:175], v[158:159] op_sel_hi:[0,1,1]
  v_pk_fma_f32 v[176:177], v[14:15], v[162:163], v[176:177] op_sel:[1,0,0] op_sel_hi:[1,1,1] neg_lo:[1,0,0] neg_hi:[1,0,0]
  v_pk_fma_f32 v[180:181], v[18:19], v[166:167], v[180:181] op_sel:[1,0,0] op_sel_hi:[1,1,1] neg_lo:[1,0,0] neg_hi:[1,0,0]
  v_pk_fma_f32 v[184:185], v[22:23], v[170:171], v[184:185] op_sel:[1,0,0] op_sel_hi:[1,1,1] neg_lo:[1,0,0] neg_hi:[1,0,0]
  v_pk_fma_f32 v[188:189], v[26:27], v[174:175], v[188:189] op_sel:[1,0,0] op_sel_hi:[1,1,1] neg_lo:[1,0,0] neg_hi:[1,0,0]
  v_pk_fma_f32 v[178:179], v[14:15], v[160:161], v[178:179] op_sel:[1,0,0] op_sel_hi:[1,1,1]
  v_pk_fma_f32 v[182:183], v[18:19], v[164:165], v[182:183] op_sel:[1,0,0] op_sel_hi:[1,1,1]
  v_pk_fma_f32 v[186:187], v[22:23], v[168:169], v[186:187] op_sel:[1,0,0] op_sel_hi:[1,1,1]
  v_pk_fma_f32 v[190:191], v[26:27], v[172:173], v[190:191] op_sel:[1,0,0] op_sel_hi:[1,1,1]
  v_fma_f32 v160, v16, v176, v177
  v_fma_f32 v161, v16, v178, v179
  v_fma_f32 v160, -v17, v178, v160
  v_fma_f32 v161, v17, v176, v161
  ds_write_b64 v10, v[160:161] offset:0

  v_fma_f32 v164, v20, v180, v181
  v_fma_f32 v165, v20, v182, v183
  v_fma_f32 v164, -v21, v182, v164
  v_fma_f32 v165, v21, v180, v165
  ds_write_b64 v10, v[164:165] offset:128

  v_fma_f32 v168, v24, v184, v185
  v_fma_f32 v169, v24, v186, v187
  v_fma_f32 v168, -v25, v186, v168
  v_fma_f32 v169, v25, v184, v169
  ds_write_b64 v10, v[168:169] offset:256

  v_fma_f32 v172, v28, v188, v189
  v_fma_f32 v173, v28, v190, v191
  v_fma_f32 v172, -v29, v190, v172
  v_fma_f32 v173, v29, v188, v173
  ds_write_b64 v10, v[172:173] offset:384

  s_mul_i32 s65, s3, 18432
  v_mul_u32_u24 v2, 144, v31
  v_lshl_add_u32 v2, v30, 5, v2
  v_add_u32 v2, s65, v2
  v_bfe_u32 v3, v1, 2, 2
  v_lshl_add_u32 v3, v30, 3, v3
  v_mul_u32_u24 v3, 144, v3
  v_and_b32 v4, 3, v1
  v_lshl_add_u32 v3, v4, 3, v3
  v_add_u32 v3, s65, v3
  v_mov_b32 v13, 158720
  v_mov_b32 v4, 1
  s_mov_b64 exec, 1
  ds_add_u32 v13, v4 offset:20
  s_mov_b64 exec, -1

  s_setprio 1
  v_lshlrev_b32 v13, 3, v31
  v_add_u32 v13, 163328, v13
  ds_read_b64 v[4:5], v13 offset:0
  ds_read_b64 v[6:7], v13 offset:128
  ds_read_b64 v[8:9], v13 offset:256
  ds_read_b64 v[170:171], v13 offset:384
  s_waitcnt lgkmcnt(0)
  v_pk_mul_f32 v[160:161], v[32:33], v[4:5] op_sel:[0,1] op_sel_hi:[1,1]
  v_pk_mul_f32 v[162:163], v[34:35], v[4:5] op_sel:[0,1] op_sel_hi:[1,1]
  v_pk_mul_f32 v[164:165], v[36:37], v[4:5] op_sel:[0,1] op_sel_hi:[1,1]
  v_pk_mul_f32 v[166:167], v[38:39], v[4:5] op_sel:[0,1] op_sel_hi:[1,1]
  v_pk_mul_f32 v[168:169], v[40:41], v[4:5] op_sel:[0,1] op_sel_hi:[1,1]
  v_pk_mul_f32 v[32:33], v[32:33], v[4:5] op_sel:[0,0] op_sel_hi:[1,0]
  v_pk_mul_f32 v[34:35], v[34:35], v[4:5] op_sel:[0,0] op_sel_hi:[1,0]
  v_pk_mul_f32 v[36:37], v[36:37], v[4:5] op_sel:[0,0] op_sel_hi:[1,0]
  v_pk_mul_f32 v[38:39], v[38:39], v[4:5] op_sel:[0,0] op_sel_hi:[1,0]
  v_pk_mul_f32 v[40:41], v[40:41], v[4:5] op_sel:[0,0] op_sel_hi:[1,0]
  v_pk_fma_f32 v[32:33], v[96:97], v[4:5], v[32:33] op_sel:[0,1,0] op_sel_hi:[1,1,1] neg_lo:[0,1,0] neg_hi:[0,1,0]
  v_pk_fma_f32 v[34:35], v[98:99], v[4:5], v[34:35] op_sel:[0,1,0] op_sel_hi:[1,1,1] neg_lo:[0,1,0] neg_hi:[0,1,0]
  v_pk_fma_f32 v[36:37], v[100:101], v[4:5], v[36:37] op_sel:[0,1,0] op_sel_hi:[1,1,1] neg_lo:[0,1,0] neg_hi:[0,1,0]
  v_pk_fma_f32 v[38:39], v[102:103], v[4:5], v[38:39] op_sel:[0,1,0] op_sel_hi:[1,1,1] neg_lo:[0,1,0] neg_hi:[0,1,0]
  v_pk_fma_f32 v[40:41], v[104:105], v[4:5], v[40:41] op_sel:[0,1,0] op_sel_hi:[1,1,1] neg_lo:[0,1,0] neg_hi:[0,1,0]
  v_pk_fma_f32 v[96:97], v[96:97], v[4:5], v[160:161] op_sel:[0,0,0] op_sel_hi:[1,0,1]
  v_pk_fma_f32 v[98:99], v[98:99], v[4:5], v[162:163] op_sel:[0,0,0] op_sel_hi:[1,0,1]
  v_pk_fma_f32 v[100:101], v[100:101], v[4:5], v[164:165] op_sel:[0,0,0] op_sel_hi:[1,0,1]
  v_pk_fma_f32 v[102:103], v[102:103], v[4:5], v[166:167] op_sel:[0,0,0] op_sel_hi:[1,0,1]
  v_pk_fma_f32 v[104:105], v[104:105], v[4:5], v[168:169] op_sel:[0,0,0] op_sel_hi:[1,0,1]
  v_pk_mul_f32 v[160:161], v[42:43], v[4:5] op_sel:[0,1] op_sel_hi:[1,1]
  v_pk_mul_f32 v[162:163], v[44:45], v[4:5] op_sel:[0,1] op_sel_hi:[1,1]
  v_pk_mul_f32 v[164:165], v[46:47], v[4:5] op_sel:[0,1] op_sel_hi:[1,1]
  v_pk_mul_f32 v[166:167], v[176:177], v[4:5] op_sel:[0,1] op_sel_hi:[1,1]
  v_pk_mul_f32 v[42:43], v[42:43], v[4:5] op_sel:[0,0] op_sel_hi:[1,0]
  v_pk_mul_f32 v[44:45], v[44:45], v[4:5] op_sel:[0,0] op_sel_hi:[1,0]
  v_pk_mul_f32 v[46:47], v[46:47], v[4:5] op_sel:[0,0] op_sel_hi:[1,0]
  v_pk_mul_f32 v[176:177], v[176:177], v[4:5] op_sel:[0,0] op_sel_hi:[1,0]
  v_pk_fma_f32 v[42:43], v[106:107], v[4:5], v[42:43] op_sel:[0,1,0] op_sel_hi:[1,1,1] neg_lo:[0,1,0] neg_hi:[0,1,0]
  v_pk_fma_f32 v[44:45], v[108:109], v[4:5], v[44:45] op_sel:[0,1,0] op_sel_hi:[1,1,1] neg_lo:[0,1,0] neg_hi:[0,1,0]
  v_pk_fma_f32 v[46:47], v[110:111], v[4:5], v[46:47] op_sel:[0,1,0] op_sel_hi:[1,1,1] neg_lo:[0,1,0] neg_hi:[0,1,0]
  v_pk_fma_f32 v[176:177], v[178:179], v[4:5], v[176:177] op_sel:[0,1,0] op_sel_hi:[1,1,1] neg_lo:[0,1,0] neg_hi:[0,1,0]
  v_pk_fma_f32 v[106:107], v[106:107], v[4:5], v[160:161] op_sel:[0,0,0] op_sel_hi:[1,0,1]
  v_pk_fma_f32 v[108:109], v[108:109], v[4:5], v[162:163] op_sel:[0,0,0] op_sel_hi:[1,0,1]
  v_pk_fma_f32 v[110:111], v[110:111], v[4:5], v[164:165] op_sel:[0,0,0] op_sel_hi:[1,0,1]
  v_pk_fma_f32 v[178:179], v[178:179], v[4:5], v[166:167] op_sel:[0,0,0] op_sel_hi:[1,0,1]
  v_pk_mul_f32 v[160:161], v[48:49], v[6:7] op_sel:[0,1] op_sel_hi:[1,1]
  v_pk_mul_f32 v[162:163], v[50:51], v[6:7] op_sel:[0,1] op_sel_hi:[1,1]
  v_pk_mul_f32 v[164:165], v[52:53], v[6:7] op_sel:[0,1] op_sel_hi:[1,1]
  v_pk_mul_f32 v[166:167], v[54:55], v[6:7] op_sel:[0,1] op_sel_hi:[1,1]
  v_pk_mul_f32 v[168:169], v[56:57], v[6:7] op_sel:[0,1] op_sel_hi:[1,1]
  v_pk_mul_f32 v[48:49], v[48:49], v[6:7] op_sel:[0,0] op_sel_hi:[1,0]
  v_pk_mul_f32 v[50:51], v[50:51], v[6:7] op_sel:[0,0] op_sel_hi:[1,0]
  v_pk_mul_f32 v[52:53], v[52:53], v[6:7] op_sel:[0,0] op_sel_hi:[1,0]
  v_pk_mul_f32 v[54:55], v[54:55], v[6:7] op_sel:[0,0] op_sel_hi:[1,0]
  v_pk_mul_f32 v[56:57], v[56:57], v[6:7] op_sel:[0,0] op_sel_hi:[1,0]
  v_pk_fma_f32 v[48:49], v[112:113], v[6:7], v[48:49] op_sel:[0,1,0] op_sel_hi:[1,1,1] neg_lo:[0,1,0] neg_hi:[0,1,0]
  v_pk_fma_f32 v[50:51], v[114:115], v[6:7], v[50:51] op_sel:[0,1,0] op_sel_hi:[1,1,1] neg_lo:[0,1,0] neg_hi:[0,1,0]
  v_pk_fma_f32 v[52:53], v[116:117], v[6:7], v[52:53] op_sel:[0,1,0] op_sel_hi:[1,1,1] neg_lo:[0,1,0] neg_hi:[0,1,0]
  v_pk_fma_f32 v[54:55], v[118:119], v[6:7], v[54:55] op_sel:[0,1,0] op_sel_hi:[1,1,1] neg_lo:[0,1,0] neg_hi:[0,1,0]
  v_pk_fma_f32 v[56:57], v[120:121], v[6:7], v[56:57] op_sel:[0,1,0] op_sel_hi:[1,1,1] neg_lo:[0,1,0] neg_hi:[0,1,0]
  v_pk_fma_f32 v[112:113], v[112:113], v[6:7], v[160:161] op_sel:[0,0,0] op_sel_hi:[1,0,1]
  v_pk_fma_f32 v[114:115], v[114:115], v[6:7], v[162:163] op_sel:[0,0,0] op_sel_hi:[1,0,1]
  v_pk_fma_f32 v[116:117], v[116:117], v[6:7], v[164:165] op_sel:[0,0,0] op_sel_hi:[1,0,1]
  v_pk_fma_f32 v[118:119], v[118:119], v[6:7], v[166:167] op_sel:[0,0,0] op_sel_hi:[1,0,1]
  v_pk_fma_f32 v[120:121], v[120:121], v[6:7], v[168:169] op_sel:[0,0,0] op_sel_hi:[1,0,1]
  v_pk_mul_f32 v[160:161], v[58:59], v[6:7] op_sel:[0,1] op_sel_hi:[1,1]
  v_pk_mul_f32 v[162:163], v[60:61], v[6:7] op_sel:[0,1] op_sel_hi:[1,1]
  v_pk_mul_f32 v[164:165], v[62:63], v[6:7] op_sel:[0,1] op_sel_hi:[1,1]
  v_pk_mul_f32 v[166:167], v[180:181], v[6:7] op_sel:[0,1] op_sel_hi:[1,1]
  v_pk_mul_f32 v[58:59], v[58:59], v[6:7] op_sel:[0,0] op_sel_hi:[1,0]
  v_pk_mul_f32 v[60:61], v[60:61], v[6:7] op_sel:[0,0] op_sel_hi:[1,0]
  v_pk_mul_f32 v[62:63], v[62:63], v[6:7] op_sel:[0,0] op_sel_hi:[1,0]
  v_pk_mul_f32 v[180:181], v[180:181], v[6:7] op_sel:[0,0] op_sel_hi:[1,0]
  v_pk_fma_f32 v[58:59], v[122:123], v[6:7], v[58:59] op_sel:[0,1,0] op_sel_hi:[1,1,1] neg_lo:[0,1,0] neg_hi:[0,1,0]
  v_pk_fma_f32 v[60:61], v[124:125], v[6:7], v[60:61] op_sel:[0,1,0] op_sel_hi:[1,1,1] neg_lo:[0,1,0] neg_hi:[0,1,0]
  v_pk_fma_f32 v[62:63], v[126:127], v[6:7], v[62:63] op_sel:[0,1,0] op_sel_hi:[1,1,1] neg_lo:[0,1,0] neg_hi:[0,1,0]
  v_pk_fma_f32 v[180:181], v[182:183], v[6:7], v[180:181] op_sel:[0,1,0] op_sel_hi:[1,1,1] neg_lo:[0,1,0] neg_hi:[0,1,0]
  v_pk_fma_f32 v[122:123], v[122:123], v[6:7], v[160:161] op_sel:[0,0,0] op_sel_hi:[1,0,1]
  v_pk_fma_f32 v[124:125], v[124:125], v[6:7], v[162:163] op_sel:[0,0,0] op_sel_hi:[1,0,1]
  v_pk_fma_f32 v[126:127], v[126:127], v[6:7], v[164:165] op_sel:[0,0,0] op_sel_hi:[1,0,1]
  v_pk_fma_f32 v[182:183], v[182:183], v[6:7], v[166:167] op_sel:[0,0,0] op_sel_hi:[1,0,1]
  v_pk_mul_f32 v[160:161], v[64:65], v[8:9] op_sel:[0,1] op_sel_hi:[1,1]
  v_pk_mul_f32 v[162:163], v[66:67], v[8:9] op_sel:[0,1] op_sel_hi:[1,1]
  v_pk_mul_f32 v[164:165], v[68:69], v[8:9] op_sel:[0,1] op_sel_hi:[1,1]
  v_pk_mul_f32 v[166:167], v[70:71], v[8:9] op_sel:[0,1] op_sel_hi:[1,1]
  v_pk_mul_f32 v[168:169], v[72:73], v[8:9] op_sel:[0,1] op_sel_hi:[1,1]
  v_pk_mul_f32 v[64:65], v[64:65], v[8:9] op_sel:[0,0] op_sel_hi:[1,0]
  v_pk_mul_f32 v[66:67], v[66:67], v[8:9] op_sel:[0,0] op_sel_hi:[1,0]
  v_pk_mul_f32 v[68:69], v[68:69], v[8:9] op_sel:[0,0] op_sel_hi:[1,0]
  v_pk_mul_f32 v[70:71], v[70:71], v[8:9] op_sel:[0,0] op_sel_hi:[1,0]
  v_pk_mul_f32 v[72:73], v[72:73], v[8:9] op_sel:[0,0] op_sel_hi:[1,0]
  v_pk_fma_f32 v[64:65], v[128:129], v[8:9], v[64:65] op_sel:[0,1,0] op_sel_hi:[1,1,1] neg_lo:[0,1,0] neg_hi:[0,1,0]
  v_pk_fma_f32 v[66:67], v[130:131], v[8:9], v[66:67] op_sel:[0,1,0] op_sel_hi:[1,1,1] neg_lo:[0,1,0] neg_hi:[0,1,0]
  v_pk_fma_f32 v[68:69], v[132:133], v[8:9], v[68:69] op_sel:[0,1,0] op_sel_hi:[1,1,1] neg_lo:[0,1,0] neg_hi:[0,1,0]
  v_pk_fma_f32 v[70:71], v[134:135], v[8:9], v[70:71] op_sel:[0,1,0] op_sel_hi:[1,1,1] neg_lo:[0,1,0] neg_hi:[0,1,0]
  v_pk_fma_f32 v[72:73], v[136:137], v[8:9], v[72:73] op_sel:[0,1,0] op_sel_hi:[1,1,1] neg_lo:[0,1,0] neg_hi:[0,1,0]
  v_pk_fma_f32 v[128:129], v[128:129], v[8:9], v[160:161] op_sel:[0,0,0] op_sel_hi:[1,0,1]
  v_pk_fma_f32 v[130:131], v[130:131], v[8:9], v[162:163] op_sel:[0,0,0] op_sel_hi:[1,0,1]
  v_pk_fma_f32 v[132:133], v[132:133], v[8:9], v[164:165] op_sel:[0,0,0] op_sel_hi:[1,0,1]
  v_pk_fma_f32 v[134:135], v[134:135], v[8:9], v[166:167] op_sel:[0,0,0] op_sel_hi:[1,0,1]
  v_pk_fma_f32 v[136:137], v[136:137], v[8:9], v[168:169] op_sel:[0,0,0] op_sel_hi:[1,0,1]
  v_pk_mul_f32 v[160:161], v[74:75], v[8:9] op_sel:[0,1] op_sel_hi:[1,1]
  v_pk_mul_f32 v[162:163], v[76:77], v[8:9] op_sel:[0,1] op_sel_hi:[1,1]
  v_pk_mul_f32 v[164:165], v[78:79], v[8:9] op_sel:[0,1] op_sel_hi:[1,1]
  v_pk_mul_f32 v[166:167], v[184:185], v[8:9] op_sel:[0,1] op_sel_hi:[1,1]
  v_pk_mul_f32 v[74:75], v[74:75], v[8:9] op_sel:[0,0] op_sel_hi:[1,0]
  v_pk_mul_f32 v[76:77], v[76:77], v[8:9] op_sel:[0,0] op_sel_hi:[1,0]
  v_pk_mul_f32 v[78:79], v[78:79], v[8:9] op_sel:[0,0] op_sel_hi:[1,0]
  v_pk_mul_f32 v[184:185], v[184:185], v[8:9] op_sel:[0,0] op_sel_hi:[1,0]
  v_pk_fma_f32 v[74:75], v[138:139], v[8:9], v[74:75] op_sel:[0,1,0] op_sel_hi:[1,1,1] neg_lo:[0,1,0] neg_hi:[0,1,0]
  v_pk_fma_f32 v[76:77], v[140:141], v[8:9], v[76:77] op_sel:[0,1,0] op_sel_hi:[1,1,1] neg_lo:[0,1,0] neg_hi:[0,1,0]
  v_pk_fma_f32 v[78:79], v[142:143], v[8:9], v[78:79] op_sel:[0,1,0] op_sel_hi:[1,1,1] neg_lo:[0,1,0] neg_hi:[0,1,0]
  v_pk_fma_f32 v[184:185], v[186:187], v[8:9], v[184:185] op_sel:[0,1,0] op_sel_hi:[1,1,1] neg_lo:[0,1,0] neg_hi:[0,1,0]
  v_pk_fma_f32 v[138:139], v[138:139], v[8:9], v[160:161] op_sel:[0,0,0] op_sel_hi:[1,0,1]
  v_pk_fma_f32 v[140:141], v[140:141], v[8:9], v[162:163] op_sel:[0,0,0] op_sel_hi:[1,0,1]
  v_pk_fma_f32 v[142:143], v[142:143], v[8:9], v[164:165] op_sel:[0,0,0] op_sel_hi:[1,0,1]
  v_pk_fma_f32 v[186:187], v[186:187], v[8:9], v[166:167] op_sel:[0,0,0] op_sel_hi:[1,0,1]
  v_pk_mul_f32 v[160:161], v[80:81], v[170:171] op_sel:[0,1] op_sel_hi:[1,1]
  v_pk_mul_f32 v[162:163], v[82:83], v[170:171] op_sel:[0,1] op_sel_hi:[1,1]
  v_pk_mul_f32 v[164:165], v[84:85], v[170:171] op_sel:[0,1] op_sel_hi:[1,1]
  v_pk_mul_f32 v[166:167], v[86:87], v[170:171] op_sel:[0,1] op_sel_hi:[1,1]
  v_pk_mul_f32 v[168:169], v[88:89], v[170:171] op_sel:[0,1] op_sel_hi:[1,1]
  v_pk_mul_f32 v[80:81], v[80:81], v[170:171] op_sel:[0,0] op_sel_hi:[1,0]
  v_pk_mul_f32 v[82:83], v[82:83], v[170:171] op_sel:[0,0] op_sel_hi:[1,0]
  v_pk_mul_f32 v[84:85], v[84:85], v[170:171] op_sel:[0,0] op_sel_hi:[1,0]
  v_pk_mul_f32 v[86:87], v[86:87], v[170:171] op_sel:[0,0] op_sel_hi:[1,0]
  v_pk_mul_f32 v[88:89], v[88:89], v[170:171] op_sel:[0,0] op_sel_hi:[1,0]
  v_pk_fma_f32 v[80:81], v[144:145], v[170:171], v[80:81] op_sel:[0,1,0] op_sel_hi:[1,1,1] neg_lo:[0,1,0] neg_hi:[0,1,0]
  v_pk_fma_f32 v[82:83], v[146:147], v[170:171], v[82:83] op_sel:[0,1,0] op_sel_hi:[1,1,1] neg_lo:[0,1,0] neg_hi:[0,1,0]
  v_pk_fma_f32 v[84:85], v[148:149], v[170:171], v[84:85] op_sel:[0,1,0] op_sel_hi:[1,1,1] neg_lo:[0,1,0] neg_hi:[0,1,0]
  v_pk_fma_f32 v[86:87], v[150:151], v[170:171], v[86:87] op_sel:[0,1,0] op_sel_hi:[1,1,1] neg_lo:[0,1,0] neg_hi:[0,1,0]
  v_pk_fma_f32 v[88:89], v[152:153], v[170:171], v[88:89] op_sel:[0,1,0] op_sel_hi:[1,1,1] neg_lo:[0,1,0] neg_hi:[0,1,0]
  v_pk_fma_f32 v[144:145], v[144:145], v[170:171], v[160:161] op_sel:[0,0,0] op_sel_hi:[1,0,1]
  v_pk_fma_f32 v[146:147], v[146:147], v[170:171], v[162:163] op_sel:[0,0,0] op_sel_hi:[1,0,1]
  v_pk_fma_f32 v[148:149], v[148:149], v[170:171], v[164:165] op_sel:[0,0,0] op_sel_hi:[1,0,1]
  v_pk_fma_f32 v[150:151], v[150:151], v[170:171], v[166:167] op_sel:[0,0,0] op_sel_hi:[1,0,1]
  v_pk_fma_f32 v[152:153], v[152:153], v[170:171], v[168:169] op_sel:[0,0,0] op_sel_hi:[1,0,1]
  v_pk_mul_f32 v[160:161], v[90:91], v[170:171] op_sel:[0,1] op_sel_hi:[1,1]
  v_pk_mul_f32 v[162:163], v[92:93], v[170:171] op_sel:[0,1] op_sel_hi:[1,1]
  v_pk_mul_f32 v[164:165], v[94:95], v[170:171] op_sel:[0,1] op_sel_hi:[1,1]
  v_pk_mul_f32 v[166:167], v[188:189], v[170:171] op_sel:[0,1] op_sel_hi:[1,1]
  v_pk_mul_f32 v[90:91], v[90:91], v[170:171] op_sel:[0,0] op_sel_hi:[1,0]
  v_pk_mul_f32 v[92:93], v[92:93], v[170:171] op_sel:[0,0] op_sel_hi:[1,0]
  v_pk_mul_f32 v[94:95], v[94:95], v[170:171] op_sel:[0,0] op_sel_hi:[1,0]
  v_pk_mul_f32 v[188:189], v[188:189], v[170:171] op_sel:[0,0] op_sel_hi:[1,0]
  v_pk_fma_f32 v[90:91], v[154:155], v[170:171], v[90:91] op_sel:[0,1,0] op_sel_hi:[1,1,1] neg_lo:[0,1,0] neg_hi:[0,1,0]
  v_pk_fma_f32 v[92:93], v[156:157], v[170:171], v[92:93] op_sel:[0,1,0] op_sel_hi:[1,1,1] neg_lo:[0,1,0] neg_hi:[0,1,0]
  v_pk_fma_f32 v[94:95], v[158:159], v[170:171], v[94:95] op_sel:[0,1,0] op_sel_hi:[1,1,1] neg_lo:[0,1,0] neg_hi:[0,1,0]
  v_pk_fma_f32 v[188:189], v[190:191], v[170:171], v[188:189] op_sel:[0,1,0] op_sel_hi:[1,1,1] neg_lo:[0,1,0] neg_hi:[0,1,0]
  v_pk_fma_f32 v[154:155], v[154:155], v[170:171], v[160:161] op_sel:[0,0,0] op_sel_hi:[1,0,1]
  v_pk_fma_f32 v[156:157], v[156:157], v[170:171], v[162:163] op_sel:[0,0,0] op_sel_hi:[1,0,1]
  v_pk_fma_f32 v[158:159], v[158:159], v[170:171], v[164:165] op_sel:[0,0,0] op_sel_hi:[1,0,1]
  v_pk_fma_f32 v[190:191], v[190:191], v[170:171], v[166:167] op_sel:[0,0,0] op_sel_hi:[1,0,1]
  v_mov_b32 v13, 158720
  s_mov_b32 s67, 0
K1_SS:
  ds_read_b32 v4, v13 offset:24
  s_add_u32 s67, s67, 1
  s_waitcnt lgkmcnt(0)
  v_readfirstlane_b32 s66, v4
  s_cmp_lg_u32 s66, 0
  s_cbranch_scc1 K1_SS_OK
  s_cmp_ge_u32 s67, 1000000
  s_cbranch_scc1 K1_SS_OK
  s_sleep 1
  s_branch K1_SS

K1_SS_OK:
  s_setprio 3
  ds_read_b32 v160, v10 offset:0
  ds_read_b32 v162, v10 offset:4
  ds_read_b32 v164, v10 offset:128
  ds_read_b32 v166, v10 offset:132
  ds_read_b32 v168, v10 offset:256
  ds_read_b32 v170, v10 offset:260
  ds_read_b32 v172, v10 offset:384
  ds_read_b32 v174, v10 offset:388
  s_waitcnt lgkmcnt(0)
  v_fma_f32 v161, v16, v160, v176
  v_fma_f32 v163, v16, v162, v178
  v_fma_f32 v161, -v17, v162, v161
  v_fma_f32 v163, v17, v160, v163

  v_fma_f32 v165, v20, v164, v180
  v_fma_f32 v167, v20, v166, v182
  v_fma_f32 v165, -v21, v166, v165
  v_fma_f32 v167, v21, v164, v167

  v_fma_f32 v169, v24, v168, v184
  v_fma_f32 v171, v24, v170, v186
  v_fma_f32 v169, -v25, v170, v169
  v_fma_f32 v171, v25, v168, v171

  v_fma_f32 v173, v28, v172, v188
  v_fma_f32 v175, v28, v174, v190
  v_fma_f32 v173, -v29, v174, v173
  v_fma_f32 v175, v29, v172, v175

  v_pk_fma_f32 v[32:33], v[14:15], v[160:161], v[32:33] op_sel_hi:[0,1,1]
  v_pk_fma_f32 v[96:97], v[14:15], v[162:163], v[96:97] op_sel_hi:[0,1,1]
  v_pk_fma_f32 v[48:49], v[18:19], v[164:165], v[48:49] op_sel_hi:[0,1,1]
  v_pk_fma_f32 v[112:113], v[18:19], v[166:167], v[112:113] op_sel_hi:[0,1,1]
  v_pk_fma_f32 v[32:33], v[14:15], v[162:163], v[32:33] op_sel:[1,0,0] op_sel_hi:[1,1,1] neg_lo:[1,0,0] neg_hi:[1,0,0]
  v_pk_fma_f32 v[96:97], v[14:15], v[160:161], v[96:97] op_sel:[1,0,0] op_sel_hi:[1,1,1]
  v_pk_fma_f32 v[48:49], v[18:19], v[166:167], v[48:49] op_sel:[1,0,0] op_sel_hi:[1,1,1] neg_lo:[1,0,0] neg_hi:[1,0,0]
  v_pk_fma_f32 v[112:113], v[18:19], v[164:165], v[112:113] op_sel:[1,0,0] op_sel_hi:[1,1,1]
  v_pk_fma_f32 v[34:35], v[14:15], v[32:33], v[34:35] op_sel_hi:[0,1,1]
  v_pk_fma_f32 v[98:99], v[14:15], v[96:97], v[98:99] op_sel_hi:[0,1,1]
  v_pk_fma_f32 v[50:51], v[18:19], v[48:49], v[50:51] op_sel_hi:[0,1,1]
  v_pk_fma_f32 v[114:115], v[18:19], v[112:113], v[114:115] op_sel_hi:[0,1,1]
  v_pk_fma_f32 v[34:35], v[14:15], v[96:97], v[34:35] op_sel:[1,0,0] op_sel_hi:[1,1,1] neg_lo:[1,0,0] neg_hi:[1,0,0]
  v_pk_fma_f32 v[98:99], v[14:15], v[32:33], v[98:99] op_sel:[1,0,0] op_sel_hi:[1,1,1]
  v_pk_fma_f32 v[50:51], v[18:19], v[112:113], v[50:51] op_sel:[1,0,0] op_sel_hi:[1,1,1] neg_lo:[1,0,0] neg_hi:[1,0,0]
  v_pk_fma_f32 v[114:115], v[18:19], v[48:49], v[114:115] op_sel:[1,0,0] op_sel_hi:[1,1,1]
  v_pk_fma_f32 v[36:37], v[14:15], v[34:35], v[36:37] op_sel_hi:[0,1,1]
  v_pk_fma_f32 v[100:101], v[14:15], v[98:99], v[100:101] op_sel_hi:[0,1,1]
  v_pk_fma_f32 v[52:53], v[18:19], v[50:51], v[52:53] op_sel_hi:[0,1,1]
  v_pk_fma_f32 v[116:117], v[18:19], v[114:115], v[116:117] op_sel_hi:[0,1,1]
  v_pk_fma_f32 v[36:37], v[14:15], v[98:99], v[36:37] op_sel:[1,0,0] op_sel_hi:[1,1,1] neg_lo:[1,0,0] neg_hi:[1,0,0]
  v_pk_fma_f32 v[100:101], v[14:15], v[34:35], v[100:101] op_sel:[1,0,0] op_sel_hi:[1,1,1]
  v_pk_fma_f32 v[52:53], v[18:19], v[114:115], v[52:53] op_sel:[1,0,0] op_sel_hi:[1,1,1] neg_lo:[1,0,0] neg_hi:[1,0,0]
  v_pk_fma_f32 v[116:117], v[18:19], v[50:51], v[116:117] op_sel:[1,0,0] op_sel_hi:[1,1,1]
  v_pk_fma_f32 v[38:39], v[14:15], v[36:37], v[38:39] op_sel_hi:[0,1,1]
  v_pk_fma_f32 v[102:103], v[14:15], v[100:101], v[102:103] op_sel_hi:[0,1,1]
  v_pk_fma_f32 v[54:55], v[18:19], v[52:53], v[54:55] op_sel_hi:[0,1,1]
  v_pk_fma_f32 v[118:119], v[18:19], v[116:117], v[118:119] op_sel_hi:[0,1,1]
  v_pk_fma_f32 v[38:39], v[14:15], v[100:101], v[38:39] op_sel:[1,0,0] op_sel_hi:[1,1,1] neg_lo:[1,0,0] neg_hi:[1,0,0]
  v_pk_fma_f32 v[102:103], v[14:15], v[36:37], v[102:103] op_sel:[1,0,0] op_sel_hi:[1,1,1]
  v_pk_fma_f32 v[54:55], v[18:19], v[116:117], v[54:55] op_sel:[1,0,0] op_sel_hi:[1,1,1] neg_lo:[1,0,0] neg_hi:[1,0,0]
  v_pk_fma_f32 v[118:119], v[18:19], v[52:53], v[118:119] op_sel:[1,0,0] op_sel_hi:[1,1,1]
  v_pk_fma_f32 v[40:41], v[14:15], v[38:39], v[40:41] op_sel_hi:[0,1,1]
  v_pk_fma_f32 v[104:105], v[14:15], v[102:103], v[104:105] op_sel_hi:[0,1,1]
  v_pk_fma_f32 v[56:57], v[18:19], v[54:55], v[56:57] op_sel_hi:[0,1,1]
  v_pk_fma_f32 v[120:121], v[18:19], v[118:119], v[120:121] op_sel_hi:[0,1,1]
  v_pk_fma_f32 v[40:41], v[14:15], v[102:103], v[40:41] op_sel:[1,0,0] op_sel_hi:[1,1,1] neg_lo:[1,0,0] neg_hi:[1,0,0]
  v_pk_fma_f32 v[104:105], v[14:15], v[38:39], v[104:105] op_sel:[1,0,0] op_sel_hi:[1,1,1]
  v_pk_fma_f32 v[56:57], v[18:19], v[118:119], v[56:57] op_sel:[1,0,0] op_sel_hi:[1,1,1] neg_lo:[1,0,0] neg_hi:[1,0,0]
  v_pk_fma_f32 v[120:121], v[18:19], v[54:55], v[120:121] op_sel:[1,0,0] op_sel_hi:[1,1,1]
  v_pk_fma_f32 v[42:43], v[14:15], v[40:41], v[42:43] op_sel_hi:[0,1,1]
  v_pk_fma_f32 v[106:107], v[14:15], v[104:105], v[106:107] op_sel_hi:[0,1,1]
  v_pk_fma_f32 v[58:59], v[18:19], v[56:57], v[58:59] op_sel_hi:[0,1,1]
  v_pk_fma_f32 v[122:123], v[18:19], v[120:121], v[122:123] op_sel_hi:[0,1,1]
  v_pk_fma_f32 v[42:43], v[14:15], v[104:105], v[42:43] op_sel:[1,0,0] op_sel_hi:[1,1,1] neg_lo:[1,0,0] neg_hi:[1,0,0]
  v_pk_fma_f32 v[106:107], v[14:15], v[40:41], v[106:107] op_sel:[1,0,0] op_sel_hi:[1,1,1]
  v_pk_fma_f32 v[58:59], v[18:19], v[120:121], v[58:59] op_sel:[1,0,0] op_sel_hi:[1,1,1] neg_lo:[1,0,0] neg_hi:[1,0,0]
  v_pk_fma_f32 v[122:123], v[18:19], v[56:57], v[122:123] op_sel:[1,0,0] op_sel_hi:[1,1,1]
  v_pk_fma_f32 v[44:45], v[14:15], v[42:43], v[44:45] op_sel_hi:[0,1,1]
  v_pk_fma_f32 v[108:109], v[14:15], v[106:107], v[108:109] op_sel_hi:[0,1,1]
  v_pk_fma_f32 v[60:61], v[18:19], v[58:59], v[60:61] op_sel_hi:[0,1,1]
  v_pk_fma_f32 v[124:125], v[18:19], v[122:123], v[124:125] op_sel_hi:[0,1,1]
  v_pk_fma_f32 v[44:45], v[14:15], v[106:107], v[44:45] op_sel:[1,0,0] op_sel_hi:[1,1,1] neg_lo:[1,0,0] neg_hi:[1,0,0]
  v_pk_fma_f32 v[108:109], v[14:15], v[42:43], v[108:109] op_sel:[1,0,0] op_sel_hi:[1,1,1]
  v_pk_fma_f32 v[60:61], v[18:19], v[122:123], v[60:61] op_sel:[1,0,0] op_sel_hi:[1,1,1] neg_lo:[1,0,0] neg_hi:[1,0,0]
  v_pk_fma_f32 v[124:125], v[18:19], v[58:59], v[124:125] op_sel:[1,0,0] op_sel_hi:[1,1,1]
  v_pk_fma_f32 v[46:47], v[14:15], v[44:45], v[46:47] op_sel_hi:[0,1,1]
  v_pk_fma_f32 v[110:111], v[14:15], v[108:109], v[110:111] op_sel_hi:[0,1,1]
  v_pk_fma_f32 v[62:63], v[18:19], v[60:61], v[62:63] op_sel_hi:[0,1,1]
  v_pk_fma_f32 v[126:127], v[18:19], v[124:125], v[126:127] op_sel_hi:[0,1,1]
  v_pk_fma_f32 v[46:47], v[14:15], v[108:109], v[46:47] op_sel:[1,0,0] op_sel_hi:[1,1,1] neg_lo:[1,0,0] neg_hi:[1,0,0]
  v_pk_fma_f32 v[110:111], v[14:15], v[44:45], v[110:111] op_sel:[1,0,0] op_sel_hi:[1,1,1]
  v_pk_fma_f32 v[62:63], v[18:19], v[124:125], v[62:63] op_sel:[1,0,0] op_sel_hi:[1,1,1] neg_lo:[1,0,0] neg_hi:[1,0,0]
  v_pk_fma_f32 v[126:127], v[18:19], v[60:61], v[126:127] op_sel:[1,0,0] op_sel_hi:[1,1,1]
  v_cvt_pk_bf16_f32 v176, v32, v34
  v_cvt_pk_bf16_f32 v180, v33, v35
  v_cvt_pk_bf16_f32 v177, v36, v38
  v_cvt_pk_bf16_f32 v181, v37, v39
  v_cvt_pk_bf16_f32 v178, v40, v42
  v_cvt_pk_bf16_f32 v182, v41, v43
  v_cvt_pk_bf16_f32 v179, v44, v46
  v_cvt_pk_bf16_f32 v183, v45, v47
  ds_write_b128 v2, v[176:179] offset:0
  ds_write_b128 v2, v[180:183] offset:16
  v_cvt_pk_bf16_f32 v184, v48, v50
  v_cvt_pk_bf16_f32 v188, v49, v51
  v_cvt_pk_bf16_f32 v185, v52, v54
  v_cvt_pk_bf16_f32 v189, v53, v55
  v_cvt_pk_bf16_f32 v186, v56, v58
  v_cvt_pk_bf16_f32 v190, v57, v59
  v_cvt_pk_bf16_f32 v187, v60, v62
  v_cvt_pk_bf16_f32 v191, v61, v63
  ds_write_b128 v2, v[184:187] offset:2304
  ds_write_b128 v2, v[188:191] offset:2320
  v_cvt_pk_bf16_f32 v176, -v96, -v98
  v_cvt_pk_bf16_f32 v180, -v97, -v99
  v_cvt_pk_bf16_f32 v177, -v100, -v102
  v_cvt_pk_bf16_f32 v181, -v101, -v103
  v_cvt_pk_bf16_f32 v178, -v104, -v106
  v_cvt_pk_bf16_f32 v182, -v105, -v107
  v_cvt_pk_bf16_f32 v179, -v108, -v110
  v_cvt_pk_bf16_f32 v183, -v109, -v111
  ds_write_b128 v2, v[176:179] offset:9216
  ds_write_b128 v2, v[180:183] offset:9232
  v_cvt_pk_bf16_f32 v184, -v112, -v114
  v_cvt_pk_bf16_f32 v188, -v113, -v115
  v_cvt_pk_bf16_f32 v185, -v116, -v118
  v_cvt_pk_bf16_f32 v189, -v117, -v119
  v_cvt_pk_bf16_f32 v186, -v120, -v122
  v_cvt_pk_bf16_f32 v190, -v121, -v123
  v_cvt_pk_bf16_f32 v187, -v124, -v126
  v_cvt_pk_bf16_f32 v191, -v125, -v127
  ds_write_b128 v2, v[184:187] offset:11520
  ds_write_b128 v2, v[188:191] offset:11536
  v_pk_fma_f32 v[64:65], v[22:23], v[168:169], v[64:65] op_sel_hi:[0,1,1]
  v_pk_fma_f32 v[128:129], v[22:23], v[170:171], v[128:129] op_sel_hi:[0,1,1]
  v_pk_fma_f32 v[80:81], v[26:27], v[172:173], v[80:81] op_sel_hi:[0,1,1]
  v_pk_fma_f32 v[144:145], v[26:27], v[174:175], v[144:145] op_sel_hi:[0,1,1]
  v_pk_fma_f32 v[64:65], v[22:23], v[170:171], v[64:65] op_sel:[1,0,0] op_sel_hi:[1,1,1] neg_lo:[1,0,0] neg_hi:[1,0,0]
  v_pk_fma_f32 v[128:129], v[22:23], v[168:169], v[128:129] op_sel:[1,0,0] op_sel_hi:[1,1,1]
  v_pk_fma_f32 v[80:81], v[26:27], v[174:175], v[80:81] op_sel:[1,0,0] op_sel_hi:[1,1,1] neg_lo:[1,0,0] neg_hi:[1,0,0]
  s_waitcnt lgkmcnt(0)
  v_pk_fma_f32 v[144:145], v[26:27], v[172:173], v[144:145] op_sel:[1,0,0] op_sel_hi:[1,1,1]
  ds_read_b64_tr_b16 v[32:33], v3 offset:0
  v_pk_fma_f32 v[66:67], v[22:23], v[64:65], v[66:67] op_sel_hi:[0,1,1]
  ds_read_b64_tr_b16 v[34:35], v3 offset:576
  v_pk_fma_f32 v[130:131], v[22:23], v[128:129], v[130:131] op_sel_hi:[0,1,1]
  ds_read_b64_tr_b16 v[36:37], v3 offset:32
  v_pk_fma_f32 v[82:83], v[26:27], v[80:81], v[82:83] op_sel_hi:[0,1,1]
  ds_read_b64_tr_b16 v[38:39], v3 offset:608
  v_pk_fma_f32 v[146:147], v[26:27], v[144:145], v[146:147] op_sel_hi:[0,1,1]
  ds_read_b64_tr_b16 v[40:41], v3 offset:64
  v_pk_fma_f32 v[66:67], v[22:23], v[128:129], v[66:67] op_sel:[1,0,0] op_sel_hi:[1,1,1] neg_lo:[1,0,0] neg_hi:[1,0,0]
  ds_read_b64_tr_b16 v[42:43], v3 offset:640
  v_pk_fma_f32 v[130:131], v[22:23], v[64:65], v[130:131] op_sel:[1,0,0] op_sel_hi:[1,1,1]
  ds_read_b64_tr_b16 v[44:45], v3 offset:96
  v_pk_fma_f32 v[82:83], v[26:27], v[144:145], v[82:83] op_sel:[1,0,0] op_sel_hi:[1,1,1] neg_lo:[1,0,0] neg_hi:[1,0,0]
  ds_read_b64_tr_b16 v[46:47], v3 offset:672
  v_pk_fma_f32 v[146:147], v[26:27], v[80:81], v[146:147] op_sel:[1,0,0] op_sel_hi:[1,1,1]
  ds_read_b64_tr_b16 v[96:97], v3 offset:9216
  v_pk_fma_f32 v[68:69], v[22:23], v[66:67], v[68:69] op_sel_hi:[0,1,1]
  ds_read_b64_tr_b16 v[98:99], v3 offset:9792
  v_pk_fma_f32 v[132:133], v[22:23], v[130:131], v[132:133] op_sel_hi:[0,1,1]
  ds_read_b64_tr_b16 v[100:101], v3 offset:9248
  v_pk_fma_f32 v[84:85], v[26:27], v[82:83], v[84:85] op_sel_hi:[0,1,1]
  ds_read_b64_tr_b16 v[102:103], v3 offset:9824
  v_pk_fma_f32 v[148:149], v[26:27], v[146:147], v[148:149] op_sel_hi:[0,1,1]
  ds_read_b64_tr_b16 v[104:105], v3 offset:9280
  v_pk_fma_f32 v[68:69], v[22:23], v[130:131], v[68:69] op_sel:[1,0,0] op_sel_hi:[1,1,1] neg_lo:[1,0,0] neg_hi:[1,0,0]
  ds_read_b64_tr_b16 v[106:107], v3 offset:9856
  v_pk_fma_f32 v[132:133], v[22:23], v[66:67], v[132:133] op_sel:[1,0,0] op_sel_hi:[1,1,1]
  ds_read_b64_tr_b16 v[108:109], v3 offset:9312
  v_pk_fma_f32 v[84:85], v[26:27], v[146:147], v[84:85] op_sel:[1,0,0] op_sel_hi:[1,1,1] neg_lo:[1,0,0] neg_hi:[1,0,0]
  ds_read_b64_tr_b16 v[110:111], v3 offset:9888
  v_pk_fma_f32 v[148:149], v[26:27], v[82:83], v[148:149] op_sel:[1,0,0] op_sel_hi:[1,1,1]
  v_pk_fma_f32 v[70:71], v[22:23], v[68:69], v[70:71] op_sel_hi:[0,1,1]
  v_pk_fma_f32 v[134:135], v[22:23], v[132:133], v[134:135] op_sel_hi:[0,1,1]
  v_pk_fma_f32 v[86:87], v[26:27], v[84:85], v[86:87] op_sel_hi:[0,1,1]
  v_pk_fma_f32 v[150:151], v[26:27], v[148:149], v[150:151] op_sel_hi:[0,1,1]
  v_pk_fma_f32 v[70:71], v[22:23], v[132:133], v[70:71] op_sel:[1,0,0] op_sel_hi:[1,1,1] neg_lo:[1,0,0] neg_hi:[1,0,0]
  v_pk_fma_f32 v[134:135], v[22:23], v[68:69], v[134:135] op_sel:[1,0,0] op_sel_hi:[1,1,1]
  v_pk_fma_f32 v[86:87], v[26:27], v[148:149], v[86:87] op_sel:[1,0,0] op_sel_hi:[1,1,1] neg_lo:[1,0,0] neg_hi:[1,0,0]
  v_pk_fma_f32 v[150:151], v[26:27], v[84:85], v[150:151] op_sel:[1,0,0] op_sel_hi:[1,1,1]
  s_waitcnt lgkmcnt(0)
  v_pk_fma_f32 v[72:73], v[22:23], v[70:71], v[72:73] op_sel_hi:[0,1,1]
  s_add_u32 s65, s64, 0
  buffer_store_dwordx4 v[32:35], v12, s[16:19], s65 offen sc1
  v_pk_fma_f32 v[136:137], v[22:23], v[134:135], v[136:137] op_sel_hi:[0,1,1]
  s_add_u32 s65, s64, 98304
  buffer_store_dwordx4 v[36:39], v12, s[16:19], s65 offen sc1
  v_pk_fma_f32 v[88:89], v[26:27], v[86:87], v[88:89] op_sel_hi:[0,1,1]
  s_add_u32 s65, s64, 196608
  buffer_store_dwordx4 v[40:43], v12, s[16:19], s65 offen sc1
  v_pk_fma_f32 v[152:153], v[26:27], v[150:151], v[152:153] op_sel_hi:[0,1,1]
  s_add_u32 s65, s64, 294912
  buffer_store_dwordx4 v[44:47], v12, s[16:19], s65 offen sc1
  v_pk_fma_f32 v[72:73], v[22:23], v[134:135], v[72:73] op_sel:[1,0,0] op_sel_hi:[1,1,1] neg_lo:[1,0,0] neg_hi:[1,0,0]
  s_add_u32 s65, s64, 2048
  buffer_store_dwordx4 v[96:99], v12, s[16:19], s65 offen sc1
  v_pk_fma_f32 v[136:137], v[22:23], v[70:71], v[136:137] op_sel:[1,0,0] op_sel_hi:[1,1,1]
  s_add_u32 s65, s64, 100352
  buffer_store_dwordx4 v[100:103], v12, s[16:19], s65 offen sc1
  v_pk_fma_f32 v[88:89], v[26:27], v[150:151], v[88:89] op_sel:[1,0,0] op_sel_hi:[1,1,1] neg_lo:[1,0,0] neg_hi:[1,0,0]
  s_add_u32 s65, s64, 198656
  buffer_store_dwordx4 v[104:107], v12, s[16:19], s65 offen sc1
  v_pk_fma_f32 v[152:153], v[26:27], v[86:87], v[152:153] op_sel:[1,0,0] op_sel_hi:[1,1,1]
  s_add_u32 s65, s64, 296960
  buffer_store_dwordx4 v[108:111], v12, s[16:19], s65 offen sc1
  v_pk_fma_f32 v[74:75], v[22:23], v[72:73], v[74:75] op_sel_hi:[0,1,1]
  v_pk_fma_f32 v[138:139], v[22:23], v[136:137], v[138:139] op_sel_hi:[0,1,1]
  v_pk_fma_f32 v[90:91], v[26:27], v[88:89], v[90:91] op_sel_hi:[0,1,1]
  v_pk_fma_f32 v[154:155], v[26:27], v[152:153], v[154:155] op_sel_hi:[0,1,1]
  v_pk_fma_f32 v[74:75], v[22:23], v[136:137], v[74:75] op_sel:[1,0,0] op_sel_hi:[1,1,1] neg_lo:[1,0,0] neg_hi:[1,0,0]
  v_pk_fma_f32 v[138:139], v[22:23], v[72:73], v[138:139] op_sel:[1,0,0] op_sel_hi:[1,1,1]
  v_pk_fma_f32 v[90:91], v[26:27], v[152:153], v[90:91] op_sel:[1,0,0] op_sel_hi:[1,1,1] neg_lo:[1,0,0] neg_hi:[1,0,0]
  v_pk_fma_f32 v[154:155], v[26:27], v[88:89], v[154:155] op_sel:[1,0,0] op_sel_hi:[1,1,1]
  v_pk_fma_f32 v[76:77], v[22:23], v[74:75], v[76:77] op_sel_hi:[0,1,1]
  v_pk_fma_f32 v[140:141], v[22:23], v[138:139], v[140:141] op_sel_hi:[0,1,1]
  v_pk_fma_f32 v[92:93], v[26:27], v[90:91], v[92:93] op_sel_hi:[0,1,1]
  v_pk_fma_f32 v[156:157], v[26:27], v[154:155], v[156:157] op_sel_hi:[0,1,1]
  v_pk_fma_f32 v[76:77], v[22:23], v[138:139], v[76:77] op_sel:[1,0,0] op_sel_hi:[1,1,1] neg_lo:[1,0,0] neg_hi:[1,0,0]
  v_pk_fma_f32 v[140:141], v[22:23], v[74:75], v[140:141] op_sel:[1,0,0] op_sel_hi:[1,1,1]
  v_pk_fma_f32 v[92:93], v[26:27], v[154:155], v[92:93] op_sel:[1,0,0] op_sel_hi:[1,1,1] neg_lo:[1,0,0] neg_hi:[1,0,0]
  v_pk_fma_f32 v[156:157], v[26:27], v[90:91], v[156:157] op_sel:[1,0,0] op_sel_hi:[1,1,1]
  v_pk_fma_f32 v[78:79], v[22:23], v[76:77], v[78:79] op_sel_hi:[0,1,1]
  v_pk_fma_f32 v[142:143], v[22:23], v[140:141], v[142:143] op_sel_hi:[0,1,1]
  v_pk_fma_f32 v[94:95], v[26:27], v[92:93], v[94:95] op_sel_hi:[0,1,1]
  v_pk_fma_f32 v[158:159], v[26:27], v[156:157], v[158:159] op_sel_hi:[0,1,1]
  v_pk_fma_f32 v[78:79], v[22:23], v[140:141], v[78:79] op_sel:[1,0,0] op_sel_hi:[1,1,1] neg_lo:[1,0,0] neg_hi:[1,0,0]
  v_pk_fma_f32 v[142:143], v[22:23], v[76:77], v[142:143] op_sel:[1,0,0] op_sel_hi:[1,1,1]
  v_pk_fma_f32 v[94:95], v[26:27], v[156:157], v[94:95] op_sel:[1,0,0] op_sel_hi:[1,1,1] neg_lo:[1,0,0] neg_hi:[1,0,0]
  v_pk_fma_f32 v[158:159], v[26:27], v[92:93], v[158:159] op_sel:[1,0,0] op_sel_hi:[1,1,1]
  v_cvt_pk_bf16_f32 v160, v64, v66
  v_cvt_pk_bf16_f32 v164, v65, v67
  v_cvt_pk_bf16_f32 v161, v68, v70
  v_cvt_pk_bf16_f32 v165, v69, v71
  v_cvt_pk_bf16_f32 v162, v72, v74
  v_cvt_pk_bf16_f32 v166, v73, v75
  v_cvt_pk_bf16_f32 v163, v76, v78
  v_cvt_pk_bf16_f32 v167, v77, v79
  ds_write_b128 v2, v[160:163] offset:4608
  ds_write_b128 v2, v[164:167] offset:4624
  v_cvt_pk_bf16_f32 v168, v80, v82
  v_cvt_pk_bf16_f32 v172, v81, v83
  v_cvt_pk_bf16_f32 v169, v84, v86
  v_cvt_pk_bf16_f32 v173, v85, v87
  v_cvt_pk_bf16_f32 v170, v88, v90
  v_cvt_pk_bf16_f32 v174, v89, v91
  v_cvt_pk_bf16_f32 v171, v92, v94
  v_cvt_pk_bf16_f32 v175, v93, v95
  ds_write_b128 v2, v[168:171] offset:6912
  ds_write_b128 v2, v[172:175] offset:6928
  v_cvt_pk_bf16_f32 v160, -v128, -v130
  v_cvt_pk_bf16_f32 v164, -v129, -v131
  v_cvt_pk_bf16_f32 v161, -v132, -v134
  v_cvt_pk_bf16_f32 v165, -v133, -v135
  v_cvt_pk_bf16_f32 v162, -v136, -v138
  v_cvt_pk_bf16_f32 v166, -v137, -v139
  v_cvt_pk_bf16_f32 v163, -v140, -v142
  v_cvt_pk_bf16_f32 v167, -v141, -v143
  ds_write_b128 v2, v[160:163] offset:13824
  ds_write_b128 v2, v[164:167] offset:13840
  v_cvt_pk_bf16_f32 v168, -v144, -v146
  v_cvt_pk_bf16_f32 v172, -v145, -v147
  v_cvt_pk_bf16_f32 v169, -v148, -v150
  v_cvt_pk_bf16_f32 v173, -v149, -v151
  v_cvt_pk_bf16_f32 v170, -v152, -v154
  v_cvt_pk_bf16_f32 v174, -v153, -v155
  v_cvt_pk_bf16_f32 v171, -v156, -v158
  v_cvt_pk_bf16_f32 v175, -v157, -v159
  ds_write_b128 v2, v[168:171] offset:16128
  ds_write_b128 v2, v[172:175] offset:16144
  s_waitcnt lgkmcnt(0)
  ds_read_b64_tr_b16 v[64:65], v3 offset:4608
  ds_read_b64_tr_b16 v[66:67], v3 offset:5184
  ds_read_b64_tr_b16 v[68:69], v3 offset:4640
  ds_read_b64_tr_b16 v[70:71], v3 offset:5216
  ds_read_b64_tr_b16 v[72:73], v3 offset:4672
  ds_read_b64_tr_b16 v[74:75], v3 offset:5248
  ds_read_b64_tr_b16 v[76:77], v3 offset:4704
  ds_read_b64_tr_b16 v[78:79], v3 offset:5280
  ds_read_b64_tr_b16 v[128:129], v3 offset:13824
  ds_read_b64_tr_b16 v[130:131], v3 offset:14400
  ds_read_b64_tr_b16 v[132:133], v3 offset:13856
  ds_read_b64_tr_b16 v[134:135], v3 offset:14432
  ds_read_b64_tr_b16 v[136:137], v3 offset:13888
  ds_read_b64_tr_b16 v[138:139], v3 offset:14464
  ds_read_b64_tr_b16 v[140:141], v3 offset:13920
  ds_read_b64_tr_b16 v[142:143], v3 offset:14496
  s_waitcnt lgkmcnt(14)
  s_add_u32 s65, s64, 1024
  buffer_store_dwordx4 v[64:67], v12, s[16:19], s65 offen sc1
  s_waitcnt lgkmcnt(12)
  s_add_u32 s65, s64, 99328
  buffer_store_dwordx4 v[68:71], v12, s[16:19], s65 offen sc1
  s_waitcnt lgkmcnt(10)
  s_add_u32 s65, s64, 197632
  buffer_store_dwordx4 v[72:75], v12, s[16:19], s65 offen sc1
  s_waitcnt lgkmcnt(8)
  s_add_u32 s65, s64, 295936
  buffer_store_dwordx4 v[76:79], v12, s[16:19], s65 offen sc1
  s_waitcnt lgkmcnt(6)
  s_add_u32 s65, s64, 3072
  buffer_store_dwordx4 v[128:131], v12, s[16:19], s65 offen sc1
  s_waitcnt lgkmcnt(4)
  s_add_u32 s65, s64, 101376
  buffer_store_dwordx4 v[132:135], v12, s[16:19], s65 offen sc1
  s_waitcnt lgkmcnt(2)
  s_add_u32 s65, s64, 199680
  buffer_store_dwordx4 v[136:139], v12, s[16:19], s65 offen sc1
  s_waitcnt lgkmcnt(0)
  s_add_u32 s65, s64, 297984
  buffer_store_dwordx4 v[140:143], v12, s[16:19], s65 offen sc1
  s_branch K1_CFLAG
K1_HELPER:
  s_and_b32 s43, s3, 1
  s_lshl_b32 s64, s62, 8
  s_lshl_b32 s65, s43, 7
  s_add_u32 s64, s64, s65
  v_lshrrev_b32 v20, 3, v1
  v_and_b32 v21, 7, v1

  s_cmp_lt_u32 s63, 10
  s_cbranch_scc1 K1_HSSM
  s_mul_i32 s66, s43, 10240
  s_add_u32 s66, s66, 98304
  v_add_u32 v18, s66, v11
  v_add_u32 v53, s64, v1
  v_lshlrev_b32 v53, 3, v53

  s_lshl_b32 s66, s62, 8
  s_lshl_b32 s67, s35, 3
  s_add_u32 s66, s66, s67
  s_lshl_b32 s67, s43, 2
  s_add_u32 s66, s66, s67
  s_mul_i32 s94, s66, 1280
  v_mul_u32_u24 v54, 1280, v30
  v_lshl_add_u32 v54, v31, 4, v54
  v_add_u32 v26, s66, v30
  v_lshlrev_b32 v26, 3, v26

  buffer_load_dwordx4 v[60:63], v54, s[8:11], s94 offen offset:0
  buffer_load_dwordx4 v[64:67], v54, s[8:11], s94 offen offset:256
  buffer_load_dwordx4 v[68:71], v54, s[8:11], s94 offen offset:512
  buffer_load_dwordx4 v[72:75], v54, s[8:11], s94 offen offset:768
  buffer_load_dwordx4 v[76:79], v54, s[8:11], s94 offen offset:1024
  s_mov_b32 s20, s54
  s_mov_b32 s21, s55
  s_mov_b32 s22, 256
  s_mov_b32 s23, 0x20000
  v_mov_b32 v55, 0
  s_or_b32 s66, s2, s43
  s_cmp_lg_u32 s66, 0
  s_cbranch_scc1 K1_E0_5
  s_memrealtime s[66:67]
  s_waitcnt lgkmcnt(0)
  s_or_b32 s66, s66, 1
  v_mov_b32 v52, s66
  s_mov_b64 exec, 1
  buffer_store_dword v52, v55, s[20:23], 0 offen sc1
  s_mov_b64 exec, -1

K1_E0_5:
  s_add_u32 s24, s4, 23068672
  s_addc_u32 s25, s5, 0
  s_mov_b32 s26, 16384
  s_mov_b32 s27, 0x20000
  s_add_u32 s28, s4, 24117248
  s_addc_u32 s29, s5, 0
  s_mov_b32 s30, 327680
  s_mov_b32 s31, 0x20000
  v_mov_b32 v32, 0
  v_mov_b32 v33, 0
  v_mov_b32 v34, 0
  v_mov_b32 v35, 0
  v_mov_b32 v36, 0
  v_mov_b32 v37, 0
  v_mov_b32 v38, 0
  v_mov_b32 v39, 0
  v_mov_b32 v40, 0
  v_mov_b32 v41, 0
  v_mov_b32 v42, 0
  v_mov_b32 v43, 0
  v_mov_b32 v44, 0
  v_mov_b32 v45, 0
  v_mov_b32 v46, 0
  v_mov_b32 v47, 0
  v_mov_b32 v48, 0
  v_mov_b32 v49, 0
  v_mov_b32 v50, 0
  v_mov_b32 v51, 0
  v_mov_b32 v128, 0
  v_mov_b32 v129, 0
  v_mov_b32 v130, 0
  v_mov_b32 v131, 0
  v_mov_b32 v132, 0
  v_mov_b32 v133, 0
  v_mov_b32 v134, 0
  v_mov_b32 v135, 0
  v_mov_b32 v136, 0
  v_mov_b32 v137, 0
  v_mov_b32 v138, 0
  v_mov_b32 v139, 0
  v_mov_b32 v140, 0
  v_mov_b32 v141, 0
  v_mov_b32 v142, 0
  v_mov_b32 v143, 0
  v_mov_b32 v144, 0
  v_mov_b32 v145, 0
  v_mov_b32 v146, 0
  v_mov_b32 v147, 0
  v_mov_b32 v56, 0x3f803f80
  v_mov_b32 v57, 0x3f803f80
  v_mov_b32 v58, 0x3f803f80
  v_mov_b32 v59, 0x3f803f80
  s_lshl_b32 s92, s35, 3
  s_add_u32 s93, s92, s62
  s_lshl_b32 s93, s93, 1
  s_add_u32 s93, s93, s43
  s_mul_i32 s93, s93, 640
  s_lshl_b32 s92, s92, 1
  s_add_u32 s92, s92, s43
  s_mul_i32 s92, s92, 640
  v_lshlrev_b32 v19, 2, v1
  v_lshlrev_b32 v17, 3, v1

  s_cmp_eq_u32 s43, 0
  s_cselect_b32 s12, s56, s58
  s_cselect_b32 s13, s57, s59
  s_mov_b32 s14, 2211840
  s_mov_b32 s15, 0x20000
  s_mul_i32 s42, s43, 10240
  s_add_u32 s42, s42, 98304

  s_sub_u32 s40, s35, 10
  s_mul_i32 s40, s40, 160
  v_add_u32 v22, 0, v1
  v_mul_u32_u24 v23, 6554, v22
  v_lshrrev_b32 v23, 16, v23
  v_mul_u32_u24 v24, 10, v23
  v_sub_u32 v24, v22, v24
  v_and_b32 v25, 0x33, v23
  v_bfe_u32 v6, v23, 2, 1
  v_lshl_or_b32 v25, v6, 3, v25
  v_bfe_u32 v6, v23, 3, 1
  v_lshl_or_b32 v25, v6, 2, v25
  v_mul_u32_u24 v25, 3456, v25
  v_lshl_add_u32 v2, v24, 4, v25

  v_add_u32 v22, 64, v1
  v_mul_u32_u24 v23, 6554, v22
  v_lshrrev_b32 v23, 16, v23
  v_mul_u32_u24 v24, 10, v23
  v_sub_u32 v24, v22, v24
  v_and_b32 v25, 0x33, v23
  v_bfe_u32 v6, v23, 2, 1
  v_lshl_or_b32 v25, v6, 3, v25
  v_bfe_u32 v6, v23, 3, 1
  v_lshl_or_b32 v25, v6, 2, v25
  v_mul_u32_u24 v25, 3456, v25
  v_lshl_add_u32 v3, v24, 4, v25

  v_add_u32 v22, 128, v1
  v_mul_u32_u24 v23, 6554, v22
  v_lshrrev_b32 v23, 16, v23
  v_mul_u32_u24 v24, 10, v23
  v_sub_u32 v24, v22, v24
  v_and_b32 v25, 0x33, v23
  v_bfe_u32 v6, v23, 2, 1
  v_lshl_or_b32 v25, v6, 3, v25
  v_bfe_u32 v6, v23, 3, 1
  v_lshl_or_b32 v25, v6, 2, v25
  v_mul_u32_u24 v25, 3456, v25
  v_lshl_add_u32 v4, v24, 4, v25

  v_add_u32 v22, 192, v1
  v_mul_u32_u24 v23, 6554, v22
  v_lshrrev_b32 v23, 16, v23
  v_mul_u32_u24 v24, 10, v23
  v_sub_u32 v24, v22, v24
  v_and_b32 v25, 0x33, v23
  v_bfe_u32 v6, v23, 2, 1
  v_lshl_or_b32 v25, v6, 3, v25
  v_bfe_u32 v6, v23, 3, 1
  v_lshl_or_b32 v25, v6, 2, v25
  v_mul_u32_u24 v25, 3456, v25
  v_lshl_add_u32 v5, v24, 4, v25

  v_add_u32 v22, 256, v1
  v_mul_u32_u24 v23, 6554, v22
  v_lshrrev_b32 v23, 16, v23
  v_mul_u32_u24 v24, 10, v23
  v_sub_u32 v24, v22, v24
  v_and_b32 v25, 0x33, v23
  v_bfe_u32 v6, v23, 2, 1
  v_lshl_or_b32 v25, v6, 3, v25
  v_bfe_u32 v6, v23, 3, 1
  v_lshl_or_b32 v25, v6, 2, v25
  v_mul_u32_u24 v25, 3456, v25
  v_lshl_add_u32 v12, v24, 4, v25

  s_waitcnt vmcnt(0)
  v_lshlrev_b32 v148, 16, v60
  v_and_b32 v149, 0xffff0000, v60
  v_lshlrev_b32 v150, 16, v61
  v_and_b32 v151, 0xffff0000, v61
  v_lshlrev_b32 v152, 16, v62
  v_and_b32 v153, 0xffff0000, v62
  v_lshlrev_b32 v154, 16, v63
  v_and_b32 v155, 0xffff0000, v63
  v_lshlrev_b32 v156, 16, v64
  v_and_b32 v157, 0xffff0000, v64
  v_lshlrev_b32 v158, 16, v65
  v_and_b32 v159, 0xffff0000, v65
  v_lshlrev_b32 v160, 16, v66
  v_and_b32 v161, 0xffff0000, v66
  v_lshlrev_b32 v162, 16, v67
  v_and_b32 v163, 0xffff0000, v67
  v_lshlrev_b32 v164, 16, v68
  v_and_b32 v165, 0xffff0000, v68
  v_lshlrev_b32 v166, 16, v69
  v_and_b32 v167, 0xffff0000, v69
  v_lshlrev_b32 v168, 16, v70
  v_and_b32 v169, 0xffff0000, v70
  v_lshlrev_b32 v170, 16, v71
  v_and_b32 v171, 0xffff0000, v71
  v_lshlrev_b32 v172, 16, v72
  v_and_b32 v173, 0xffff0000, v72
  v_lshlrev_b32 v174, 16, v73
  v_and_b32 v175, 0xffff0000, v73
  v_lshlrev_b32 v176, 16, v74
  v_and_b32 v177, 0xffff0000, v74
  v_lshlrev_b32 v178, 16, v75
  v_and_b32 v179, 0xffff0000, v75
  v_lshlrev_b32 v180, 16, v76
  v_and_b32 v181, 0xffff0000, v76
  v_lshlrev_b32 v182, 16, v77
  v_and_b32 v183, 0xffff0000, v77
  v_lshlrev_b32 v184, 16, v78
  v_and_b32 v185, 0xffff0000, v78
  v_lshlrev_b32 v186, 16, v79
  v_and_b32 v187, 0xffff0000, v79
  v_pk_add_f32 v[22:23], v[148:149], v[150:151]
  v_pk_add_f32 v[28:29], v[152:153], v[154:155]
  v_pk_add_f32 v[22:23], v[22:23], v[156:157]
  v_pk_add_f32 v[28:29], v[28:29], v[158:159]
  v_pk_add_f32 v[22:23], v[22:23], v[160:161]
  v_pk_add_f32 v[28:29], v[28:29], v[162:163]
  v_pk_add_f32 v[22:23], v[22:23], v[164:165]
  v_pk_add_f32 v[28:29], v[28:29], v[166:167]
  v_pk_add_f32 v[22:23], v[22:23], v[168:169]
  v_pk_add_f32 v[28:29], v[28:29], v[170:171]
  v_pk_add_f32 v[22:23], v[22:23], v[172:173]
  v_pk_add_f32 v[28:29], v[28:29], v[174:175]
  v_pk_add_f32 v[22:23], v[22:23], v[176:177]
  v_pk_add_f32 v[28:29], v[28:29], v[178:179]
  v_pk_add_f32 v[22:23], v[22:23], v[180:181]
  v_pk_add_f32 v[28:29], v[28:29], v[182:183]
  v_pk_add_f32 v[22:23], v[22:23], v[184:185]
  v_pk_add_f32 v[28:29], v[28:29], v[186:187]
  v_pk_add_f32 v[22:23], v[22:23], v[28:29]
  s_nop 0
  v_add_f32 v22, v22, v23
  s_nop 1
  v_add_f32_dpp v22, v22, v22 row_ror:8 row_mask:0xf bank_mask:0xf
  s_nop 1
  v_add_f32_dpp v22, v22, v22 row_ror:4 row_mask:0xf bank_mask:0xf
  s_nop 1
  v_add_f32_dpp v22, v22, v22 row_ror:2 row_mask:0xf bank_mask:0xf
  s_nop 1
  v_add_f32_dpp v22, v22, v22 row_ror:1 row_mask:0xf bank_mask:0xf
  v_mul_f32 v80, 0x3acccccd, v22
  buffer_load_dword v52, v55, s[20:23], 0 offen sc1
  s_barrier
  s_mov_b32 s67, 0
K1_EP_6:
  s_waitcnt vmcnt(0)
  v_readfirstlane_b32 s95, v52
  s_add_u32 s67, s67, 1
  s_cmp_lg_u32 s95, 0
  s_cbranch_scc1 K1_EO_7
  s_sleep 4
  buffer_load_dword v52, v55, s[20:23], 0 offen sc1
  s_cmp_lt_u32 s67, 100000
  s_cbranch_scc1 K1_EP_6

K1_EO_7:
  v_pk_add_f32 v[148:149], v[148:149], v[80:81] op_sel_hi:[1,0] neg_lo:[0,1] neg_hi:[0,1]
  v_pk_add_f32 v[150:151], v[150:151], v[80:81] op_sel_hi:[1,0] neg_lo:[0,1] neg_hi:[0,1]
  v_pk_add_f32 v[152:153], v[152:153], v[80:81] op_sel_hi:[1,0] neg_lo:[0,1] neg_hi:[0,1]
  v_pk_add_f32 v[154:155], v[154:155], v[80:81] op_sel_hi:[1,0] neg_lo:[0,1] neg_hi:[0,1]
  v_pk_add_f32 v[156:157], v[156:157], v[80:81] op_sel_hi:[1,0] neg_lo:[0,1] neg_hi:[0,1]
  v_pk_add_f32 v[158:159], v[158:159], v[80:81] op_sel_hi:[1,0] neg_lo:[0,1] neg_hi:[0,1]
  v_pk_add_f32 v[160:161], v[160:161], v[80:81] op_sel_hi:[1,0] neg_lo:[0,1] neg_hi:[0,1]
  v_pk_add_f32 v[162:163], v[162:163], v[80:81] op_sel_hi:[1,0] neg_lo:[0,1] neg_hi:[0,1]
  v_pk_add_f32 v[164:165], v[164:165], v[80:81] op_sel_hi:[1,0] neg_lo:[0,1] neg_hi:[0,1]
  v_pk_add_f32 v[166:167], v[166:167], v[80:81] op_sel_hi:[1,0] neg_lo:[0,1] neg_hi:[0,1]
  v_pk_add_f32 v[168:169], v[168:169], v[80:81] op_sel_hi:[1,0] neg_lo:[0,1] neg_hi:[0,1]
  v_pk_add_f32 v[170:171], v[170:171], v[80:81] op_sel_hi:[1,0] neg_lo:[0,1] neg_hi:[0,1]
  v_pk_add_f32 v[172:173], v[172:173], v[80:81] op_sel_hi:[1,0] neg_lo:[0,1] neg_hi:[0,1]
  v_pk_add_f32 v[174:175], v[174:175], v[80:81] op_sel_hi:[1,0] neg_lo:[0,1] neg_hi:[0,1]
  v_pk_add_f32 v[176:177], v[176:177], v[80:81] op_sel_hi:[1,0] neg_lo:[0,1] neg_hi:[0,1]
  v_pk_add_f32 v[178:179], v[178:179], v[80:81] op_sel_hi:[1,0] neg_lo:[0,1] neg_hi:[0,1]
  v_pk_add_f32 v[180:181], v[180:181], v[80:81] op_sel_hi:[1,0] neg_lo:[0,1] neg_hi:[0,1]
  v_pk_add_f32 v[182:183], v[182:183], v[80:81] op_sel_hi:[1,0] neg_lo:[0,1] neg_hi:[0,1]
  v_pk_add_f32 v[184:185], v[184:185], v[80:81] op_sel_hi:[1,0] neg_lo:[0,1] neg_hi:[0,1]
  v_pk_add_f32 v[186:187], v[186:187], v[80:81] op_sel_hi:[1,0] neg_lo:[0,1] neg_hi:[0,1]
  v_pk_mul_f32 v[22:23], v[148:149], v[148:149]
  v_pk_mul_f32 v[28:29], v[150:151], v[150:151]
  v_pk_fma_f32 v[22:23], v[152:153], v[152:153], v[22:23]
  v_pk_fma_f32 v[28:29], v[154:155], v[154:155], v[28:29]
  v_pk_fma_f32 v[22:23], v[156:157], v[156:157], v[22:23]
  v_pk_fma_f32 v[28:29], v[158:159], v[158:159], v[28:29]
  v_pk_fma_f32 v[22:23], v[160:161], v[160:161], v[22:23]
  v_pk_fma_f32 v[28:29], v[162:163], v[162:163], v[28:29]
  v_pk_fma_f32 v[22:23], v[164:165], v[164:165], v[22:23]
  v_pk_fma_f32 v[28:29], v[166:167], v[166:167], v[28:29]
  v_pk_fma_f32 v[22:23], v[168:169], v[168:169], v[22:23]
  v_pk_fma_f32 v[28:29], v[170:171], v[170:171], v[28:29]
  v_pk_fma_f32 v[22:23], v[172:173], v[172:173], v[22:23]
  v_pk_fma_f32 v[28:29], v[174:175], v[174:175], v[28:29]
  v_pk_fma_f32 v[22:23], v[176:177], v[176:177], v[22:23]
  v_pk_fma_f32 v[28:29], v[178:179], v[178:179], v[28:29]
  v_pk_fma_f32 v[22:23], v[180:181], v[180:181], v[22:23]
  v_pk_fma_f32 v[28:29], v[182:183], v[182:183], v[28:29]
  v_pk_fma_f32 v[22:23], v[184:185], v[184:185], v[22:23]
  v_pk_fma_f32 v[28:29], v[186:187], v[186:187], v[28:29]
  v_pk_add_f32 v[22:23], v[22:23], v[28:29]
  s_nop 0
  v_add_f32 v25, v22, v23
  s_nop 1
  v_add_f32_dpp v25, v25, v25 row_ror:8 row_mask:0xf bank_mask:0xf
  s_nop 1
  v_add_f32_dpp v25, v25, v25 row_ror:4 row_mask:0xf bank_mask:0xf
  s_nop 1
  v_add_f32_dpp v25, v25, v25 row_ror:2 row_mask:0xf bank_mask:0xf
  s_nop 1
  v_add_f32_dpp v25, v25, v25 row_ror:1 row_mask:0xf bank_mask:0xf
  v_mul_f32 v25, 0x3acccccd, v25
  v_cvt_pk_bf16_f32 v25, v25, v25
  v_lshlrev_b32 v25, 16, v25
  v_add_f32 v25, 0x3727c5ac, v25
  v_cvt_pk_bf16_f32 v25, v25, v25
  v_lshlrev_b32 v25, 16, v25
  v_sqrt_f32 v25, v25
  s_nop 0
  v_cvt_pk_bf16_f32 v24, v25, v80
  v_mov_b32 v25, s95
  s_mov_b32 exec_lo, 0x10001
  s_mov_b32 exec_hi, 0x10001
  buffer_store_dwordx2 v[24:25], v26, s[24:27], 0 offen sc1
  s_mov_b64 exec, -1

  s_cmp_lg_u32 s62, 0
  s_cbranch_scc1 K1_LC_8
  s_add_u32 s93, s92, 0
  ds_read_b64_tr_b16 v[88:89], v18 offset:0
  ds_read_b64_tr_b16 v[90:91], v18 offset:1280
  ds_read_b64_tr_b16 v[92:93], v18 offset:32
  ds_read_b64_tr_b16 v[94:95], v18 offset:1312
  ds_read_b64_tr_b16 v[96:97], v18 offset:64
  ds_read_b64_tr_b16 v[98:99], v18 offset:1344
  ds_read_b64_tr_b16 v[100:101], v18 offset:96
  ds_read_b64_tr_b16 v[102:103], v18 offset:1376
  ds_read_b64_tr_b16 v[104:105], v18 offset:128
  ds_read_b64_tr_b16 v[106:107], v18 offset:1408
  s_waitcnt lgkmcnt(2)
  ds_read_b64_tr_b16 v[108:109], v18 offset:5120
  ds_read_b64_tr_b16 v[110:111], v18 offset:6400
  ds_read_b64_tr_b16 v[112:113], v18 offset:5152
  ds_read_b64_tr_b16 v[114:115], v18 offset:6432
  ds_read_b64_tr_b16 v[116:117], v18 offset:5184
  ds_read_b64_tr_b16 v[118:119], v18 offset:6464
  ds_read_b64_tr_b16 v[120:121], v18 offset:5216
  ds_read_b64_tr_b16 v[122:123], v18 offset:6496
  ds_read_b64_tr_b16 v[124:125], v18 offset:5248
  ds_read_b64_tr_b16 v[126:127], v18 offset:6528
  s_waitcnt lgkmcnt(10)
  v_mfma_f32_16x16x32_bf16 v[128:131], v[56:59], v[88:91], v[128:131]
  v_mfma_f32_16x16x32_bf16 v[132:135], v[56:59], v[92:95], v[132:135]
  v_mfma_f32_16x16x32_bf16 v[136:139], v[56:59], v[96:99], v[136:139]
  v_mfma_f32_16x16x32_bf16 v[140:143], v[56:59], v[100:103], v[140:143]
  v_mfma_f32_16x16x32_bf16 v[144:147], v[56:59], v[104:107], v[144:147]
  s_waitcnt lgkmcnt(0)
  v_mfma_f32_16x16x32_bf16 v[128:131], v[56:59], v[108:111], v[128:131]
  v_mfma_f32_16x16x32_bf16 v[132:135], v[56:59], v[112:115], v[132:135]
  v_mfma_f32_16x16x32_bf16 v[136:139], v[56:59], v[116:119], v[136:139]
  v_mfma_f32_16x16x32_bf16 v[140:143], v[56:59], v[120:123], v[140:143]
  v_mfma_f32_16x16x32_bf16 v[144:147], v[56:59], v[124:127], v[144:147]
  s_nop 7
  v_mov_b32 v24, v128
  v_cmp_eq_u32 vcc, 1, v30
  s_nop 1
  v_cndmask_b32 v24, v24, v132, vcc
  v_cmp_eq_u32 vcc, 2, v30
  s_nop 1
  v_cndmask_b32 v24, v24, v136, vcc
  v_cmp_eq_u32 vcc, 3, v30
  s_nop 1
  v_cndmask_b32 v24, v24, v140, vcc
  v_mov_b32 v25, v144
  v_mov_b32 v22, v24
  v_mov_b32 v23, s95
  buffer_store_dwordx2 v[22:23], v17, s[28:31], s93 offen sc1
  v_mov_b32 v28, v25
  v_mov_b32 v29, s95
  s_mov_b64 exec, 0xffff
  buffer_store_dwordx2 v[28:29], v17, s[28:31], s93 offen offset:512 sc1
  s_mov_b64 exec, -1
K1_LC_8:
  s_barrier
  s_cmp_lg_u32 s62, 1
  s_cbranch_scc1 K1_LC_9
  s_add_u32 s93, s92, 1280
  ds_read_b64_tr_b16 v[88:89], v18 offset:20480
  ds_read_b64_tr_b16 v[90:91], v18 offset:21760
  ds_read_b64_tr_b16 v[92:93], v18 offset:20512
  ds_read_b64_tr_b16 v[94:95], v18 offset:21792
  ds_read_b64_tr_b16 v[96:97], v18 offset:20544
  ds_read_b64_tr_b16 v[98:99], v18 offset:21824
  ds_read_b64_tr_b16 v[100:101], v18 offset:20576
  ds_read_b64_tr_b16 v[102:103], v18 offset:21856
  ds_read_b64_tr_b16 v[104:105], v18 offset:20608
  ds_read_b64_tr_b16 v[106:107], v18 offset:21888
  s_waitcnt lgkmcnt(2)
  ds_read_b64_tr_b16 v[108:109], v18 offset:25600
  ds_read_b64_tr_b16 v[110:111], v18 offset:26880
  ds_read_b64_tr_b16 v[112:113], v18 offset:25632
  ds_read_b64_tr_b16 v[114:115], v18 offset:26912
  ds_read_b64_tr_b16 v[116:117], v18 offset:25664
  ds_read_b64_tr_b16 v[118:119], v18 offset:26944
  ds_read_b64_tr_b16 v[120:121], v18 offset:25696
  ds_read_b64_tr_b16 v[122:123], v18 offset:26976
  ds_read_b64_tr_b16 v[124:125], v18 offset:25728
  ds_read_b64_tr_b16 v[126:127], v18 offset:27008
  s_waitcnt lgkmcnt(10)
  v_mfma_f32_16x16x32_bf16 v[128:131], v[56:59], v[88:91], v[128:131]
  v_mfma_f32_16x16x32_bf16 v[132:135], v[56:59], v[92:95], v[132:135]
  v_mfma_f32_16x16x32_bf16 v[136:139], v[56:59], v[96:99], v[136:139]
  v_mfma_f32_16x16x32_bf16 v[140:143], v[56:59], v[100:103], v[140:143]
  v_mfma_f32_16x16x32_bf16 v[144:147], v[56:59], v[104:107], v[144:147]
  s_waitcnt lgkmcnt(0)
  v_mfma_f32_16x16x32_bf16 v[128:131], v[56:59], v[108:111], v[128:131]
  v_mfma_f32_16x16x32_bf16 v[132:135], v[56:59], v[112:115], v[132:135]
  v_mfma_f32_16x16x32_bf16 v[136:139], v[56:59], v[116:119], v[136:139]
  v_mfma_f32_16x16x32_bf16 v[140:143], v[56:59], v[120:123], v[140:143]
  v_mfma_f32_16x16x32_bf16 v[144:147], v[56:59], v[124:127], v[144:147]
  s_nop 7
  v_mov_b32 v24, v128
  v_cmp_eq_u32 vcc, 1, v30
  s_nop 1
  v_cndmask_b32 v24, v24, v132, vcc
  v_cmp_eq_u32 vcc, 2, v30
  s_nop 1
  v_cndmask_b32 v24, v24, v136, vcc
  v_cmp_eq_u32 vcc, 3, v30
  s_nop 1
  v_cndmask_b32 v24, v24, v140, vcc
  v_mov_b32 v25, v144
  v_mov_b32 v22, v24
  v_mov_b32 v23, s95
  buffer_store_dwordx2 v[22:23], v17, s[28:31], s93 offen sc1
  v_mov_b32 v28, v25
  v_mov_b32 v29, s95
  s_mov_b64 exec, 0xffff
  buffer_store_dwordx2 v[28:29], v17, s[28:31], s93 offen offset:512 sc1
  s_mov_b64 exec, -1
K1_LC_9:
  s_barrier
  s_add_u32 m0, s42, 3072
  s_add_u32 s41, s40, 663552
  buffer_load_dwordx4 v5, s[12:15], s41 offen lds
  s_add_u32 m0, s42, 4096
  s_add_u32 s41, s40, 663552
  buffer_load_dwordx4 v12, s[12:15], s41 offen lds
  s_add_u32 m0, s42, 5120
  s_add_u32 s41, s40, 774144
  buffer_load_dwordx4 v2, s[12:15], s41 offen lds
  s_add_u32 m0, s42, 6144
  s_add_u32 s41, s40, 774144
  buffer_load_dwordx4 v3, s[12:15], s41 offen lds
  s_add_u32 m0, s42, 7168
  s_add_u32 s41, s40, 774144
  buffer_load_dwordx4 v4, s[12:15], s41 offen lds
  s_add_u32 m0, s42, 8192
  s_add_u32 s41, s40, 774144
  buffer_load_dwordx4 v5, s[12:15], s41 offen lds
  s_add_u32 m0, s42, 9216
  s_add_u32 s41, s40, 774144
  buffer_load_dwordx4 v12, s[12:15], s41 offen lds
  s_add_u32 m0, s42, 23552
  s_add_u32 s41, s40, 884736
  buffer_load_dwordx4 v5, s[12:15], s41 offen lds
  s_add_u32 m0, s42, 24576
  s_add_u32 s41, s40, 884736
  buffer_load_dwordx4 v12, s[12:15], s41 offen lds
  s_add_u32 m0, s42, 25600
  s_add_u32 s41, s40, 995328
  buffer_load_dwordx4 v2, s[12:15], s41 offen lds
  s_add_u32 m0, s42, 26624
  s_add_u32 s41, s40, 995328
  buffer_load_dwordx4 v3, s[12:15], s41 offen lds
  s_add_u32 m0, s42, 27648
  s_add_u32 s41, s40, 995328
  buffer_load_dwordx4 v4, s[12:15], s41 offen lds
  s_add_u32 m0, s42, 28672
  s_add_u32 s41, s40, 995328
  buffer_load_dwordx4 v5, s[12:15], s41 offen lds
  s_add_u32 m0, s42, 29696
  s_add_u32 s41, s40, 995328
  buffer_load_dwordx4 v12, s[12:15], s41 offen lds
  s_cmp_lg_u32 s62, 2
  s_cbranch_scc1 K1_LC_10
  s_add_u32 s93, s92, 2560
  ds_read_b64_tr_b16 v[88:89], v18 offset:40960
  ds_read_b64_tr_b16 v[90:91], v18 offset:42240
  ds_read_b64_tr_b16 v[92:93], v18 offset:40992
  ds_read_b64_tr_b16 v[94:95], v18 offset:42272
  ds_read_b64_tr_b16 v[96:97], v18 offset:41024
  ds_read_b64_tr_b16 v[98:99], v18 offset:42304
  ds_read_b64_tr_b16 v[100:101], v18 offset:41056
  ds_read_b64_tr_b16 v[102:103], v18 offset:42336
  ds_read_b64_tr_b16 v[104:105], v18 offset:41088
  ds_read_b64_tr_b16 v[106:107], v18 offset:42368
  s_waitcnt lgkmcnt(2)
  ds_read_b64_tr_b16 v[108:109], v18 offset:46080
  ds_read_b64_tr_b16 v[110:111], v18 offset:47360
  ds_read_b64_tr_b16 v[112:113], v18 offset:46112
  ds_read_b64_tr_b16 v[114:115], v18 offset:47392
  ds_read_b64_tr_b16 v[116:117], v18 offset:46144
  ds_read_b64_tr_b16 v[118:119], v18 offset:47424
  ds_read_b64_tr_b16 v[120:121], v18 offset:46176
  ds_read_b64_tr_b16 v[122:123], v18 offset:47456
  ds_read_b64_tr_b16 v[124:125], v18 offset:46208
  ds_read_b64_tr_b16 v[126:127], v18 offset:47488
  s_waitcnt lgkmcnt(10)
  v_mfma_f32_16x16x32_bf16 v[128:131], v[56:59], v[88:91], v[128:131]
  v_mfma_f32_16x16x32_bf16 v[132:135], v[56:59], v[92:95], v[132:135]
  v_mfma_f32_16x16x32_bf16 v[136:139], v[56:59], v[96:99], v[136:139]
  v_mfma_f32_16x16x32_bf16 v[140:143], v[56:59], v[100:103], v[140:143]
  v_mfma_f32_16x16x32_bf16 v[144:147], v[56:59], v[104:107], v[144:147]
  s_waitcnt lgkmcnt(0)
  v_mfma_f32_16x16x32_bf16 v[128:131], v[56:59], v[108:111], v[128:131]
  v_mfma_f32_16x16x32_bf16 v[132:135], v[56:59], v[112:115], v[132:135]
  v_mfma_f32_16x16x32_bf16 v[136:139], v[56:59], v[116:119], v[136:139]
  v_mfma_f32_16x16x32_bf16 v[140:143], v[56:59], v[120:123], v[140:143]
  v_mfma_f32_16x16x32_bf16 v[144:147], v[56:59], v[124:127], v[144:147]
  s_nop 7
  v_mov_b32 v24, v128
  v_cmp_eq_u32 vcc, 1, v30
  s_nop 1
  v_cndmask_b32 v24, v24, v132, vcc
  v_cmp_eq_u32 vcc, 2, v30
  s_nop 1
  v_cndmask_b32 v24, v24, v136, vcc
  v_cmp_eq_u32 vcc, 3, v30
  s_nop 1
  v_cndmask_b32 v24, v24, v140, vcc
  v_mov_b32 v25, v144
  v_mov_b32 v22, v24
  v_mov_b32 v23, s95
  buffer_store_dwordx2 v[22:23], v17, s[28:31], s93 offen sc1
  v_mov_b32 v28, v25
  v_mov_b32 v29, s95
  s_mov_b64 exec, 0xffff
  buffer_store_dwordx2 v[28:29], v17, s[28:31], s93 offen offset:512 sc1
  s_mov_b64 exec, -1
K1_LC_10:
  s_waitcnt vmcnt(7)
  s_barrier
  s_add_u32 m0, s42, 44032
  s_add_u32 s41, s40, 1105920
  buffer_load_dwordx4 v5, s[12:15], s41 offen lds
  s_add_u32 m0, s42, 45056
  s_add_u32 s41, s40, 1105920
  buffer_load_dwordx4 v12, s[12:15], s41 offen lds
  s_add_u32 m0, s42, 46080
  s_add_u32 s41, s40, 1216512
  buffer_load_dwordx4 v2, s[12:15], s41 offen lds
  s_add_u32 m0, s42, 47104
  s_add_u32 s41, s40, 1216512
  buffer_load_dwordx4 v3, s[12:15], s41 offen lds
  s_add_u32 m0, s42, 48128
  s_add_u32 s41, s40, 1216512
  buffer_load_dwordx4 v4, s[12:15], s41 offen lds
  s_add_u32 m0, s42, 49152
  s_add_u32 s41, s40, 1216512
  buffer_load_dwordx4 v5, s[12:15], s41 offen lds
  s_add_u32 m0, s42, 50176
  s_add_u32 s41, s40, 1216512
  buffer_load_dwordx4 v12, s[12:15], s41 offen lds
  s_cmp_lg_u32 s62, 3
  s_cbranch_scc1 K1_LC_11
  s_add_u32 s93, s92, 3840
  ds_read_b64_tr_b16 v[88:89], v18 offset:0
  ds_read_b64_tr_b16 v[90:91], v18 offset:1280
  ds_read_b64_tr_b16 v[92:93], v18 offset:32
  ds_read_b64_tr_b16 v[94:95], v18 offset:1312
  ds_read_b64_tr_b16 v[96:97], v18 offset:64
  ds_read_b64_tr_b16 v[98:99], v18 offset:1344
  ds_read_b64_tr_b16 v[100:101], v18 offset:96
  ds_read_b64_tr_b16 v[102:103], v18 offset:1376
  ds_read_b64_tr_b16 v[104:105], v18 offset:128
  ds_read_b64_tr_b16 v[106:107], v18 offset:1408
  s_waitcnt lgkmcnt(2)
  ds_read_b64_tr_b16 v[108:109], v18 offset:5120
  ds_read_b64_tr_b16 v[110:111], v18 offset:6400
  ds_read_b64_tr_b16 v[112:113], v18 offset:5152
  ds_read_b64_tr_b16 v[114:115], v18 offset:6432
  ds_read_b64_tr_b16 v[116:117], v18 offset:5184
  ds_read_b64_tr_b16 v[118:119], v18 offset:6464
  ds_read_b64_tr_b16 v[120:121], v18 offset:5216
  ds_read_b64_tr_b16 v[122:123], v18 offset:6496
  ds_read_b64_tr_b16 v[124:125], v18 offset:5248
  ds_read_b64_tr_b16 v[126:127], v18 offset:6528
  s_waitcnt lgkmcnt(10)
  v_mfma_f32_16x16x32_bf16 v[128:131], v[56:59], v[88:91], v[128:131]
  v_mfma_f32_16x16x32_bf16 v[132:135], v[56:59], v[92:95], v[132:135]
  v_mfma_f32_16x16x32_bf16 v[136:139], v[56:59], v[96:99], v[136:139]
  v_mfma_f32_16x16x32_bf16 v[140:143], v[56:59], v[100:103], v[140:143]
  v_mfma_f32_16x16x32_bf16 v[144:147], v[56:59], v[104:107], v[144:147]
  s_waitcnt lgkmcnt(0)
  v_mfma_f32_16x16x32_bf16 v[128:131], v[56:59], v[108:111], v[128:131]
  v_mfma_f32_16x16x32_bf16 v[132:135], v[56:59], v[112:115], v[132:135]
  v_mfma_f32_16x16x32_bf16 v[136:139], v[56:59], v[116:119], v[136:139]
  v_mfma_f32_16x16x32_bf16 v[140:143], v[56:59], v[120:123], v[140:143]
  v_mfma_f32_16x16x32_bf16 v[144:147], v[56:59], v[124:127], v[144:147]
  s_nop 7
  v_mov_b32 v24, v128
  v_cmp_eq_u32 vcc, 1, v30
  s_nop 1
  v_cndmask_b32 v24, v24, v132, vcc
  v_cmp_eq_u32 vcc, 2, v30
  s_nop 1
  v_cndmask_b32 v24, v24, v136, vcc
  v_cmp_eq_u32 vcc, 3, v30
  s_nop 1
  v_cndmask_b32 v24, v24, v140, vcc
  v_mov_b32 v25, v144
  v_mov_b32 v22, v24
  v_mov_b32 v23, s95
  buffer_store_dwordx2 v[22:23], v17, s[28:31], s93 offen sc1
  v_mov_b32 v28, v25
  v_mov_b32 v29, s95
  s_mov_b64 exec, 0xffff
  buffer_store_dwordx2 v[28:29], v17, s[28:31], s93 offen offset:512 sc1
  s_mov_b64 exec, -1
K1_LC_11:
  s_waitcnt vmcnt(7)
  s_barrier
  s_cmp_lg_u32 s62, 4
  s_cbranch_scc1 K1_LC_12
  s_add_u32 s93, s92, 5120
  ds_read_b64_tr_b16 v[88:89], v18 offset:20480
  ds_read_b64_tr_b16 v[90:91], v18 offset:21760
  ds_read_b64_tr_b16 v[92:93], v18 offset:20512
  ds_read_b64_tr_b16 v[94:95], v18 offset:21792
  ds_read_b64_tr_b16 v[96:97], v18 offset:20544
  ds_read_b64_tr_b16 v[98:99], v18 offset:21824
  ds_read_b64_tr_b16 v[100:101], v18 offset:20576
  ds_read_b64_tr_b16 v[102:103], v18 offset:21856
  ds_read_b64_tr_b16 v[104:105], v18 offset:20608
  ds_read_b64_tr_b16 v[106:107], v18 offset:21888
  s_waitcnt lgkmcnt(2)
  ds_read_b64_tr_b16 v[108:109], v18 offset:25600
  ds_read_b64_tr_b16 v[110:111], v18 offset:26880
  ds_read_b64_tr_b16 v[112:113], v18 offset:25632
  ds_read_b64_tr_b16 v[114:115], v18 offset:26912
  ds_read_b64_tr_b16 v[116:117], v18 offset:25664
  ds_read_b64_tr_b16 v[118:119], v18 offset:26944
  ds_read_b64_tr_b16 v[120:121], v18 offset:25696
  ds_read_b64_tr_b16 v[122:123], v18 offset:26976
  ds_read_b64_tr_b16 v[124:125], v18 offset:25728
  ds_read_b64_tr_b16 v[126:127], v18 offset:27008
  s_waitcnt lgkmcnt(10)
  v_mfma_f32_16x16x32_bf16 v[128:131], v[56:59], v[88:91], v[128:131]
  v_mfma_f32_16x16x32_bf16 v[132:135], v[56:59], v[92:95], v[132:135]
  v_mfma_f32_16x16x32_bf16 v[136:139], v[56:59], v[96:99], v[136:139]
  v_mfma_f32_16x16x32_bf16 v[140:143], v[56:59], v[100:103], v[140:143]
  v_mfma_f32_16x16x32_bf16 v[144:147], v[56:59], v[104:107], v[144:147]
  s_waitcnt lgkmcnt(0)
  v_mfma_f32_16x16x32_bf16 v[128:131], v[56:59], v[108:111], v[128:131]
  v_mfma_f32_16x16x32_bf16 v[132:135], v[56:59], v[112:115], v[132:135]
  v_mfma_f32_16x16x32_bf16 v[136:139], v[56:59], v[116:119], v[136:139]
  v_mfma_f32_16x16x32_bf16 v[140:143], v[56:59], v[120:123], v[140:143]
  v_mfma_f32_16x16x32_bf16 v[144:147], v[56:59], v[124:127], v[144:147]
  s_nop 7
  v_mov_b32 v24, v128
  v_cmp_eq_u32 vcc, 1, v30
  s_nop 1
  v_cndmask_b32 v24, v24, v132, vcc
  v_cmp_eq_u32 vcc, 2, v30
  s_nop 1
  v_cndmask_b32 v24, v24, v136, vcc
  v_cmp_eq_u32 vcc, 3, v30
  s_nop 1
  v_cndmask_b32 v24, v24, v140, vcc
  v_mov_b32 v25, v144
  v_mov_b32 v22, v24
  v_mov_b32 v23, s95
  buffer_store_dwordx2 v[22:23], v17, s[28:31], s93 offen sc1
  v_mov_b32 v28, v25
  v_mov_b32 v29, s95
  s_mov_b64 exec, 0xffff
  buffer_store_dwordx2 v[28:29], v17, s[28:31], s93 offen offset:512 sc1
  s_mov_b64 exec, -1
K1_LC_12:
  s_waitcnt vmcnt(0)
  s_barrier
  s_add_u32 m0, s42, 3072
  s_add_u32 s41, s40, 1327104
  buffer_load_dwordx4 v5, s[12:15], s41 offen lds
  s_add_u32 m0, s42, 4096
  s_add_u32 s41, s40, 1327104
  buffer_load_dwordx4 v12, s[12:15], s41 offen lds
  s_add_u32 m0, s42, 5120
  s_add_u32 s41, s40, 1437696
  buffer_load_dwordx4 v2, s[12:15], s41 offen lds
  s_add_u32 m0, s42, 6144
  s_add_u32 s41, s40, 1437696
  buffer_load_dwordx4 v3, s[12:15], s41 offen lds
  s_add_u32 m0, s42, 7168
  s_add_u32 s41, s40, 1437696
  buffer_load_dwordx4 v4, s[12:15], s41 offen lds
  s_add_u32 m0, s42, 8192
  s_add_u32 s41, s40, 1437696
  buffer_load_dwordx4 v5, s[12:15], s41 offen lds
  s_add_u32 m0, s42, 9216
  s_add_u32 s41, s40, 1437696
  buffer_load_dwordx4 v12, s[12:15], s41 offen lds
  s_add_u32 m0, s42, 23552
  s_add_u32 s41, s40, 1548288
  buffer_load_dwordx4 v5, s[12:15], s41 offen lds
  s_add_u32 m0, s42, 24576
  s_add_u32 s41, s40, 1548288
  buffer_load_dwordx4 v12, s[12:15], s41 offen lds
  s_add_u32 m0, s42, 25600
  s_add_u32 s41, s40, 1658880
  buffer_load_dwordx4 v2, s[12:15], s41 offen lds
  s_add_u32 m0, s42, 26624
  s_add_u32 s41, s40, 1658880
  buffer_load_dwordx4 v3, s[12:15], s41 offen lds
  s_add_u32 m0, s42, 27648
  s_add_u32 s41, s40, 1658880
  buffer_load_dwordx4 v4, s[12:15], s41 offen lds
  s_add_u32 m0, s42, 28672
  s_add_u32 s41, s40, 1658880
  buffer_load_dwordx4 v5, s[12:15], s41 offen lds
  s_add_u32 m0, s42, 29696
  s_add_u32 s41, s40, 1658880
  buffer_load_dwordx4 v12, s[12:15], s41 offen lds
  s_cmp_lg_u32 s62, 5
  s_cbranch_scc1 K1_LC_13
  s_add_u32 s93, s92, 6400
  ds_read_b64_tr_b16 v[88:89], v18 offset:40960
  ds_read_b64_tr_b16 v[90:91], v18 offset:42240
  ds_read_b64_tr_b16 v[92:93], v18 offset:40992
  ds_read_b64_tr_b16 v[94:95], v18 offset:42272
  ds_read_b64_tr_b16 v[96:97], v18 offset:41024
  ds_read_b64_tr_b16 v[98:99], v18 offset:42304
  ds_read_b64_tr_b16 v[100:101], v18 offset:41056
  ds_read_b64_tr_b16 v[102:103], v18 offset:42336
  ds_read_b64_tr_b16 v[104:105], v18 offset:41088
  ds_read_b64_tr_b16 v[106:107], v18 offset:42368
  s_waitcnt lgkmcnt(2)
  ds_read_b64_tr_b16 v[108:109], v18 offset:46080
  ds_read_b64_tr_b16 v[110:111], v18 offset:47360
  ds_read_b64_tr_b16 v[112:113], v18 offset:46112
  ds_read_b64_tr_b16 v[114:115], v18 offset:47392
  ds_read_b64_tr_b16 v[116:117], v18 offset:46144
  ds_read_b64_tr_b16 v[118:119], v18 offset:47424
  ds_read_b64_tr_b16 v[120:121], v18 offset:46176
  ds_read_b64_tr_b16 v[122:123], v18 offset:47456
  ds_read_b64_tr_b16 v[124:125], v18 offset:46208
  ds_read_b64_tr_b16 v[126:127], v18 offset:47488
  s_waitcnt lgkmcnt(10)
  v_mfma_f32_16x16x32_bf16 v[128:131], v[56:59], v[88:91], v[128:131]
  v_mfma_f32_16x16x32_bf16 v[132:135], v[56:59], v[92:95], v[132:135]
  v_mfma_f32_16x16x32_bf16 v[136:139], v[56:59], v[96:99], v[136:139]
  v_mfma_f32_16x16x32_bf16 v[140:143], v[56:59], v[100:103], v[140:143]
  v_mfma_f32_16x16x32_bf16 v[144:147], v[56:59], v[104:107], v[144:147]
  s_waitcnt lgkmcnt(0)
  v_mfma_f32_16x16x32_bf16 v[128:131], v[56:59], v[108:111], v[128:131]
  v_mfma_f32_16x16x32_bf16 v[132:135], v[56:59], v[112:115], v[132:135]
  v_mfma_f32_16x16x32_bf16 v[136:139], v[56:59], v[116:119], v[136:139]
  v_mfma_f32_16x16x32_bf16 v[140:143], v[56:59], v[120:123], v[140:143]
  v_mfma_f32_16x16x32_bf16 v[144:147], v[56:59], v[124:127], v[144:147]
  s_nop 7
  v_mov_b32 v24, v128
  v_cmp_eq_u32 vcc, 1, v30
  s_nop 1
  v_cndmask_b32 v24, v24, v132, vcc
  v_cmp_eq_u32 vcc, 2, v30
  s_nop 1
  v_cndmask_b32 v24, v24, v136, vcc
  v_cmp_eq_u32 vcc, 3, v30
  s_nop 1
  v_cndmask_b32 v24, v24, v140, vcc
  v_mov_b32 v25, v144
  v_mov_b32 v22, v24
  v_mov_b32 v23, s95
  buffer_store_dwordx2 v[22:23], v17, s[28:31], s93 offen sc1
  v_mov_b32 v28, v25
  v_mov_b32 v29, s95
  s_mov_b64 exec, 0xffff
  buffer_store_dwordx2 v[28:29], v17, s[28:31], s93 offen offset:512 sc1
  s_mov_b64 exec, -1
K1_LC_13:
  s_waitcnt vmcnt(7)
  s_barrier
  s_setprio 2
  s_add_u32 m0, s42, 44032
  s_add_u32 s41, s40, 1769472
  buffer_load_dwordx4 v5, s[12:15], s41 offen lds
  s_add_u32 m0, s42, 45056
  s_add_u32 s41, s40, 1769472
  buffer_load_dwordx4 v12, s[12:15], s41 offen lds
  s_add_u32 m0, s42, 46080
  s_add_u32 s41, s40, 1880064
  buffer_load_dwordx4 v2, s[12:15], s41 offen lds
  s_add_u32 m0, s42, 47104
  s_add_u32 s41, s40, 1880064
  buffer_load_dwordx4 v3, s[12:15], s41 offen lds
  s_add_u32 m0, s42, 48128
  s_add_u32 s41, s40, 1880064
  buffer_load_dwordx4 v4, s[12:15], s41 offen lds
  s_add_u32 m0, s42, 49152
  s_add_u32 s41, s40, 1880064
  buffer_load_dwordx4 v5, s[12:15], s41 offen lds
  s_add_u32 m0, s42, 50176
  s_add_u32 s41, s40, 1880064
  buffer_load_dwordx4 v12, s[12:15], s41 offen lds
  ds_read_b64_tr_b16 v[88:89], v18 offset:0
  ds_read_b64_tr_b16 v[90:91], v18 offset:1280
  ds_read_b64_tr_b16 v[92:93], v18 offset:32
  ds_read_b64_tr_b16 v[94:95], v18 offset:1312
  ds_read_b64_tr_b16 v[96:97], v18 offset:64
  ds_read_b64_tr_b16 v[98:99], v18 offset:1344
  ds_read_b64_tr_b16 v[100:101], v18 offset:96
  ds_read_b64_tr_b16 v[102:103], v18 offset:1376
  ds_read_b64_tr_b16 v[104:105], v18 offset:128
  ds_read_b64_tr_b16 v[106:107], v18 offset:1408
  s_waitcnt lgkmcnt(2)
  ds_read_b64_tr_b16 v[108:109], v18 offset:5120
  ds_read_b64_tr_b16 v[110:111], v18 offset:6400
  ds_read_b64_tr_b16 v[112:113], v18 offset:5152
  ds_read_b64_tr_b16 v[114:115], v18 offset:6432
  ds_read_b64_tr_b16 v[116:117], v18 offset:5184
  ds_read_b64_tr_b16 v[118:119], v18 offset:6464
  ds_read_b64_tr_b16 v[120:121], v18 offset:5216
  ds_read_b64_tr_b16 v[122:123], v18 offset:6496
  ds_read_b64_tr_b16 v[124:125], v18 offset:5248
  ds_read_b64_tr_b16 v[126:127], v18 offset:6528
  s_waitcnt lgkmcnt(10)
  v_mfma_f32_16x16x32_bf16 v[32:35], v[56:59], v[88:91], v[32:35]
  v_mfma_f32_16x16x32_bf16 v[36:39], v[56:59], v[92:95], v[36:39]
  v_mfma_f32_16x16x32_bf16 v[40:43], v[56:59], v[96:99], v[40:43]
  v_mfma_f32_16x16x32_bf16 v[44:47], v[56:59], v[100:103], v[44:47]
  v_mfma_f32_16x16x32_bf16 v[48:51], v[56:59], v[104:107], v[48:51]
  s_waitcnt lgkmcnt(0)
  v_mfma_f32_16x16x32_bf16 v[32:35], v[56:59], v[108:111], v[32:35]
  v_mfma_f32_16x16x32_bf16 v[36:39], v[56:59], v[112:115], v[36:39]
  v_mfma_f32_16x16x32_bf16 v[40:43], v[56:59], v[116:119], v[40:43]
  v_mfma_f32_16x16x32_bf16 v[44:47], v[56:59], v[120:123], v[44:47]
  v_mfma_f32_16x16x32_bf16 v[48:51], v[56:59], v[124:127], v[48:51]
  s_waitcnt vmcnt(7)
  s_barrier
  buffer_load_dwordx2 v[26:27], v53, s[24:27], 0 offen sc1
  buffer_load_dwordx2 v[28:29], v53, s[24:27], 0 offen offset:512 sc1
  s_add_u32 s66, s92, 0
  buffer_load_dwordx2 v[60:61], v17, s[28:31], s66 offen sc1
  buffer_load_dwordx2 v[72:73], v17, s[28:31], s66 offen offset:512 sc1
  s_add_u32 s66, s92, 1280
  buffer_load_dwordx2 v[62:63], v17, s[28:31], s66 offen sc1
  buffer_load_dwordx2 v[74:75], v17, s[28:31], s66 offen offset:512 sc1
  s_add_u32 s66, s92, 2560
  buffer_load_dwordx2 v[64:65], v17, s[28:31], s66 offen sc1
  buffer_load_dwordx2 v[76:77], v17, s[28:31], s66 offen offset:512 sc1
  s_add_u32 s66, s92, 3840
  buffer_load_dwordx2 v[66:67], v17, s[28:31], s66 offen sc1
  buffer_load_dwordx2 v[78:79], v17, s[28:31], s66 offen offset:512 sc1
  s_add_u32 s66, s92, 5120
  buffer_load_dwordx2 v[68:69], v17, s[28:31], s66 offen sc1
  buffer_load_dwordx2 v[80:81], v17, s[28:31], s66 offen offset:512 sc1
  s_add_u32 s66, s92, 6400
  buffer_load_dwordx2 v[70:71], v17, s[28:31], s66 offen sc1
  buffer_load_dwordx2 v[82:83], v17, s[28:31], s66 offen offset:512 sc1
  ds_read_b64_tr_b16 v[88:89], v18 offset:20480
  ds_read_b64_tr_b16 v[90:91], v18 offset:21760
  ds_read_b64_tr_b16 v[92:93], v18 offset:20512
  ds_read_b64_tr_b16 v[94:95], v18 offset:21792
  ds_read_b64_tr_b16 v[96:97], v18 offset:20544
  ds_read_b64_tr_b16 v[98:99], v18 offset:21824
  ds_read_b64_tr_b16 v[100:101], v18 offset:20576
  ds_read_b64_tr_b16 v[102:103], v18 offset:21856
  ds_read_b64_tr_b16 v[104:105], v18 offset:20608
  ds_read_b64_tr_b16 v[106:107], v18 offset:21888
  s_waitcnt lgkmcnt(2)
  ds_read_b64_tr_b16 v[108:109], v18 offset:25600
  ds_read_b64_tr_b16 v[110:111], v18 offset:26880
  ds_read_b64_tr_b16 v[112:113], v18 offset:25632
  ds_read_b64_tr_b16 v[114:115], v18 offset:26912
  ds_read_b64_tr_b16 v[116:117], v18 offset:25664
  ds_read_b64_tr_b16 v[118:119], v18 offset:26944
  ds_read_b64_tr_b16 v[120:121], v18 offset:25696
  ds_read_b64_tr_b16 v[122:123], v18 offset:26976
  ds_read_b64_tr_b16 v[124:125], v18 offset:25728
  ds_read_b64_tr_b16 v[126:127], v18 offset:27008
  s_waitcnt lgkmcnt(10)
  v_mfma_f32_16x16x32_bf16 v[32:35], v[56:59], v[88:91], v[32:35]
  v_mfma_f32_16x16x32_bf16 v[36:39], v[56:59], v[92:95], v[36:39]
  v_mfma_f32_16x16x32_bf16 v[40:43], v[56:59], v[96:99], v[40:43]
  v_mfma_f32_16x16x32_bf16 v[44:47], v[56:59], v[100:103], v[44:47]
  v_mfma_f32_16x16x32_bf16 v[48:51], v[56:59], v[104:107], v[48:51]
  s_waitcnt lgkmcnt(0)
  v_mfma_f32_16x16x32_bf16 v[32:35], v[56:59], v[108:111], v[32:35]
  v_mfma_f32_16x16x32_bf16 v[36:39], v[56:59], v[112:115], v[36:39]
  v_mfma_f32_16x16x32_bf16 v[40:43], v[56:59], v[116:119], v[40:43]
  v_mfma_f32_16x16x32_bf16 v[44:47], v[56:59], v[120:123], v[44:47]
  v_mfma_f32_16x16x32_bf16 v[48:51], v[56:59], v[124:127], v[48:51]
  s_waitcnt vmcnt(14)
  s_barrier
  s_add_u32 m0, s42, 3072
  s_add_u32 s41, s40, 1990656
  buffer_load_dwordx4 v5, s[12:15], s41 offen lds
  s_add_u32 m0, s42, 4096
  s_add_u32 s41, s40, 1990656
  buffer_load_dwordx4 v12, s[12:15], s41 offen lds
  s_add_u32 m0, s42, 5120
  s_add_u32 s41, s40, 2101248
  buffer_load_dwordx4 v2, s[12:15], s41 offen lds
  s_add_u32 m0, s42, 6144
  s_add_u32 s41, s40, 2101248
  buffer_load_dwordx4 v3, s[12:15], s41 offen lds
  s_add_u32 m0, s42, 7168
  s_add_u32 s41, s40, 2101248
  buffer_load_dwordx4 v4, s[12:15], s41 offen lds
  s_add_u32 m0, s42, 8192
  s_add_u32 s41, s40, 2101248
  buffer_load_dwordx4 v5, s[12:15], s41 offen lds
  s_add_u32 m0, s42, 9216
  s_add_u32 s41, s40, 2101248
  buffer_load_dwordx4 v12, s[12:15], s41 offen lds
  ds_read_b64_tr_b16 v[88:89], v18 offset:40960
  ds_read_b64_tr_b16 v[90:91], v18 offset:42240
  ds_read_b64_tr_b16 v[92:93], v18 offset:40992
  ds_read_b64_tr_b16 v[94:95], v18 offset:42272
  ds_read_b64_tr_b16 v[96:97], v18 offset:41024
  ds_read_b64_tr_b16 v[98:99], v18 offset:42304
  ds_read_b64_tr_b16 v[100:101], v18 offset:41056
  ds_read_b64_tr_b16 v[102:103], v18 offset:42336
  ds_read_b64_tr_b16 v[104:105], v18 offset:41088
  ds_read_b64_tr_b16 v[106:107], v18 offset:42368
  s_waitcnt lgkmcnt(2)
  ds_read_b64_tr_b16 v[108:109], v18 offset:46080
  ds_read_b64_tr_b16 v[110:111], v18 offset:47360
  ds_read_b64_tr_b16 v[112:113], v18 offset:46112
  ds_read_b64_tr_b16 v[114:115], v18 offset:47392
  ds_read_b64_tr_b16 v[116:117], v18 offset:46144
  ds_read_b64_tr_b16 v[118:119], v18 offset:47424
  ds_read_b64_tr_b16 v[120:121], v18 offset:46176
  ds_read_b64_tr_b16 v[122:123], v18 offset:47456
  ds_read_b64_tr_b16 v[124:125], v18 offset:46208
  ds_read_b64_tr_b16 v[126:127], v18 offset:47488
  s_waitcnt lgkmcnt(10)
  v_mfma_f32_16x16x32_bf16 v[32:35], v[56:59], v[88:91], v[32:35]
  v_mfma_f32_16x16x32_bf16 v[36:39], v[56:59], v[92:95], v[36:39]
  v_mfma_f32_16x16x32_bf16 v[40:43], v[56:59], v[96:99], v[40:43]
  v_mfma_f32_16x16x32_bf16 v[44:47], v[56:59], v[100:103], v[44:47]
  v_mfma_f32_16x16x32_bf16 v[48:51], v[56:59], v[104:107], v[48:51]
  s_waitcnt lgkmcnt(0)
  v_mfma_f32_16x16x32_bf16 v[32:35], v[56:59], v[108:111], v[32:35]
  v_mfma_f32_16x16x32_bf16 v[36:39], v[56:59], v[112:115], v[36:39]
  v_mfma_f32_16x16x32_bf16 v[40:43], v[56:59], v[116:119], v[40:43]
  v_mfma_f32_16x16x32_bf16 v[44:47], v[56:59], v[120:123], v[44:47]
  v_mfma_f32_16x16x32_bf16 v[48:51], v[56:59], v[124:127], v[48:51]
  s_mov_b64 s[32:33], 0xffff
  s_mul_i32 s65, s43, 320
  v_add_u32 v13, s65, v19
  v_add_u32 v13, 162816, v13
  s_lshl_b32 s65, s43, 9
  v_add_u32 v23, s65, v19
  v_add_u32 v23, 160768, v23
  s_mov_b32 s67, 0
  s_waitcnt vmcnt(7)

K1_GP_14:
  v_cmp_eq_u32 s[68:69], s95, v27
  v_cmp_eq_u32 vcc, s95, v29
  s_and_b64 s[68:69], s[68:69], vcc
  v_cmp_eq_u32 vcc, s95, v61
  s_and_b64 s[68:69], s[68:69], vcc
  v_cmp_eq_u32 vcc, s95, v63
  s_and_b64 s[68:69], s[68:69], vcc
  v_cmp_eq_u32 vcc, s95, v65
  s_and_b64 s[68:69], s[68:69], vcc
  v_cmp_eq_u32 vcc, s95, v67
  s_and_b64 s[68:69], s[68:69], vcc
  v_cmp_eq_u32 vcc, s95, v69
  s_and_b64 s[68:69], s[68:69], vcc
  v_cmp_eq_u32 vcc, s95, v71
  s_and_b64 s[68:69], s[68:69], vcc
  v_cmp_eq_u32 vcc, s95, v73
  s_orn2_b64 vcc, vcc, s[32:33]
  s_and_b64 s[68:69], s[68:69], vcc
  v_cmp_eq_u32 vcc, s95, v75
  s_orn2_b64 vcc, vcc, s[32:33]
  s_and_b64 s[68:69], s[68:69], vcc
  v_cmp_eq_u32 vcc, s95, v77
  s_orn2_b64 vcc, vcc, s[32:33]
  s_and_b64 s[68:69], s[68:69], vcc
  v_cmp_eq_u32 vcc, s95, v79
  s_orn2_b64 vcc, vcc, s[32:33]
  s_and_b64 s[68:69], s[68:69], vcc
  v_cmp_eq_u32 vcc, s95, v81
  s_orn2_b64 vcc, vcc, s[32:33]
  s_and_b64 s[68:69], s[68:69], vcc
  v_cmp_eq_u32 vcc, s95, v83
  s_orn2_b64 vcc, vcc, s[32:33]
  s_and_b64 s[68:69], s[68:69], vcc
  s_cmp_eq_u64 s[68:69], -1
  s_cbranch_scc1 K1_GO_15
  s_add_u32 s67, s67, 1
  s_cmp_ge_u32 s67, 100000
  s_cbranch_scc1 K1_GO_15
  s_sleep 4

  buffer_load_dwordx2 v[26:27], v53, s[24:27], 0 offen sc1
  buffer_load_dwordx2 v[28:29], v53, s[24:27], 0 offen offset:512 sc1
  s_add_u32 s66, s92, 0
  buffer_load_dwordx2 v[60:61], v17, s[28:31], s66 offen sc1
  buffer_load_dwordx2 v[72:73], v17, s[28:31], s66 offen offset:512 sc1
  s_add_u32 s66, s92, 1280
  buffer_load_dwordx2 v[62:63], v17, s[28:31], s66 offen sc1
  buffer_load_dwordx2 v[74:75], v17, s[28:31], s66 offen offset:512 sc1
  s_add_u32 s66, s92, 2560
  buffer_load_dwordx2 v[64:65], v17, s[28:31], s66 offen sc1
  buffer_load_dwordx2 v[76:77], v17, s[28:31], s66 offen offset:512 sc1
  s_add_u32 s66, s92, 3840
  buffer_load_dwordx2 v[66:67], v17, s[28:31], s66 offen sc1
  buffer_load_dwordx2 v[78:79], v17, s[28:31], s66 offen offset:512 sc1
  s_add_u32 s66, s92, 5120
  buffer_load_dwordx2 v[68:69], v17, s[28:31], s66 offen sc1
  buffer_load_dwordx2 v[80:81], v17, s[28:31], s66 offen offset:512 sc1
  s_add_u32 s66, s92, 6400
  buffer_load_dwordx2 v[70:71], v17, s[28:31], s66 offen sc1
  buffer_load_dwordx2 v[82:83], v17, s[28:31], s66 offen offset:512 sc1
  s_waitcnt vmcnt(0)
  s_branch K1_GP_14
K1_GO_15:
  v_lshlrev_b32 v27, 16, v26
  v_lshlrev_b32 v29, 16, v28
  v_and_b32 v26, 0xffff0000, v26
  v_and_b32 v28, 0xffff0000, v28
  v_rcp_f32 v27, v27
  v_rcp_f32 v29, v29
  ds_write_b32 v23, v26 offset:1024
  ds_write_b32 v23, v28 offset:1280
  ds_write_b32 v23, v27
  ds_write_b32 v23, v29 offset:256

  v_add_f32 v60, v60, v62
  v_add_f32 v72, v72, v74
  v_add_f32 v60, v60, v64
  v_add_f32 v72, v72, v76
  v_add_f32 v60, v60, v66
  v_add_f32 v72, v72, v78
  v_add_f32 v60, v60, v68
  v_add_f32 v72, v72, v80
  v_add_f32 v60, v60, v70
  v_add_f32 v72, v72, v82
  s_waitcnt vmcnt(0)
  s_barrier
  ds_read_b64_tr_b16 v[88:89], v18 offset:0
  ds_read_b64_tr_b16 v[90:91], v18 offset:1280
  ds_read_b64_tr_b16 v[92:93], v18 offset:32
  ds_read_b64_tr_b16 v[94:95], v18 offset:1312
  ds_read_b64_tr_b16 v[96:97], v18 offset:64
  ds_read_b64_tr_b16 v[98:99], v18 offset:1344
  ds_read_b64_tr_b16 v[100:101], v18 offset:96
  ds_read_b64_tr_b16 v[102:103], v18 offset:1376
  ds_read_b64_tr_b16 v[104:105], v18 offset:128
  ds_read_b64_tr_b16 v[106:107], v18 offset:1408
  s_waitcnt lgkmcnt(2)
  ds_read_b64_tr_b16 v[108:109], v18 offset:5120
  ds_read_b64_tr_b16 v[110:111], v18 offset:6400
  ds_read_b64_tr_b16 v[112:113], v18 offset:5152
  ds_read_b64_tr_b16 v[114:115], v18 offset:6432
  ds_read_b64_tr_b16 v[116:117], v18 offset:5184
  ds_read_b64_tr_b16 v[118:119], v18 offset:6464
  ds_read_b64_tr_b16 v[120:121], v18 offset:5216
  ds_read_b64_tr_b16 v[122:123], v18 offset:6496
  ds_read_b64_tr_b16 v[124:125], v18 offset:5248
  ds_read_b64_tr_b16 v[126:127], v18 offset:6528
  s_waitcnt lgkmcnt(10)
  v_mfma_f32_16x16x32_bf16 v[32:35], v[56:59], v[88:91], v[32:35]
  v_mfma_f32_16x16x32_bf16 v[36:39], v[56:59], v[92:95], v[36:39]
  v_mfma_f32_16x16x32_bf16 v[40:43], v[56:59], v[96:99], v[40:43]
  v_mfma_f32_16x16x32_bf16 v[44:47], v[56:59], v[100:103], v[44:47]
  v_mfma_f32_16x16x32_bf16 v[48:51], v[56:59], v[104:107], v[48:51]
  s_waitcnt lgkmcnt(0)
  v_mfma_f32_16x16x32_bf16 v[32:35], v[56:59], v[108:111], v[32:35]
  v_mfma_f32_16x16x32_bf16 v[36:39], v[56:59], v[112:115], v[36:39]
  v_mfma_f32_16x16x32_bf16 v[40:43], v[56:59], v[116:119], v[40:43]
  v_mfma_f32_16x16x32_bf16 v[44:47], v[56:59], v[120:123], v[44:47]
  v_mfma_f32_16x16x32_bf16 v[48:51], v[56:59], v[124:127], v[48:51]
  s_nop 7
  v_mov_b32 v24, v32
  v_cmp_eq_u32 vcc, 1, v30
  s_nop 1
  v_cndmask_b32 v24, v24, v36, vcc
  v_cmp_eq_u32 vcc, 2, v30
  s_nop 1
  v_cndmask_b32 v24, v24, v40, vcc
  v_cmp_eq_u32 vcc, 3, v30
  s_nop 1
  v_cndmask_b32 v24, v24, v44, vcc
  v_mov_b32 v25, v48
  v_mov_b32 v84, s95
  v_mov_b32 v85, 0
  v_mov_b32 v86, 0
  v_mov_b32 v87, 0
  v_mov_b32 v88, 158720
  ds_write_b128 v88, v[84:87]
  ds_write_b64 v88, v[86:87] offset:16
  ds_write_b64 v88, v[86:87] offset:24

  v_add_f32 v24, v24, v60
  v_add_f32 v25, v25, v72
  ds_write_b32 v13, v24
  s_mov_b64 exec, 0xffff
  ds_write_b32 v13, v25 offset:256
  s_mov_b64 exec, -1
  s_setprio 0
  s_waitcnt lgkmcnt(0)
  s_barrier
  s_mov_b32 s47, 0
  s_branch K1_P2
K1_HSSM:
  s_mul_i32 s67, s43, 10240
  s_add_u32 s67, s67, 98304
  v_add_u32 v18, s67, v10
  v_xor_b32 v16, 64, v18
  v_bfe_u32 v53, v1, 2, 2
  v_lshlrev_b32 v53, 4, v53
  v_and_b32 v22, 1, v1
  v_lshl_add_u32 v53, v22, 3, v53
  v_bfe_u32 v22, v1, 1, 1
  v_add_u32 v53, v53, v22
  v_lshl_add_u32 v53, v30, 1, v53
  v_add_u32 v53, s64, v53
  v_lshlrev_b32 v53, 3, v53

  s_lshl_b32 s66, s62, 8
  s_lshl_b32 s67, s35, 3
  s_add_u32 s66, s66, s67
  s_lshl_b32 s67, s43, 2
  s_add_u32 s66, s66, s67
  s_mul_i32 s94, s66, 1280
  v_mul_u32_u24 v54, 1280, v30
  v_lshl_add_u32 v54, v31, 4, v54
  v_add_u32 v26, s66, v30
  v_lshlrev_b32 v26, 3, v26

  buffer_load_dwordx4 v[60:63], v54, s[8:11], s94 offen offset:0
  buffer_load_dwordx4 v[64:67], v54, s[8:11], s94 offen offset:256
  buffer_load_dwordx4 v[68:71], v54, s[8:11], s94 offen offset:512
  buffer_load_dwordx4 v[72:75], v54, s[8:11], s94 offen offset:768
  buffer_load_dwordx4 v[76:79], v54, s[8:11], s94 offen offset:1024
  s_mov_b32 s20, s44
  s_mov_b32 s21, s45
  s_mov_b32 s22, 1280
  s_mov_b32 s23, 0x20000
  s_mov_b32 s24, s46
  s_mov_b32 s25, s47
  s_mov_b32 s26, 1280
  s_mov_b32 s27, 0x20000
  s_mov_b32 s28, s52
  s_mov_b32 s29, s53
  s_mov_b32 s30, 1280
  s_mov_b32 s31, 0x20000
  s_lshl_b32 s65, s63, 7
  v_lshlrev_b32 v22, 1, v1
  v_add_u32 v22, s65, v22
  s_lshl_b32 s90, s63, 13
  s_lshl_b32 s91, s62, 10
  s_add_u32 s91, s91, s90
  buffer_load_ushort v85, v22, s[20:23], 0 offen
  buffer_load_ushort v86, v22, s[24:27], 0 offen
  buffer_load_ushort v87, v22, s[28:31], 0 offen

  s_mov_b32 s20, s54
  s_mov_b32 s21, s55
  s_mov_b32 s22, 256
  s_mov_b32 s23, 0x20000
  v_mov_b32 v55, 0
  s_or_b32 s66, s2, s43
  s_cmp_lg_u32 s66, 0
  s_cbranch_scc1 K1_E0_16
  s_memrealtime s[66:67]
  s_waitcnt lgkmcnt(0)
  s_or_b32 s66, s66, 1
  v_mov_b32 v52, s66
  s_mov_b64 exec, 1
  buffer_store_dword v52, v55, s[20:23], 0 offen sc1
  s_mov_b64 exec, -1

K1_E0_16:
  s_add_u32 s24, s4, 23068672
  s_addc_u32 s25, s5, 0
  s_mov_b32 s26, 16384
  s_mov_b32 s27, 0x20000
  s_add_u32 s28, s4, 24117248
  s_addc_u32 s29, s5, 0
  s_mov_b32 s30, 327680
  s_mov_b32 s31, 0x20000
  v_mov_b32 v32, 0
  v_mov_b32 v33, 0
  v_mov_b32 v34, 0
  v_mov_b32 v35, 0
  v_mov_b32 v36, 0
  v_mov_b32 v37, 0
  v_mov_b32 v38, 0
  v_mov_b32 v39, 0
  v_mov_b32 v40, 0
  v_mov_b32 v41, 0
  v_mov_b32 v42, 0
  v_mov_b32 v43, 0
  v_mov_b32 v44, 0
  v_mov_b32 v45, 0
  v_mov_b32 v46, 0
  v_mov_b32 v47, 0
  v_mov_b32 v48, 0
  v_mov_b32 v49, 0
  v_mov_b32 v50, 0
  v_mov_b32 v51, 0
  v_mov_b32 v128, 0
  v_mov_b32 v129, 0
  v_mov_b32 v130, 0
  v_mov_b32 v131, 0
  v_mov_b32 v132, 0
  v_mov_b32 v133, 0
  v_mov_b32 v134, 0
  v_mov_b32 v135, 0
  v_mov_b32 v136, 0
  v_mov_b32 v137, 0
  v_mov_b32 v138, 0
  v_mov_b32 v139, 0
  v_mov_b32 v140, 0
  v_mov_b32 v141, 0
  v_mov_b32 v142, 0
  v_mov_b32 v143, 0
  v_mov_b32 v144, 0
  v_mov_b32 v145, 0
  v_mov_b32 v146, 0
  v_mov_b32 v147, 0
  v_mov_b32 v56, 0x3f803f80
  v_mov_b32 v57, 0x3f803f80
  v_mov_b32 v58, 0x3f803f80
  v_mov_b32 v59, 0x3f803f80
  s_lshl_b32 s92, s35, 3
  s_add_u32 s93, s92, s62
  s_lshl_b32 s93, s93, 1
  s_add_u32 s93, s93, s43
  s_mul_i32 s93, s93, 640
  s_lshl_b32 s92, s92, 1
  s_add_u32 s92, s92, s43
  s_mul_i32 s92, s92, 640
  v_lshlrev_b32 v19, 2, v1
  v_lshlrev_b32 v17, 3, v1

  s_cmp_eq_u32 s43, 0
  s_cselect_b32 s12, s48, s50
  s_cselect_b32 s13, s49, s51
  s_mov_b32 s14, 819200
  s_mov_b32 s15, 0x20000
  s_mul_i32 s42, s43, 10240
  s_add_u32 s42, s42, 98304

  s_mul_i32 s40, s35, 81920
  v_xor_b32 v23, v30, v21
  v_mul_u32_u24 v24, 1280, v20
  v_lshl_add_u32 v2, v23, 4, v24
  v_xor_b32 v3, 64, v2
  v_add_u32 v3, 10240, v3
  v_add_u32 v4, 20480, v2
  v_add_u32 v5, 20480, v3

  s_waitcnt vmcnt(0)
  v_lshlrev_b32 v148, 16, v60
  v_and_b32 v149, 0xffff0000, v60
  v_lshlrev_b32 v150, 16, v61
  v_and_b32 v151, 0xffff0000, v61
  v_lshlrev_b32 v152, 16, v62
  v_and_b32 v153, 0xffff0000, v62
  v_lshlrev_b32 v154, 16, v63
  v_and_b32 v155, 0xffff0000, v63
  v_lshlrev_b32 v156, 16, v64
  v_and_b32 v157, 0xffff0000, v64
  v_lshlrev_b32 v158, 16, v65
  v_and_b32 v159, 0xffff0000, v65
  v_lshlrev_b32 v160, 16, v66
  v_and_b32 v161, 0xffff0000, v66
  v_lshlrev_b32 v162, 16, v67
  v_and_b32 v163, 0xffff0000, v67
  v_lshlrev_b32 v164, 16, v68
  v_and_b32 v165, 0xffff0000, v68
  v_lshlrev_b32 v166, 16, v69
  v_and_b32 v167, 0xffff0000, v69
  v_lshlrev_b32 v168, 16, v70
  v_and_b32 v169, 0xffff0000, v70
  v_lshlrev_b32 v170, 16, v71
  v_and_b32 v171, 0xffff0000, v71
  v_lshlrev_b32 v172, 16, v72
  v_and_b32 v173, 0xffff0000, v72
  v_lshlrev_b32 v174, 16, v73
  v_and_b32 v175, 0xffff0000, v73
  v_lshlrev_b32 v176, 16, v74
  v_and_b32 v177, 0xffff0000, v74
  v_lshlrev_b32 v178, 16, v75
  v_and_b32 v179, 0xffff0000, v75
  v_lshlrev_b32 v180, 16, v76
  v_and_b32 v181, 0xffff0000, v76
  v_lshlrev_b32 v182, 16, v77
  v_and_b32 v183, 0xffff0000, v77
  v_lshlrev_b32 v184, 16, v78
  v_and_b32 v185, 0xffff0000, v78
  v_lshlrev_b32 v186, 16, v79
  v_and_b32 v187, 0xffff0000, v79
  v_pk_add_f32 v[22:23], v[148:149], v[150:151]
  v_pk_add_f32 v[28:29], v[152:153], v[154:155]
  v_pk_add_f32 v[22:23], v[22:23], v[156:157]
  v_pk_add_f32 v[28:29], v[28:29], v[158:159]
  v_pk_add_f32 v[22:23], v[22:23], v[160:161]
  v_pk_add_f32 v[28:29], v[28:29], v[162:163]
  v_pk_add_f32 v[22:23], v[22:23], v[164:165]
  v_pk_add_f32 v[28:29], v[28:29], v[166:167]
  v_pk_add_f32 v[22:23], v[22:23], v[168:169]
  v_pk_add_f32 v[28:29], v[28:29], v[170:171]
  v_pk_add_f32 v[22:23], v[22:23], v[172:173]
  v_pk_add_f32 v[28:29], v[28:29], v[174:175]
  v_pk_add_f32 v[22:23], v[22:23], v[176:177]
  v_pk_add_f32 v[28:29], v[28:29], v[178:179]
  v_pk_add_f32 v[22:23], v[22:23], v[180:181]
  v_pk_add_f32 v[28:29], v[28:29], v[182:183]
  v_pk_add_f32 v[22:23], v[22:23], v[184:185]
  v_pk_add_f32 v[28:29], v[28:29], v[186:187]
  v_pk_add_f32 v[22:23], v[22:23], v[28:29]
  s_nop 0
  v_add_f32 v22, v22, v23
  s_nop 1
  v_add_f32_dpp v22, v22, v22 row_ror:8 row_mask:0xf bank_mask:0xf
  s_nop 1
  v_add_f32_dpp v22, v22, v22 row_ror:4 row_mask:0xf bank_mask:0xf
  s_nop 1
  v_add_f32_dpp v22, v22, v22 row_ror:2 row_mask:0xf bank_mask:0xf
  s_nop 1
  v_add_f32_dpp v22, v22, v22 row_ror:1 row_mask:0xf bank_mask:0xf
  v_mul_f32 v80, 0x3acccccd, v22
  buffer_load_dword v52, v55, s[20:23], 0 offen sc1
  s_barrier
  s_mov_b32 s67, 0
K1_EP_17:
  s_waitcnt vmcnt(0)
  v_readfirstlane_b32 s95, v52
  s_add_u32 s67, s67, 1
  s_cmp_lg_u32 s95, 0
  s_cbranch_scc1 K1_EO_18
  s_sleep 4
  buffer_load_dword v52, v55, s[20:23], 0 offen sc1
  s_cmp_lt_u32 s67, 100000
  s_cbranch_scc1 K1_EP_17

K1_EO_18:
  v_pk_add_f32 v[148:149], v[148:149], v[80:81] op_sel_hi:[1,0] neg_lo:[0,1] neg_hi:[0,1]
  v_pk_add_f32 v[150:151], v[150:151], v[80:81] op_sel_hi:[1,0] neg_lo:[0,1] neg_hi:[0,1]
  v_pk_add_f32 v[152:153], v[152:153], v[80:81] op_sel_hi:[1,0] neg_lo:[0,1] neg_hi:[0,1]
  v_pk_add_f32 v[154:155], v[154:155], v[80:81] op_sel_hi:[1,0] neg_lo:[0,1] neg_hi:[0,1]
  v_pk_add_f32 v[156:157], v[156:157], v[80:81] op_sel_hi:[1,0] neg_lo:[0,1] neg_hi:[0,1]
  v_pk_add_f32 v[158:159], v[158:159], v[80:81] op_sel_hi:[1,0] neg_lo:[0,1] neg_hi:[0,1]
  v_pk_add_f32 v[160:161], v[160:161], v[80:81] op_sel_hi:[1,0] neg_lo:[0,1] neg_hi:[0,1]
  v_pk_add_f32 v[162:163], v[162:163], v[80:81] op_sel_hi:[1,0] neg_lo:[0,1] neg_hi:[0,1]
  v_pk_add_f32 v[164:165], v[164:165], v[80:81] op_sel_hi:[1,0] neg_lo:[0,1] neg_hi:[0,1]
  v_pk_add_f32 v[166:167], v[166:167], v[80:81] op_sel_hi:[1,0] neg_lo:[0,1] neg_hi:[0,1]
  v_pk_add_f32 v[168:169], v[168:169], v[80:81] op_sel_hi:[1,0] neg_lo:[0,1] neg_hi:[0,1]
  v_pk_add_f32 v[170:171], v[170:171], v[80:81] op_sel_hi:[1,0] neg_lo:[0,1] neg_hi:[0,1]
  v_pk_add_f32 v[172:173], v[172:173], v[80:81] op_sel_hi:[1,0] neg_lo:[0,1] neg_hi:[0,1]
  v_pk_add_f32 v[174:175], v[174:175], v[80:81] op_sel_hi:[1,0] neg_lo:[0,1] neg_hi:[0,1]
  v_pk_add_f32 v[176:177], v[176:177], v[80:81] op_sel_hi:[1,0] neg_lo:[0,1] neg_hi:[0,1]
  v_pk_add_f32 v[178:179], v[178:179], v[80:81] op_sel_hi:[1,0] neg_lo:[0,1] neg_hi:[0,1]
  v_pk_add_f32 v[180:181], v[180:181], v[80:81] op_sel_hi:[1,0] neg_lo:[0,1] neg_hi:[0,1]
  v_pk_add_f32 v[182:183], v[182:183], v[80:81] op_sel_hi:[1,0] neg_lo:[0,1] neg_hi:[0,1]
  v_pk_add_f32 v[184:185], v[184:185], v[80:81] op_sel_hi:[1,0] neg_lo:[0,1] neg_hi:[0,1]
  v_pk_add_f32 v[186:187], v[186:187], v[80:81] op_sel_hi:[1,0] neg_lo:[0,1] neg_hi:[0,1]
  v_pk_mul_f32 v[22:23], v[148:149], v[148:149]
  v_pk_mul_f32 v[28:29], v[150:151], v[150:151]
  v_pk_fma_f32 v[22:23], v[152:153], v[152:153], v[22:23]
  v_pk_fma_f32 v[28:29], v[154:155], v[154:155], v[28:29]
  v_pk_fma_f32 v[22:23], v[156:157], v[156:157], v[22:23]
  v_pk_fma_f32 v[28:29], v[158:159], v[158:159], v[28:29]
  v_pk_fma_f32 v[22:23], v[160:161], v[160:161], v[22:23]
  v_pk_fma_f32 v[28:29], v[162:163], v[162:163], v[28:29]
  v_pk_fma_f32 v[22:23], v[164:165], v[164:165], v[22:23]
  v_pk_fma_f32 v[28:29], v[166:167], v[166:167], v[28:29]
  v_pk_fma_f32 v[22:23], v[168:169], v[168:169], v[22:23]
  v_pk_fma_f32 v[28:29], v[170:171], v[170:171], v[28:29]
  v_pk_fma_f32 v[22:23], v[172:173], v[172:173], v[22:23]
  v_pk_fma_f32 v[28:29], v[174:175], v[174:175], v[28:29]
  v_pk_fma_f32 v[22:23], v[176:177], v[176:177], v[22:23]
  v_pk_fma_f32 v[28:29], v[178:179], v[178:179], v[28:29]
  v_pk_fma_f32 v[22:23], v[180:181], v[180:181], v[22:23]
  v_pk_fma_f32 v[28:29], v[182:183], v[182:183], v[28:29]
  v_pk_fma_f32 v[22:23], v[184:185], v[184:185], v[22:23]
  v_pk_fma_f32 v[28:29], v[186:187], v[186:187], v[28:29]
  v_pk_add_f32 v[22:23], v[22:23], v[28:29]
  s_nop 0
  v_add_f32 v25, v22, v23
  s_nop 1
  v_add_f32_dpp v25, v25, v25 row_ror:8 row_mask:0xf bank_mask:0xf
  s_nop 1
  v_add_f32_dpp v25, v25, v25 row_ror:4 row_mask:0xf bank_mask:0xf
  s_nop 1
  v_add_f32_dpp v25, v25, v25 row_ror:2 row_mask:0xf bank_mask:0xf
  s_nop 1
  v_add_f32_dpp v25, v25, v25 row_ror:1 row_mask:0xf bank_mask:0xf
  v_mul_f32 v25, 0x3acccccd, v25
  v_cvt_pk_bf16_f32 v25, v25, v25
  v_lshlrev_b32 v25, 16, v25
  v_add_f32 v25, 0x3727c5ac, v25
  v_cvt_pk_bf16_f32 v25, v25, v25
  v_lshlrev_b32 v25, 16, v25
  v_sqrt_f32 v25, v25
  s_nop 0
  v_cvt_pk_bf16_f32 v24, v25, v80
  v_mov_b32 v25, s95
  s_mov_b32 exec_lo, 0x10001
  s_mov_b32 exec_hi, 0x10001
  buffer_store_dwordx2 v[24:25], v26, s[24:27], 0 offen sc1
  s_mov_b64 exec, -1

  s_cmp_lg_u32 s62, 0
  s_cbranch_scc1 K1_LC_19
  s_add_u32 s93, s92, 0
  ds_read_b128 v[88:91], v18 offset:0
  ds_read_b128 v[92:95], v18 offset:2048
  ds_read_b128 v[96:99], v18 offset:5120
  ds_read_b128 v[100:103], v18 offset:7168
  ds_read_b128 v[108:111], v16 offset:0
  ds_read_b128 v[112:115], v16 offset:2048
  ds_read_b128 v[116:119], v16 offset:5120
  ds_read_b128 v[120:123], v16 offset:7168
  s_waitcnt lgkmcnt(4)
  v_mfma_f32_16x16x32_bf16 v[128:131], v[56:59], v[88:91], v[128:131]
  v_mfma_f32_16x16x32_bf16 v[132:135], v[56:59], v[92:95], v[132:135]
  v_mfma_f32_16x16x32_bf16 v[136:139], v[56:59], v[96:99], v[136:139]
  v_mfma_f32_16x16x32_bf16 v[140:143], v[56:59], v[100:103], v[140:143]
  s_waitcnt lgkmcnt(0)
  v_mfma_f32_16x16x32_bf16 v[128:131], v[56:59], v[108:111], v[128:131]
  v_mfma_f32_16x16x32_bf16 v[132:135], v[56:59], v[112:115], v[132:135]
  v_mfma_f32_16x16x32_bf16 v[136:139], v[56:59], v[116:119], v[136:139]
  v_mfma_f32_16x16x32_bf16 v[140:143], v[56:59], v[120:123], v[140:143]
  s_nop 7
  v_mov_b32 v24, v128
  v_cmp_eq_u32 vcc, 1, v30
  s_nop 1
  v_cndmask_b32 v24, v24, v132, vcc
  v_cmp_eq_u32 vcc, 2, v30
  s_nop 1
  v_cndmask_b32 v24, v24, v136, vcc
  v_cmp_eq_u32 vcc, 3, v30
  s_nop 1
  v_cndmask_b32 v24, v24, v140, vcc
  v_mov_b32 v22, v24
  v_mov_b32 v23, s95
  buffer_store_dwordx2 v[22:23], v17, s[28:31], s93 offen sc1
K1_LC_19:
  s_barrier
  s_cmp_lg_u32 s62, 1
  s_cbranch_scc1 K1_LC_20
  s_add_u32 s93, s92, 1280
  ds_read_b128 v[88:91], v18 offset:20480
  ds_read_b128 v[92:95], v18 offset:22528
  ds_read_b128 v[96:99], v18 offset:25600
  ds_read_b128 v[100:103], v18 offset:27648
  ds_read_b128 v[108:111], v16 offset:20480
  ds_read_b128 v[112:115], v16 offset:22528
  ds_read_b128 v[116:119], v16 offset:25600
  ds_read_b128 v[120:123], v16 offset:27648
  s_waitcnt lgkmcnt(4)
  v_mfma_f32_16x16x32_bf16 v[128:131], v[56:59], v[88:91], v[128:131]
  v_mfma_f32_16x16x32_bf16 v[132:135], v[56:59], v[92:95], v[132:135]
  v_mfma_f32_16x16x32_bf16 v[136:139], v[56:59], v[96:99], v[136:139]
  v_mfma_f32_16x16x32_bf16 v[140:143], v[56:59], v[100:103], v[140:143]
  s_waitcnt lgkmcnt(0)
  v_mfma_f32_16x16x32_bf16 v[128:131], v[56:59], v[108:111], v[128:131]
  v_mfma_f32_16x16x32_bf16 v[132:135], v[56:59], v[112:115], v[132:135]
  v_mfma_f32_16x16x32_bf16 v[136:139], v[56:59], v[116:119], v[136:139]
  v_mfma_f32_16x16x32_bf16 v[140:143], v[56:59], v[120:123], v[140:143]
  s_nop 7
  v_mov_b32 v24, v128
  v_cmp_eq_u32 vcc, 1, v30
  s_nop 1
  v_cndmask_b32 v24, v24, v132, vcc
  v_cmp_eq_u32 vcc, 2, v30
  s_nop 1
  v_cndmask_b32 v24, v24, v136, vcc
  v_cmp_eq_u32 vcc, 3, v30
  s_nop 1
  v_cndmask_b32 v24, v24, v140, vcc
  v_mov_b32 v22, v24
  v_mov_b32 v23, s95
  buffer_store_dwordx2 v[22:23], v17, s[28:31], s93 offen sc1
K1_LC_20:
  v_lshlrev_b32 v85, 16, v85
  v_lshlrev_b32 v86, 16, v86
  v_lshlrev_b32 v87, 16, v87
  v_mul_f32 v148, 0x3fb8aa3b, v87
  v_exp_f32 v148, v148
  s_nop 0

  v_cvt_pk_bf16_f32 v148, v148, v148
  v_lshlrev_b32 v148, 16, v148
  v_mul_f32 v149, v148, v85
  v_mul_f32 v150, v148, v86
  v_mul_f32 v149, 0x3fb8aa3b, v149
  v_mul_f32 v150, 0x3e22f983, v150
  v_exp_f32 v149, v149
  v_fract_f32 v150, v150
  s_nop 0
  v_cos_f32 v151, v150
  v_sin_f32 v152, v150
  s_nop 0
  v_mul_f32 v8, v149, v151
  v_mul_f32 v9, v149, v152

  v_add_f32 v148, -1.0, v8
  v_mul_f32 v149, v85, v85
  v_fmac_f32 v149, v86, v86
  v_rcp_f32 v149, v149
  v_mul_f32 v150, v148, v85
  v_fmac_f32 v150, v9, v86
  v_mul_f32 v151, v9, v85
  v_fma_f32 v151, -v148, v86, v151
  v_mul_f32 v6, v150, v149
  v_mul_f32 v7, v151, v149

  v_add_f32 v6, v6, v6
  v_add_f32 v7, v7, v7
  v_lshlrev_b32 v22, 3, v1
  v_add_u32 v22, 163328, v22
  ds_write_b64 v22, v[6:7]

  s_barrier
  s_add_u32 m0, s42, 3072
  s_add_u32 s41, s40, 384
  buffer_load_dwordx4 v5, s[12:15], s41 offen lds
  s_add_u32 m0, s42, 5120
  s_add_u32 s41, s40, 41344
  buffer_load_dwordx4 v2, s[12:15], s41 offen lds
  s_add_u32 m0, s42, 6144
  s_add_u32 s41, s40, 41344
  buffer_load_dwordx4 v3, s[12:15], s41 offen lds
  s_add_u32 m0, s42, 7168
  s_add_u32 s41, s40, 41344
  buffer_load_dwordx4 v4, s[12:15], s41 offen lds
  s_add_u32 m0, s42, 8192
  s_add_u32 s41, s40, 41344
  buffer_load_dwordx4 v5, s[12:15], s41 offen lds
  s_add_u32 m0, s42, 23552
  s_add_u32 s41, s40, 512
  buffer_load_dwordx4 v5, s[12:15], s41 offen lds
  s_add_u32 m0, s42, 25600
  s_add_u32 s41, s40, 41472
  buffer_load_dwordx4 v2, s[12:15], s41 offen lds
  s_add_u32 m0, s42, 26624
  s_add_u32 s41, s40, 41472
  buffer_load_dwordx4 v3, s[12:15], s41 offen lds
  s_add_u32 m0, s42, 27648
  s_add_u32 s41, s40, 41472
  buffer_load_dwordx4 v4, s[12:15], s41 offen lds
  s_add_u32 m0, s42, 28672
  s_add_u32 s41, s40, 41472
  buffer_load_dwordx4 v5, s[12:15], s41 offen lds
  s_cmp_lg_u32 s62, 2
  s_cbranch_scc1 K1_LC_21
  s_add_u32 s93, s92, 2560
  ds_read_b128 v[88:91], v18 offset:40960
  ds_read_b128 v[92:95], v18 offset:43008
  ds_read_b128 v[96:99], v18 offset:46080
  ds_read_b128 v[100:103], v18 offset:48128
  ds_read_b128 v[108:111], v16 offset:40960
  ds_read_b128 v[112:115], v16 offset:43008
  ds_read_b128 v[116:119], v16 offset:46080
  ds_read_b128 v[120:123], v16 offset:48128
  s_waitcnt lgkmcnt(4)
  v_mfma_f32_16x16x32_bf16 v[128:131], v[56:59], v[88:91], v[128:131]
  v_mfma_f32_16x16x32_bf16 v[132:135], v[56:59], v[92:95], v[132:135]
  v_mfma_f32_16x16x32_bf16 v[136:139], v[56:59], v[96:99], v[136:139]
  v_mfma_f32_16x16x32_bf16 v[140:143], v[56:59], v[100:103], v[140:143]
  s_waitcnt lgkmcnt(0)
  v_mfma_f32_16x16x32_bf16 v[128:131], v[56:59], v[108:111], v[128:131]
  v_mfma_f32_16x16x32_bf16 v[132:135], v[56:59], v[112:115], v[132:135]
  v_mfma_f32_16x16x32_bf16 v[136:139], v[56:59], v[116:119], v[136:139]
  v_mfma_f32_16x16x32_bf16 v[140:143], v[56:59], v[120:123], v[140:143]
  s_nop 7
  v_mov_b32 v24, v128
  v_cmp_eq_u32 vcc, 1, v30
  s_nop 1
  v_cndmask_b32 v24, v24, v132, vcc
  v_cmp_eq_u32 vcc, 2, v30
  s_nop 1
  v_cndmask_b32 v24, v24, v136, vcc
  v_cmp_eq_u32 vcc, 3, v30
  s_nop 1
  v_cndmask_b32 v24, v24, v140, vcc
  v_mov_b32 v22, v24
  v_mov_b32 v23, s95
  buffer_store_dwordx2 v[22:23], v17, s[28:31], s93 offen sc1
K1_LC_21:
  s_waitcnt vmcnt(5)
  s_barrier
  s_add_u32 m0, s42, 44032
  s_add_u32 s41, s40, 640
  buffer_load_dwordx4 v5, s[12:15], s41 offen lds
  s_add_u32 m0, s42, 46080
  s_add_u32 s41, s40, 41600
  buffer_load_dwordx4 v2, s[12:15], s41 offen lds
  s_add_u32 m0, s42, 47104
  s_add_u32 s41, s40, 41600
  buffer_load_dwordx4 v3, s[12:15], s41 offen lds
  s_add_u32 m0, s42, 48128
  s_add_u32 s41, s40, 41600
  buffer_load_dwordx4 v4, s[12:15], s41 offen lds
  s_add_u32 m0, s42, 49152
  s_add_u32 s41, s40, 41600
  buffer_load_dwordx4 v5, s[12:15], s41 offen lds
  s_cmp_lg_u32 s62, 3
  s_cbranch_scc1 K1_LC_22
  s_add_u32 s93, s92, 3840
  ds_read_b128 v[88:91], v18 offset:0
  ds_read_b128 v[92:95], v18 offset:2048
  ds_read_b128 v[96:99], v18 offset:5120
  ds_read_b128 v[100:103], v18 offset:7168
  ds_read_b128 v[108:111], v16 offset:0
  ds_read_b128 v[112:115], v16 offset:2048
  ds_read_b128 v[116:119], v16 offset:5120
  ds_read_b128 v[120:123], v16 offset:7168
  s_waitcnt lgkmcnt(4)
  v_mfma_f32_16x16x32_bf16 v[128:131], v[56:59], v[88:91], v[128:131]
  v_mfma_f32_16x16x32_bf16 v[132:135], v[56:59], v[92:95], v[132:135]
  v_mfma_f32_16x16x32_bf16 v[136:139], v[56:59], v[96:99], v[136:139]
  v_mfma_f32_16x16x32_bf16 v[140:143], v[56:59], v[100:103], v[140:143]
  s_waitcnt lgkmcnt(0)
  v_mfma_f32_16x16x32_bf16 v[128:131], v[56:59], v[108:111], v[128:131]
  v_mfma_f32_16x16x32_bf16 v[132:135], v[56:59], v[112:115], v[132:135]
  v_mfma_f32_16x16x32_bf16 v[136:139], v[56:59], v[116:119], v[136:139]
  v_mfma_f32_16x16x32_bf16 v[140:143], v[56:59], v[120:123], v[140:143]
  s_nop 7
  v_mov_b32 v24, v128
  v_cmp_eq_u32 vcc, 1, v30
  s_nop 1
  v_cndmask_b32 v24, v24, v132, vcc
  v_cmp_eq_u32 vcc, 2, v30
  s_nop 1
  v_cndmask_b32 v24, v24, v136, vcc
  v_cmp_eq_u32 vcc, 3, v30
  s_nop 1
  v_cndmask_b32 v24, v24, v140, vcc
  v_mov_b32 v22, v24
  v_mov_b32 v23, s95
  buffer_store_dwordx2 v[22:23], v17, s[28:31], s93 offen sc1
K1_LC_22:
  s_waitcnt vmcnt(5)
  s_barrier
  s_cmp_lg_u32 s62, 4
  s_cbranch_scc1 K1_LC_23
  s_add_u32 s93, s92, 5120
  ds_read_b128 v[88:91], v18 offset:20480
  ds_read_b128 v[92:95], v18 offset:22528
  ds_read_b128 v[96:99], v18 offset:25600
  ds_read_b128 v[100:103], v18 offset:27648
  ds_read_b128 v[108:111], v16 offset:20480
  ds_read_b128 v[112:115], v16 offset:22528
  ds_read_b128 v[116:119], v16 offset:25600
  ds_read_b128 v[120:123], v16 offset:27648
  s_waitcnt lgkmcnt(4)
  v_mfma_f32_16x16x32_bf16 v[128:131], v[56:59], v[88:91], v[128:131]
  v_mfma_f32_16x16x32_bf16 v[132:135], v[56:59], v[92:95], v[132:135]
  v_mfma_f32_16x16x32_bf16 v[136:139], v[56:59], v[96:99], v[136:139]
  v_mfma_f32_16x16x32_bf16 v[140:143], v[56:59], v[100:103], v[140:143]
  s_waitcnt lgkmcnt(0)
  v_mfma_f32_16x16x32_bf16 v[128:131], v[56:59], v[108:111], v[128:131]
  v_mfma_f32_16x16x32_bf16 v[132:135], v[56:59], v[112:115], v[132:135]
  v_mfma_f32_16x16x32_bf16 v[136:139], v[56:59], v[116:119], v[136:139]
  v_mfma_f32_16x16x32_bf16 v[140:143], v[56:59], v[120:123], v[140:143]
  s_nop 7
  v_mov_b32 v24, v128
  v_cmp_eq_u32 vcc, 1, v30
  s_nop 1
  v_cndmask_b32 v24, v24, v132, vcc
  v_cmp_eq_u32 vcc, 2, v30
  s_nop 1
  v_cndmask_b32 v24, v24, v136, vcc
  v_cmp_eq_u32 vcc, 3, v30
  s_nop 1
  v_cndmask_b32 v24, v24, v140, vcc
  v_mov_b32 v22, v24
  v_mov_b32 v23, s95
  buffer_store_dwordx2 v[22:23], v17, s[28:31], s93 offen sc1
K1_LC_23:
  v_mul_f32 v22, v9, v9
  v_mul_f32 v23, v8, v9
  v_fma_f32 v10, v8, v8, -v22
  v_add_f32 v11, v23, v23

  v_mul_f32 v22, v11, v11
  v_mul_f32 v23, v10, v11
  v_fma_f32 v10, v10, v10, -v22
  v_add_f32 v11, v23, v23

  v_mul_f32 v22, v11, v11
  v_mul_f32 v23, v10, v11
  v_fma_f32 v10, v10, v10, -v22
  v_add_f32 v11, v23, v23

  v_mul_f32 v22, v11, v11
  v_mul_f32 v23, v10, v11
  v_fma_f32 v188, v10, v10, -v22
  v_add_f32 v189, v23, v23

  v_mul_f32 v22, v189, v189
  v_mul_f32 v23, v188, v189
  v_fma_f32 v190, v188, v188, -v22
  v_add_f32 v191, v23, v23

  v_mul_f32 v22, v191, v191
  v_mul_f32 v23, v190, v191
  v_fma_f32 v190, v190, v190, -v22
  v_add_f32 v191, v23, v23

  v_mul_f32 v22, v191, v191
  v_mul_f32 v23, v190, v191
  v_fma_f32 v190, v190, v190, -v22
  v_add_f32 v191, v23, v23

  v_mul_f32 v22, v191, v191
  v_mul_f32 v23, v190, v191
  v_fma_f32 v190, v190, v190, -v22
  v_add_f32 v191, v23, v23

  v_mov_b32 v148, v6
  v_mov_b32 v149, v7
  v_mul_f32 v150, v188, v148
  v_mul_f32 v151, v188, v149
  v_fma_f32 v150, -v189, v149, v150
  v_fma_f32 v151, v189, v148, v151

  v_mul_f32 v152, v188, v150
  v_mul_f32 v153, v188, v151
  v_fma_f32 v152, -v189, v151, v152
  v_fma_f32 v153, v189, v150, v153

  v_mul_f32 v154, v188, v152
  v_mul_f32 v155, v188, v153
  v_fma_f32 v154, -v189, v153, v154
  v_fma_f32 v155, v189, v152, v155

  v_mul_f32 v156, v188, v154
  v_mul_f32 v157, v188, v155
  v_fma_f32 v156, -v189, v155, v156
  v_fma_f32 v157, v189, v154, v157

  v_mul_f32 v158, v188, v156
  v_mul_f32 v159, v188, v157
  v_fma_f32 v158, -v189, v157, v158
  v_fma_f32 v159, v189, v156, v159

  v_mul_f32 v160, v188, v158
  v_mul_f32 v161, v188, v159
  v_fma_f32 v160, -v189, v159, v160
  v_fma_f32 v161, v189, v158, v161

  v_mul_f32 v162, v188, v160
  v_mul_f32 v163, v188, v161
  v_fma_f32 v162, -v189, v161, v162
  v_fma_f32 v163, v189, v160, v163

  v_mul_f32 v164, v188, v162
  v_mul_f32 v165, v188, v163
  v_fma_f32 v164, -v189, v163, v164
  v_fma_f32 v165, v189, v162, v165

  v_mul_f32 v166, v188, v164
  v_mul_f32 v167, v188, v165
  v_fma_f32 v166, -v189, v165, v166
  v_fma_f32 v167, v189, v164, v167

  v_mul_f32 v168, v188, v166
  v_mul_f32 v169, v188, v167
  v_fma_f32 v168, -v189, v167, v168
  v_fma_f32 v169, v189, v166, v169

  v_mul_f32 v170, v188, v168
  v_mul_f32 v171, v188, v169
  v_fma_f32 v170, -v189, v169, v170
  v_fma_f32 v171, v189, v168, v171

  v_mul_f32 v172, v188, v170
  v_mul_f32 v173, v188, v171
  v_fma_f32 v172, -v189, v171, v172
  v_fma_f32 v173, v189, v170, v173

  v_mul_f32 v174, v188, v172
  v_mul_f32 v175, v188, v173
  v_fma_f32 v174, -v189, v173, v174
  v_fma_f32 v175, v189, v172, v175

  v_mul_f32 v176, v188, v174
  v_mul_f32 v177, v188, v175
  v_fma_f32 v176, -v189, v175, v176
  v_fma_f32 v177, v189, v174, v177

  v_mul_f32 v178, v188, v176
  v_mul_f32 v179, v188, v177
  v_fma_f32 v178, -v189, v177, v178
  v_fma_f32 v179, v189, v176, v179

  v_lshlrev_b32 v22, 4, v1
  v_add_u32 v23, 159744, v22
  ds_write_b128 v23, v[8:11]
  s_waitcnt lgkmcnt(0)

  s_waitcnt vmcnt(0)
  s_barrier
  s_add_u32 m0, s42, 3072
  s_add_u32 s41, s40, 768
  buffer_load_dwordx4 v5, s[12:15], s41 offen lds
  s_add_u32 m0, s42, 5120
  s_add_u32 s41, s40, 41728
  buffer_load_dwordx4 v2, s[12:15], s41 offen lds
  s_add_u32 m0, s42, 6144
  s_add_u32 s41, s40, 41728
  buffer_load_dwordx4 v3, s[12:15], s41 offen lds
  s_add_u32 m0, s42, 7168
  s_add_u32 s41, s40, 41728
  buffer_load_dwordx4 v4, s[12:15], s41 offen lds
  s_add_u32 m0, s42, 8192
  s_add_u32 s41, s40, 41728
  buffer_load_dwordx4 v5, s[12:15], s41 offen lds
  s_add_u32 m0, s42, 23552
  s_add_u32 s41, s40, 896
  buffer_load_dwordx4 v5, s[12:15], s41 offen lds
  s_add_u32 m0, s42, 25600
  s_add_u32 s41, s40, 41856
  buffer_load_dwordx4 v2, s[12:15], s41 offen lds
  s_add_u32 m0, s42, 26624
  s_add_u32 s41, s40, 41856
  buffer_load_dwordx4 v3, s[12:15], s41 offen lds
  s_add_u32 m0, s42, 27648
  s_add_u32 s41, s40, 41856
  buffer_load_dwordx4 v4, s[12:15], s41 offen lds
  s_add_u32 m0, s42, 28672
  s_add_u32 s41, s40, 41856
  buffer_load_dwordx4 v5, s[12:15], s41 offen lds
  s_cmp_lg_u32 s62, 5
  s_cbranch_scc1 K1_LC_24
  s_add_u32 s93, s92, 6400
  ds_read_b128 v[88:91], v18 offset:40960
  ds_read_b128 v[92:95], v18 offset:43008
  ds_read_b128 v[96:99], v18 offset:46080
  ds_read_b128 v[100:103], v18 offset:48128
  ds_read_b128 v[108:111], v16 offset:40960
  ds_read_b128 v[112:115], v16 offset:43008
  ds_read_b128 v[116:119], v16 offset:46080
  ds_read_b128 v[120:123], v16 offset:48128
  s_waitcnt lgkmcnt(4)
  v_mfma_f32_16x16x32_bf16 v[128:131], v[56:59], v[88:91], v[128:131]
  v_mfma_f32_16x16x32_bf16 v[132:135], v[56:59], v[92:95], v[132:135]
  v_mfma_f32_16x16x32_bf16 v[136:139], v[56:59], v[96:99], v[136:139]
  v_mfma_f32_16x16x32_bf16 v[140:143], v[56:59], v[100:103], v[140:143]
  s_waitcnt lgkmcnt(0)
  v_mfma_f32_16x16x32_bf16 v[128:131], v[56:59], v[108:111], v[128:131]
  v_mfma_f32_16x16x32_bf16 v[132:135], v[56:59], v[112:115], v[132:135]
  v_mfma_f32_16x16x32_bf16 v[136:139], v[56:59], v[116:119], v[136:139]
  v_mfma_f32_16x16x32_bf16 v[140:143], v[56:59], v[120:123], v[140:143]
  s_nop 7
  v_mov_b32 v24, v128
  v_cmp_eq_u32 vcc, 1, v30
  s_nop 1
  v_cndmask_b32 v24, v24, v132, vcc
  v_cmp_eq_u32 vcc, 2, v30
  s_nop 1
  v_cndmask_b32 v24, v24, v136, vcc
  v_cmp_eq_u32 vcc, 3, v30
  s_nop 1
  v_cndmask_b32 v24, v24, v140, vcc
  v_mov_b32 v22, v24
  v_mov_b32 v23, s95
  buffer_store_dwordx2 v[22:23], v17, s[28:31], s93 offen sc1
K1_LC_24:
  s_waitcnt vmcnt(5)
  s_barrier
  s_setprio 2
  s_add_u32 m0, s42, 44032
  s_add_u32 s41, s40, 1024
  buffer_load_dwordx4 v5, s[12:15], s41 offen lds
  s_add_u32 m0, s42, 46080
  s_add_u32 s41, s40, 41984
  buffer_load_dwordx4 v2, s[12:15], s41 offen lds
  s_add_u32 m0, s42, 47104
  s_add_u32 s41, s40, 41984
  buffer_load_dwordx4 v3, s[12:15], s41 offen lds
  s_add_u32 m0, s42, 48128
  s_add_u32 s41, s40, 41984
  buffer_load_dwordx4 v4, s[12:15], s41 offen lds
  s_add_u32 m0, s42, 49152
  s_add_u32 s41, s40, 41984
  buffer_load_dwordx4 v5, s[12:15], s41 offen lds
  ds_read_b128 v[88:91], v18 offset:0
  ds_read_b128 v[92:95], v18 offset:2048
  ds_read_b128 v[96:99], v18 offset:5120
  ds_read_b128 v[100:103], v18 offset:7168
  ds_read_b128 v[108:111], v16 offset:0
  ds_read_b128 v[112:115], v16 offset:2048
  ds_read_b128 v[116:119], v16 offset:5120
  ds_read_b128 v[120:123], v16 offset:7168
  s_waitcnt lgkmcnt(4)
  v_mfma_f32_16x16x32_bf16 v[32:35], v[56:59], v[88:91], v[32:35]
  v_mfma_f32_16x16x32_bf16 v[36:39], v[56:59], v[92:95], v[36:39]
  v_mfma_f32_16x16x32_bf16 v[40:43], v[56:59], v[96:99], v[40:43]
  v_mfma_f32_16x16x32_bf16 v[44:47], v[56:59], v[100:103], v[44:47]
  s_waitcnt lgkmcnt(0)
  v_mfma_f32_16x16x32_bf16 v[32:35], v[56:59], v[108:111], v[32:35]
  v_mfma_f32_16x16x32_bf16 v[36:39], v[56:59], v[112:115], v[36:39]
  v_mfma_f32_16x16x32_bf16 v[40:43], v[56:59], v[116:119], v[40:43]
  v_mfma_f32_16x16x32_bf16 v[44:47], v[56:59], v[120:123], v[44:47]
  s_waitcnt vmcnt(5)
  s_barrier
  buffer_load_dwordx2 v[26:27], v53, s[24:27], 0 offen sc1
  buffer_load_dwordx2 v[28:29], v53, s[24:27], 0 offen offset:512 sc1
  s_add_u32 s66, s92, 0
  buffer_load_dwordx2 v[60:61], v17, s[28:31], s66 offen sc1
  s_add_u32 s66, s92, 1280
  buffer_load_dwordx2 v[62:63], v17, s[28:31], s66 offen sc1
  s_add_u32 s66, s92, 2560
  buffer_load_dwordx2 v[64:65], v17, s[28:31], s66 offen sc1
  s_add_u32 s66, s92, 3840
  buffer_load_dwordx2 v[66:67], v17, s[28:31], s66 offen sc1
  s_add_u32 s66, s92, 5120
  buffer_load_dwordx2 v[68:69], v17, s[28:31], s66 offen sc1
  s_add_u32 s66, s92, 6400
  buffer_load_dwordx2 v[70:71], v17, s[28:31], s66 offen sc1
  ds_read_b128 v[88:91], v18 offset:20480
  ds_read_b128 v[92:95], v18 offset:22528
  ds_read_b128 v[96:99], v18 offset:25600
  ds_read_b128 v[100:103], v18 offset:27648
  ds_read_b128 v[108:111], v16 offset:20480
  ds_read_b128 v[112:115], v16 offset:22528
  ds_read_b128 v[116:119], v16 offset:25600
  ds_read_b128 v[120:123], v16 offset:27648
  s_waitcnt lgkmcnt(4)
  v_mfma_f32_16x16x32_bf16 v[32:35], v[56:59], v[88:91], v[32:35]
  v_mfma_f32_16x16x32_bf16 v[36:39], v[56:59], v[92:95], v[36:39]
  v_mfma_f32_16x16x32_bf16 v[40:43], v[56:59], v[96:99], v[40:43]
  v_mfma_f32_16x16x32_bf16 v[44:47], v[56:59], v[100:103], v[44:47]
  s_waitcnt lgkmcnt(0)
  v_mfma_f32_16x16x32_bf16 v[32:35], v[56:59], v[108:111], v[32:35]
  v_mfma_f32_16x16x32_bf16 v[36:39], v[56:59], v[112:115], v[36:39]
  v_mfma_f32_16x16x32_bf16 v[40:43], v[56:59], v[116:119], v[40:43]
  v_mfma_f32_16x16x32_bf16 v[44:47], v[56:59], v[120:123], v[44:47]
  s_waitcnt vmcnt(8)
  s_barrier
  s_add_u32 m0, s42, 3072
  s_add_u32 s41, s40, 1152
  buffer_load_dwordx4 v5, s[12:15], s41 offen lds
  s_add_u32 m0, s42, 5120
  s_add_u32 s41, s40, 42112
  buffer_load_dwordx4 v2, s[12:15], s41 offen lds
  s_add_u32 m0, s42, 6144
  s_add_u32 s41, s40, 42112
  buffer_load_dwordx4 v3, s[12:15], s41 offen lds
  s_add_u32 m0, s42, 7168
  s_add_u32 s41, s40, 42112
  buffer_load_dwordx4 v4, s[12:15], s41 offen lds
  s_add_u32 m0, s42, 8192
  s_add_u32 s41, s40, 42112
  buffer_load_dwordx4 v5, s[12:15], s41 offen lds
  ds_read_b128 v[88:91], v18 offset:40960
  ds_read_b128 v[92:95], v18 offset:43008
  ds_read_b128 v[96:99], v18 offset:46080
  ds_read_b128 v[100:103], v18 offset:48128
  ds_read_b128 v[108:111], v16 offset:40960
  ds_read_b128 v[112:115], v16 offset:43008
  ds_read_b128 v[116:119], v16 offset:46080
  ds_read_b128 v[120:123], v16 offset:48128
  s_waitcnt lgkmcnt(4)
  v_mfma_f32_16x16x32_bf16 v[32:35], v[56:59], v[88:91], v[32:35]
  v_mfma_f32_16x16x32_bf16 v[36:39], v[56:59], v[92:95], v[36:39]
  v_mfma_f32_16x16x32_bf16 v[40:43], v[56:59], v[96:99], v[40:43]
  v_mfma_f32_16x16x32_bf16 v[44:47], v[56:59], v[100:103], v[44:47]
  s_waitcnt lgkmcnt(0)
  v_mfma_f32_16x16x32_bf16 v[32:35], v[56:59], v[108:111], v[32:35]
  v_mfma_f32_16x16x32_bf16 v[36:39], v[56:59], v[112:115], v[36:39]
  v_mfma_f32_16x16x32_bf16 v[40:43], v[56:59], v[116:119], v[40:43]
  v_mfma_f32_16x16x32_bf16 v[44:47], v[56:59], v[120:123], v[44:47]
  s_mov_b64 s[32:33], 0xffff
  s_mul_i32 s65, s43, 256
  v_add_u32 v13, s65, v19
  v_add_u32 v13, 162816, v13
  s_lshl_b32 s65, s43, 9
  v_add_u32 v23, s65, v19
  v_add_u32 v23, 160768, v23
  s_mov_b32 s67, 0
  s_waitcnt vmcnt(5)

K1_GP_25:
  v_cmp_eq_u32 s[68:69], s95, v27
  v_cmp_eq_u32 vcc, s95, v29
  s_and_b64 s[68:69], s[68:69], vcc
  v_cmp_eq_u32 vcc, s95, v61
  s_and_b64 s[68:69], s[68:69], vcc
  v_cmp_eq_u32 vcc, s95, v63
  s_and_b64 s[68:69], s[68:69], vcc
  v_cmp_eq_u32 vcc, s95, v65
  s_and_b64 s[68:69], s[68:69], vcc
  v_cmp_eq_u32 vcc, s95, v67
  s_and_b64 s[68:69], s[68:69], vcc
  v_cmp_eq_u32 vcc, s95, v69
  s_and_b64 s[68:69], s[68:69], vcc
  v_cmp_eq_u32 vcc, s95, v71
  s_and_b64 s[68:69], s[68:69], vcc
  s_cmp_eq_u64 s[68:69], -1
  s_cbranch_scc1 K1_GO_26
  s_add_u32 s67, s67, 1
  s_cmp_ge_u32 s67, 100000
  s_cbranch_scc1 K1_GO_26
  s_sleep 4

  buffer_load_dwordx2 v[26:27], v53, s[24:27], 0 offen sc1
  buffer_load_dwordx2 v[28:29], v53, s[24:27], 0 offen offset:512 sc1
  s_add_u32 s66, s92, 0
  buffer_load_dwordx2 v[60:61], v17, s[28:31], s66 offen sc1
  s_add_u32 s66, s92, 1280
  buffer_load_dwordx2 v[62:63], v17, s[28:31], s66 offen sc1
  s_add_u32 s66, s92, 2560
  buffer_load_dwordx2 v[64:65], v17, s[28:31], s66 offen sc1
  s_add_u32 s66, s92, 3840
  buffer_load_dwordx2 v[66:67], v17, s[28:31], s66 offen sc1
  s_add_u32 s66, s92, 5120
  buffer_load_dwordx2 v[68:69], v17, s[28:31], s66 offen sc1
  s_add_u32 s66, s92, 6400
  buffer_load_dwordx2 v[70:71], v17, s[28:31], s66 offen sc1
  s_waitcnt vmcnt(0)
  s_branch K1_GP_25
K1_GO_26:
  v_lshlrev_b32 v27, 16, v26
  v_lshlrev_b32 v29, 16, v28
  v_and_b32 v26, 0xffff0000, v26
  v_and_b32 v28, 0xffff0000, v28
  v_rcp_f32 v27, v27
  v_rcp_f32 v29, v29
  ds_write_b32 v23, v26 offset:1024
  ds_write_b32 v23, v28 offset:1280
  ds_write_b32 v23, v27
  ds_write_b32 v23, v29 offset:256

  v_add_f32 v60, v60, v62
  v_add_f32 v60, v60, v64
  v_add_f32 v60, v60, v66
  v_add_f32 v60, v60, v68
  v_add_f32 v60, v60, v70
  s_waitcnt vmcnt(0)
  s_barrier
  ds_read_b128 v[88:91], v18 offset:0
  ds_read_b128 v[92:95], v18 offset:2048
  ds_read_b128 v[96:99], v18 offset:5120
  ds_read_b128 v[100:103], v18 offset:7168
  ds_read_b128 v[108:111], v16 offset:0
  ds_read_b128 v[112:115], v16 offset:2048
  ds_read_b128 v[116:119], v16 offset:5120
  ds_read_b128 v[120:123], v16 offset:7168
  s_waitcnt lgkmcnt(4)
  v_mfma_f32_16x16x32_bf16 v[32:35], v[56:59], v[88:91], v[32:35]
  v_mfma_f32_16x16x32_bf16 v[36:39], v[56:59], v[92:95], v[36:39]
  v_mfma_f32_16x16x32_bf16 v[40:43], v[56:59], v[96:99], v[40:43]
  v_mfma_f32_16x16x32_bf16 v[44:47], v[56:59], v[100:103], v[44:47]
  s_waitcnt lgkmcnt(0)
  v_mfma_f32_16x16x32_bf16 v[32:35], v[56:59], v[108:111], v[32:35]
  v_mfma_f32_16x16x32_bf16 v[36:39], v[56:59], v[112:115], v[36:39]
  v_mfma_f32_16x16x32_bf16 v[40:43], v[56:59], v[116:119], v[40:43]
  v_mfma_f32_16x16x32_bf16 v[44:47], v[56:59], v[120:123], v[44:47]
  s_nop 7
  v_mov_b32 v24, v32
  v_cmp_eq_u32 vcc, 1, v30
  s_nop 1
  v_cndmask_b32 v24, v24, v36, vcc
  v_cmp_eq_u32 vcc, 2, v30
  s_nop 1
  v_cndmask_b32 v24, v24, v40, vcc
  v_cmp_eq_u32 vcc, 3, v30
  s_nop 1
  v_cndmask_b32 v24, v24, v44, vcc
  v_mov_b32 v84, s95
  v_mov_b32 v85, 0
  v_mov_b32 v86, 0
  v_mov_b32 v87, 0
  v_mov_b32 v88, 158720
  ds_write_b128 v88, v[84:87]
  ds_write_b64 v88, v[86:87] offset:16
  ds_write_b64 v88, v[86:87] offset:24

  v_add_f32 v24, v24, v60
  ds_write_b32 v13, v24
  s_setprio 0
  s_waitcnt lgkmcnt(0)
  s_barrier
  s_mov_b32 s47, 0
  s_cmp_lg_u32 s43, 0
  s_cbranch_scc1 K1_P2
  v_lshlrev_b32 v22, 4, v1
  v_lshlrev_b32 v23, 3, v1
  v_add_u32 v23, 73728, v23
  v_add_u32 v24, 4096, v22

  s_setprio 3
  v_mov_b32 v25, 158720
  s_mov_b32 s67, 0
K1_SE:
  ds_read_b32 v4, v25 offset:20
  s_add_u32 s67, s67, 1
  s_waitcnt lgkmcnt(0)
  v_readfirstlane_b32 s66, v4
  s_cmp_ge_u32 s66, 4
  s_cbranch_scc1 K1_SE_OK
  s_cmp_ge_u32 s67, 1000000
  s_cbranch_scc1 K1_SE_OK
  s_sleep 1
  s_branch K1_SE

K1_SE_OK:
  ds_read_b64 v[32:33], v23 offset:0
  ds_read_b64 v[34:35], v23 offset:512
  ds_read_b64 v[36:37], v23 offset:1024
  ds_read_b64 v[38:39], v23 offset:1536
  ds_read_b64 v[40:41], v23 offset:2048
  ds_read_b64 v[42:43], v23 offset:2560
  ds_read_b64 v[44:45], v23 offset:3072
  ds_read_b64 v[46:47], v23 offset:3584
  ds_read_b64 v[48:49], v23 offset:4096
  ds_read_b64 v[50:51], v23 offset:4608
  ds_read_b64 v[52:53], v23 offset:5120
  ds_read_b64 v[54:55], v23 offset:5632
  ds_read_b64 v[56:57], v23 offset:6144
  ds_read_b64 v[58:59], v23 offset:6656
  ds_read_b64 v[60:61], v23 offset:7168
  ds_read_b64 v[62:63], v23 offset:7680
  v_mov_b32 v98, s95
  v_mov_b32 v99, 0
  s_waitcnt lgkmcnt(0)
  v_fma_f32 v34, v188, v32, v34
  v_fma_f32 v35, v188, v33, v35
  v_fma_f32 v34, -v189, v33, v34
  v_fma_f32 v35, v189, v32, v35

  v_fma_f32 v36, v188, v34, v36
  v_fma_f32 v37, v188, v35, v37
  v_fma_f32 v36, -v189, v35, v36
  v_fma_f32 v37, v189, v34, v37

  v_fma_f32 v38, v188, v36, v38
  v_fma_f32 v39, v188, v37, v39
  v_fma_f32 v38, -v189, v37, v38
  v_fma_f32 v39, v189, v36, v39

  v_fma_f32 v40, v188, v38, v40
  v_fma_f32 v41, v188, v39, v41
  v_fma_f32 v40, -v189, v39, v40
  v_fma_f32 v41, v189, v38, v41

  v_fma_f32 v42, v188, v40, v42
  v_fma_f32 v43, v188, v41, v43
  v_fma_f32 v42, -v189, v41, v42
  v_fma_f32 v43, v189, v40, v43

  v_fma_f32 v44, v188, v42, v44
  v_fma_f32 v45, v188, v43, v45
  v_fma_f32 v44, -v189, v43, v44
  v_fma_f32 v45, v189, v42, v45

  v_fma_f32 v46, v188, v44, v46
  v_fma_f32 v47, v188, v45, v47
  v_fma_f32 v46, -v189, v45, v46
  v_fma_f32 v47, v189, v44, v47

  v_fma_f32 v48, v188, v46, v48
  v_fma_f32 v49, v188, v47, v49
  v_fma_f32 v48, -v189, v47, v48
  v_fma_f32 v49, v189, v46, v49

  v_fma_f32 v50, v188, v48, v50
  v_fma_f32 v51, v188, v49, v51
  v_fma_f32 v50, -v189, v49, v50
  v_fma_f32 v51, v189, v48, v51

  v_fma_f32 v52, v188, v50, v52
  v_fma_f32 v53, v188, v51, v53
  v_fma_f32 v52, -v189, v51, v52
  v_fma_f32 v53, v189, v50, v53

  v_fma_f32 v54, v188, v52, v54
  v_fma_f32 v55, v188, v53, v55
  v_fma_f32 v54, -v189, v53, v54
  v_fma_f32 v55, v189, v52, v55

  v_fma_f32 v56, v188, v54, v56
  v_fma_f32 v57, v188, v55, v57
  v_fma_f32 v56, -v189, v55, v56
  v_fma_f32 v57, v189, v54, v57

  v_fma_f32 v58, v188, v56, v58
  v_fma_f32 v59, v188, v57, v59
  v_fma_f32 v58, -v189, v57, v58
  v_fma_f32 v59, v189, v56, v59

  v_fma_f32 v60, v188, v58, v60
  v_fma_f32 v61, v188, v59, v61
  v_fma_f32 v60, -v189, v59, v60
  v_fma_f32 v61, v189, v58, v61

  v_fma_f32 v96, v188, v60, v62
  v_fma_f32 v97, v188, v61, v63
  v_fma_f32 v96, -v189, v61, v96
  v_fma_f32 v97, v189, v60, v97

  buffer_store_dwordx4 v[96:99], v22, s[76:79], s91 offen sc1
  s_mov_b32 s67, 0

  s_cmp_eq_u32 s62, 0
  s_cbranch_scc1 K1_POLL0
  buffer_load_dwordx4 v[64:67], v22, s[76:79], s90 offen offset:0 sc1
  buffer_load_dwordx4 v[68:71], v22, s[76:79], s90 offen offset:1024 sc1
  buffer_load_dwordx4 v[72:75], v22, s[76:79], s90 offen offset:2048 sc1
  buffer_load_dwordx4 v[76:79], v22, s[76:79], s90 offen offset:3072 sc1
  buffer_load_dwordx4 v[80:83], v24, s[76:79], s90 offen offset:0 sc1
  buffer_load_dwordx4 v[84:87], v24, s[76:79], s90 offen offset:1024 sc1
  buffer_load_dwordx4 v[88:91], v24, s[76:79], s90 offen offset:2048 sc1
K1_POLL0:
  v_mul_f32 v112, v6, v32
  v_mul_f32 v113, v6, v33
  v_fma_f32 v112, -v7, v33, v112
  v_fma_f32 v113, v7, v32, v113

  v_mul_f32 v114, v6, v34
  v_mul_f32 v115, v6, v35
  v_fma_f32 v114, -v7, v35, v114
  v_fma_f32 v115, v7, v34, v115

  v_mul_f32 v116, v6, v36
  v_mul_f32 v117, v6, v37
  v_fma_f32 v116, -v7, v37, v116
  v_fma_f32 v117, v7, v36, v117

  v_mul_f32 v118, v6, v38
  v_mul_f32 v119, v6, v39
  v_fma_f32 v118, -v7, v39, v118
  v_fma_f32 v119, v7, v38, v119

  v_mul_f32 v120, v6, v40
  v_mul_f32 v121, v6, v41
  v_fma_f32 v120, -v7, v41, v120
  v_fma_f32 v121, v7, v40, v121

  v_mul_f32 v122, v6, v42
  v_mul_f32 v123, v6, v43
  v_fma_f32 v122, -v7, v43, v122
  v_fma_f32 v123, v7, v42, v123

  v_mul_f32 v124, v6, v44
  v_mul_f32 v125, v6, v45
  v_fma_f32 v124, -v7, v45, v124
  v_fma_f32 v125, v7, v44, v125

  v_mul_f32 v126, v6, v46
  v_mul_f32 v127, v6, v47
  v_fma_f32 v126, -v7, v47, v126
  v_fma_f32 v127, v7, v46, v127

  v_mul_f32 v128, v6, v48
  v_mul_f32 v129, v6, v49
  v_fma_f32 v128, -v7, v49, v128
  v_fma_f32 v129, v7, v48, v129

  v_mul_f32 v130, v6, v50
  v_mul_f32 v131, v6, v51
  v_fma_f32 v130, -v7, v51, v130
  v_fma_f32 v131, v7, v50, v131

  v_mul_f32 v132, v6, v52
  v_mul_f32 v133, v6, v53
  v_fma_f32 v132, -v7, v53, v132
  v_fma_f32 v133, v7, v52, v133

  v_mul_f32 v134, v6, v54
  v_mul_f32 v135, v6, v55
  v_fma_f32 v134, -v7, v55, v134
  v_fma_f32 v135, v7, v54, v135

  v_mul_f32 v136, v6, v56
  v_mul_f32 v137, v6, v57
  v_fma_f32 v136, -v7, v57, v136
  v_fma_f32 v137, v7, v56, v137

  v_mul_f32 v138, v6, v58
  v_mul_f32 v139, v6, v59
  v_fma_f32 v138, -v7, v59, v138
  v_fma_f32 v139, v7, v58, v139

  v_mul_f32 v140, v6, v60
  v_mul_f32 v141, v6, v61
  v_fma_f32 v140, -v7, v61, v140
  v_fma_f32 v141, v7, v60, v141

  s_cbranch_scc1 K1_POLLOK
  s_branch K1_POLL1
K1_POLL:
  buffer_load_dwordx4 v[64:67], v22, s[76:79], s90 offen offset:0 sc1
  buffer_load_dwordx4 v[68:71], v22, s[76:79], s90 offen offset:1024 sc1
  buffer_load_dwordx4 v[72:75], v22, s[76:79], s90 offen offset:2048 sc1
  buffer_load_dwordx4 v[76:79], v22, s[76:79], s90 offen offset:3072 sc1
  buffer_load_dwordx4 v[80:83], v24, s[76:79], s90 offen offset:0 sc1
  buffer_load_dwordx4 v[84:87], v24, s[76:79], s90 offen offset:1024 sc1
  buffer_load_dwordx4 v[88:91], v24, s[76:79], s90 offen offset:2048 sc1
K1_POLL1:
  s_waitcnt vmcnt(0)
  s_mov_b64 s[68:69], -1
  s_cmp_le_u32 s62, 0
  s_cbranch_scc1 K1_CHK_27
  v_cmp_eq_u32 vcc, s95, v66
  s_and_b64 s[68:69], s[68:69], vcc

  s_cmp_le_u32 s62, 1
  s_cbranch_scc1 K1_CHK_27
  v_cmp_eq_u32 vcc, s95, v70
  s_and_b64 s[68:69], s[68:69], vcc

  s_cmp_le_u32 s62, 2
  s_cbranch_scc1 K1_CHK_27
  v_cmp_eq_u32 vcc, s95, v74
  s_and_b64 s[68:69], s[68:69], vcc

  s_cmp_le_u32 s62, 3
  s_cbranch_scc1 K1_CHK_27
  v_cmp_eq_u32 vcc, s95, v78
  s_and_b64 s[68:69], s[68:69], vcc

  s_cmp_le_u32 s62, 4
  s_cbranch_scc1 K1_CHK_27
  v_cmp_eq_u32 vcc, s95, v82
  s_and_b64 s[68:69], s[68:69], vcc

  s_cmp_le_u32 s62, 5
  s_cbranch_scc1 K1_CHK_27
  v_cmp_eq_u32 vcc, s95, v86
  s_and_b64 s[68:69], s[68:69], vcc

  s_cmp_le_u32 s62, 6
  s_cbranch_scc1 K1_CHK_27
  v_cmp_eq_u32 vcc, s95, v90
  s_and_b64 s[68:69], s[68:69], vcc

K1_CHK_27:
  s_cmp_eq_u64 s[68:69], -1
  s_cbranch_scc1 K1_POLLOK
  s_add_u32 s67, s67, 1
  s_cmp_lt_u32 s67, 100000
  s_sleep 1
  s_cbranch_scc1 K1_POLL

K1_POLLOK:
  v_mov_b32 v104, 0
  v_mov_b32 v105, 0
  s_cmp_le_u32 s62, 0
  s_cbranch_scc1 K1_CAR_28
  v_fma_f32 v106, v190, v104, v64
  v_fma_f32 v107, v190, v105, v65
  v_fma_f32 v106, -v191, v105, v106
  v_fma_f32 v107, v191, v104, v107

  v_mov_b32 v104, v106
  v_mov_b32 v105, v107
  s_cmp_le_u32 s62, 1
  s_cbranch_scc1 K1_CAR_28
  v_fma_f32 v106, v190, v104, v68
  v_fma_f32 v107, v190, v105, v69
  v_fma_f32 v106, -v191, v105, v106
  v_fma_f32 v107, v191, v104, v107

  v_mov_b32 v104, v106
  v_mov_b32 v105, v107
  s_cmp_le_u32 s62, 2
  s_cbranch_scc1 K1_CAR_28
  v_fma_f32 v106, v190, v104, v72
  v_fma_f32 v107, v190, v105, v73
  v_fma_f32 v106, -v191, v105, v106
  v_fma_f32 v107, v191, v104, v107

  v_mov_b32 v104, v106
  v_mov_b32 v105, v107
  s_cmp_le_u32 s62, 3
  s_cbranch_scc1 K1_CAR_28
  v_fma_f32 v106, v190, v104, v76
  v_fma_f32 v107, v190, v105, v77
  v_fma_f32 v106, -v191, v105, v106
  v_fma_f32 v107, v191, v104, v107

  v_mov_b32 v104, v106
  v_mov_b32 v105, v107
  s_cmp_le_u32 s62, 4
  s_cbranch_scc1 K1_CAR_28
  v_fma_f32 v106, v190, v104, v80
  v_fma_f32 v107, v190, v105, v81
  v_fma_f32 v106, -v191, v105, v106
  v_fma_f32 v107, v191, v104, v107

  v_mov_b32 v104, v106
  v_mov_b32 v105, v107
  s_cmp_le_u32 s62, 5
  s_cbranch_scc1 K1_CAR_28
  v_fma_f32 v106, v190, v104, v84
  v_fma_f32 v107, v190, v105, v85
  v_fma_f32 v106, -v191, v105, v106
  v_fma_f32 v107, v191, v104, v107

  v_mov_b32 v104, v106
  v_mov_b32 v105, v107
  s_cmp_le_u32 s62, 6
  s_cbranch_scc1 K1_CAR_28
  v_fma_f32 v106, v190, v104, v88
  v_fma_f32 v107, v190, v105, v89
  v_fma_f32 v106, -v191, v105, v106
  v_fma_f32 v107, v191, v104, v107

  v_mov_b32 v104, v106
  v_mov_b32 v105, v107
K1_CAR_28:
  v_mul_f32 v108, v148, v104
  v_mul_f32 v109, v148, v105
  v_fma_f32 v112, v150, v104, v112
  v_fma_f32 v113, v150, v105, v113
  v_fma_f32 v114, v152, v104, v114
  v_fma_f32 v115, v152, v105, v115
  v_fma_f32 v116, v154, v104, v116
  v_fma_f32 v117, v154, v105, v117
  v_fma_f32 v108, -v149, v105, v108
  v_fma_f32 v109, v149, v104, v109
  v_fma_f32 v112, -v151, v105, v112
  v_fma_f32 v113, v151, v104, v113
  v_fma_f32 v114, -v153, v105, v114
  v_fma_f32 v115, v153, v104, v115
  v_fma_f32 v116, -v155, v105, v116
  v_fma_f32 v117, v155, v104, v117
  ds_write_b64 v23, v[108:109] offset:0
  ds_write_b64 v23, v[112:113] offset:512
  ds_write_b64 v23, v[114:115] offset:1024
  ds_write_b64 v23, v[116:117] offset:1536
  v_fma_f32 v118, v156, v104, v118
  v_fma_f32 v119, v156, v105, v119
  v_fma_f32 v120, v158, v104, v120
  v_fma_f32 v121, v158, v105, v121
  v_fma_f32 v122, v160, v104, v122
  v_fma_f32 v123, v160, v105, v123
  v_fma_f32 v124, v162, v104, v124
  v_fma_f32 v125, v162, v105, v125
  v_fma_f32 v118, -v157, v105, v118
  v_fma_f32 v119, v157, v104, v119
  v_fma_f32 v120, -v159, v105, v120
  v_fma_f32 v121, v159, v104, v121
  v_fma_f32 v122, -v161, v105, v122
  v_fma_f32 v123, v161, v104, v123
  v_fma_f32 v124, -v163, v105, v124
  v_fma_f32 v125, v163, v104, v125
  ds_write_b64 v23, v[118:119] offset:2048
  ds_write_b64 v23, v[120:121] offset:2560
  ds_write_b64 v23, v[122:123] offset:3072
  ds_write_b64 v23, v[124:125] offset:3584
  v_fma_f32 v126, v164, v104, v126
  v_fma_f32 v127, v164, v105, v127
  v_fma_f32 v128, v166, v104, v128
  v_fma_f32 v129, v166, v105, v129
  v_fma_f32 v130, v168, v104, v130
  v_fma_f32 v131, v168, v105, v131
  v_fma_f32 v132, v170, v104, v132
  v_fma_f32 v133, v170, v105, v133
  v_fma_f32 v126, -v165, v105, v126
  v_fma_f32 v127, v165, v104, v127
  v_fma_f32 v128, -v167, v105, v128
  v_fma_f32 v129, v167, v104, v129
  v_fma_f32 v130, -v169, v105, v130
  v_fma_f32 v131, v169, v104, v131
  v_fma_f32 v132, -v171, v105, v132
  v_fma_f32 v133, v171, v104, v133
  ds_write_b64 v23, v[126:127] offset:4096
  ds_write_b64 v23, v[128:129] offset:4608
  ds_write_b64 v23, v[130:131] offset:5120
  ds_write_b64 v23, v[132:133] offset:5632
  v_fma_f32 v134, v172, v104, v134
  v_fma_f32 v135, v172, v105, v135
  v_fma_f32 v136, v174, v104, v136
  v_fma_f32 v137, v174, v105, v137
  v_fma_f32 v138, v176, v104, v138
  v_fma_f32 v139, v176, v105, v139
  v_fma_f32 v140, v178, v104, v140
  v_fma_f32 v141, v178, v105, v141
  v_fma_f32 v134, -v173, v105, v134
  v_fma_f32 v135, v173, v104, v135
  v_fma_f32 v136, -v175, v105, v136
  v_fma_f32 v137, v175, v104, v137
  v_fma_f32 v138, -v177, v105, v138
  v_fma_f32 v139, v177, v104, v139
  v_fma_f32 v140, -v179, v105, v140
  v_fma_f32 v141, v179, v104, v141
  ds_write_b64 v23, v[134:135] offset:6144
  ds_write_b64 v23, v[136:137] offset:6656
  ds_write_b64 v23, v[138:139] offset:7168
  ds_write_b64 v23, v[140:141] offset:7680
  v_mov_b32 v4, 1
  ds_write_b32 v25, v4 offset:24
  s_mov_b32 s47, 0
  s_setprio 0
K1_P2:
  s_and_b32 s46, s3, 3
  s_mov_b32 s50, s35
  s_bfe_u32 s49, s86, 0x10003
  s_lshl_b32 s49, s49, 2
  s_bfe_u32 s65, s86, 0x20001
  s_add_u32 s49, s49, s65
  s_lshr_b32 s48, s86, 4
  s_lshl_b32 s48, s48, 1
  s_and_b32 s65, s86, 1
  s_add_u32 s48, s48, s65
  s_lshl_b32 s51, s48, 6
  s_lshl_b32 s65, s62, 2
  s_add_u32 s48, s48, s65
  s_mul_i32 s52, s49, 491520
  s_add_u32 s53, s52, 98304
  s_add_u32 s54, s52, 196608
  s_add_u32 s55, s52, 294912
  s_add_u32 s56, s52, 393216
  s_xor_b32 s65, s3, 2
  s_cmp_ge_u32 s3, 4
  s_cselect_b32 s65, s65, s3
  s_mul_i32 s36, s65, 20480
  s_movk_i32 s41, 4096
  s_cselect_b32 s40, s41, 4294885376
  s_cselect_b32 s41, 12288, s41
  s_mov_b32 s66, 77824
  s_cselect_b32 s66, 40960, s66
  s_cmp_eq_u32 s3, 3
  s_cselect_b32 s38, 0x40000000, 0
  s_sub_u32 s40, s40, s38
  s_add_u32 s38, s38, 4096
  s_cmp_eq_u32 s3, 7
  s_cselect_b32 s39, 0x40000000, 0
  s_add_u32 s39, s39, 4096
  s_lshl_b32 s65, s46, 10
  s_add_u32 s65, s65, s66

  v_lshlrev_b32 v2, 4, v1
  v_add_u32 v3, s65, v2
  v_mov_b32 v4, v3
  v_add_u32 v13, s36, v2
  v_and_b32 v5, 15, v1
  v_lshrrev_b32 v6, 4, v1
  v_mov_b32 v9, 158720

  s_add_u32 s8, s4, 4194304
  s_addc_u32 s9, s5, 0
  s_mov_b32 s10, 12582912
  s_mov_b32 s11, 0x20000
  s_add_u32 s12, s4, 17825792
  s_addc_u32 s13, s5, 0
  s_mov_b32 s14, 3932160
  s_mov_b32 s15, 0x20000
  s_add_u32 s20, s4, 24510464
  s_addc_u32 s21, s5, 0
  s_mov_b32 s22, 16384
  s_mov_b32 s23, 0x20000
  s_xor_b32 s65, s46, 0
  s_lshl_b32 s66, s48, 2
  s_add_u32 s65, s65, s66
  s_mul_i32 s32, s65, 98304
  s_xor_b32 s65, s46, 1
  s_lshl_b32 s66, s48, 2
  s_add_u32 s65, s65, s66
  s_mul_i32 s33, s65, 98304
  s_xor_b32 s65, s46, 2
  s_lshl_b32 s66, s48, 2
  s_add_u32 s65, s65, s66
  s_mul_i32 s34, s65, 98304
  s_xor_b32 s65, s46, 3
  s_lshl_b32 s66, s48, 2
  s_add_u32 s65, s65, s66
  s_mul_i32 s35, s65, 98304
  s_lshl_b32 s65, s48, 6
  s_lshl_b32 s66, s46, 4
  s_add_u32 s65, s65, s66
  v_add_u32 v7, s65, v5
  v_lshlrev_b32 v12, 2, v6
  s_mul_i32 s66, s49, 80
  v_add_u32 v12, s66, v12
  v_mul_u32_u24 v7, 640, v7
  v_add_u32 v7, v7, v12
  v_lshlrev_b32 v8, 1, v7
  v_lshlrev_b32 v7, 2, v7
  v_lshlrev_b32 v12, 1, v12

  s_mov_b32 s28, s100
  s_mov_b32 s29, s101
  s_mov_b32 s30, 5242880
  s_mov_b32 s31, 0x20000
  s_cmp_lt_u32 s3, 4
  s_cbranch_scc1 K1_P2W
  s_mov_b32 s16, s6
  s_mov_b32 s17, s7
  s_mov_b32 s18, 2621440
  s_mov_b32 s19, 0x20000
  s_mov_b32 s24, s96
  s_mov_b32 s25, s97
  s_mov_b32 s26, 1280
  s_mov_b32 s27, 0x20000
  buffer_load_dwordx2 v[96:97], v8, s[16:19], 0 offen offset:0
  buffer_load_dwordx2 v[106:107], v12, s[24:27], 0 offen offset:0
  buffer_load_dwordx2 v[98:99], v8, s[16:19], 0 offen offset:32
  buffer_load_dwordx2 v[108:109], v12, s[24:27], 0 offen offset:32
  buffer_load_dwordx2 v[100:101], v8, s[16:19], 0 offen offset:64
  buffer_load_dwordx2 v[110:111], v12, s[24:27], 0 offen offset:64
  buffer_load_dwordx2 v[102:103], v8, s[16:19], 0 offen offset:96
  buffer_load_dwordx2 v[112:113], v12, s[24:27], 0 offen offset:96
  buffer_load_dwordx2 v[104:105], v8, s[16:19], 0 offen offset:128
  buffer_load_dwordx2 v[114:115], v12, s[24:27], 0 offen offset:128
  v_bfe_u32 v14, v1, 1, 2
  v_lshlrev_b32 v14, 4, v14
  v_and_b32 v10, 1, v1
  v_lshl_add_u32 v14, v10, 1, v14
  v_bfe_u32 v10, v1, 3, 1
  v_add_u32 v14, v14, v10
  s_lshl_b32 s65, s46, 2
  v_add_u32 v14, s65, v14
  s_lshl_b32 s65, s46, 4
  v_add_u32 v10, s65, v5
  s_cmp_lt_u32 s50, 10
  s_cselect_b64 vcc, -1, 0
  v_cndmask_b32 v14, v10, v14, vcc
  v_add_u32 v14, s51, v14
  v_lshlrev_b32 v14, 2, v14
  v_add_u32 v14, 160768, v14

K1_P2BAR:
  s_cmp_eq_u32 s47, 0
  s_cbranch_scc1 K1_P2E
  s_barrier
  s_sub_u32 s47, s47, 1
  s_branch K1_P2BAR

K1_P2E:
  ds_read_b32 v11, v14
  ds_read_b32 v10, v14 offset:1024
  ds_read_b32 v12, v9
  v_mov_b32 v14, 16
  s_waitcnt lgkmcnt(0)
  v_readfirstlane_b32 s95, v12
  s_mov_b64 exec, 1
  ds_add_u32 v9, v14 offset:12
  s_mov_b64 exec, -1

K1_P2W:
  v_lshlrev_b32 v5, 2, v1
  s_lshl_b32 s65, s49, 8
  s_add_u32 s65, s65, 8192
  v_add_u32 v14, 16, v9

  s_cmp_ge_u32 s50, 10
  s_cbranch_scc1 K1_HLA_OK
  s_mov_b32 s67, 0
K1_HLA:
  ds_read_b32 v6, v9 offset:24
  s_add_u32 s67, s67, 1
  s_waitcnt lgkmcnt(0)
  v_readfirstlane_b32 s66, v6
  s_cmp_lg_u32 s66, 0
  s_cbranch_scc1 K1_HLA_OK
  s_cmp_ge_u32 s67, 1000000
  s_cbranch_scc1 K1_HLA_OK
  s_sleep 1
  s_branch K1_HLA

K1_HLA_OK:
  s_mov_b32 s67, 0
  s_cmp_eq_u32 s3, 4
  s_cbranch_scc0 K1_P2SPINW
K1_P2POLLW:
  buffer_load_dword v6, v5, s[20:23], s65 offen sc1
  s_waitcnt vmcnt(0)
  v_cmp_eq_u32 vcc, s95, v6
  s_add_u32 s67, s67, 1
  s_cmp_eq_u64 vcc, -1
  s_cbranch_scc1 K1_P2SETW
  s_cmp_ge_u32 s67, 100000
  s_cbranch_scc1 K1_P2SETW
  s_sleep 8
  s_branch K1_P2POLLW

K1_P2SETW:
  v_mov_b32 v6, 1
  ds_write_b32 v14, v6
  s_branch K1_P2GOW
K1_P2SPINW:
  ds_read_b32 v6, v14
  s_add_u32 s67, s67, 1
  s_waitcnt lgkmcnt(0)
  v_readfirstlane_b32 s66, v6
  s_cmp_lg_u32 s66, 0
  s_cbranch_scc1 K1_P2GOW
  s_cmp_ge_u32 s67, 1000000
  s_cbranch_scc1 K1_P2GOW
  s_sleep 1
  s_branch K1_P2SPINW

K1_P2GOW:
  buffer_load_dwordx4 v[144:147], v4, s[12:15], s52 offen sc1
  buffer_load_dwordx4 v[148:151], v4, s[12:15], s53 offen sc1
  buffer_load_dwordx4 v[152:155], v4, s[12:15], s54 offen sc1
  buffer_load_dwordx4 v[156:159], v4, s[12:15], s55 offen sc1
  buffer_load_dwordx4 v[160:163], v4, s[12:15], s56 offen sc1
  v_add_u32 v4, s38, v4
  buffer_load_dwordx4 v[164:167], v4, s[12:15], s52 offen sc1
  buffer_load_dwordx4 v[168:171], v4, s[12:15], s53 offen sc1
  buffer_load_dwordx4 v[172:175], v4, s[12:15], s54 offen sc1
  buffer_load_dwordx4 v[176:179], v4, s[12:15], s55 offen sc1
  buffer_load_dwordx4 v[180:183], v4, s[12:15], s56 offen sc1
  v_add_u32 v4, s40, v4
  buffer_load_dwordx4 a[0:3], v4, s[12:15], s52 offen sc1
  buffer_load_dwordx4 a[4:7], v4, s[12:15], s53 offen sc1
  buffer_load_dwordx4 a[8:11], v4, s[12:15], s54 offen sc1
  buffer_load_dwordx4 a[12:15], v4, s[12:15], s55 offen sc1
  buffer_load_dwordx4 a[16:19], v4, s[12:15], s56 offen sc1
  v_add_u32 v4, 4096, v4
  buffer_load_dwordx4 a[20:23], v4, s[12:15], s52 offen sc1
  buffer_load_dwordx4 a[24:27], v4, s[12:15], s53 offen sc1
  buffer_load_dwordx4 a[28:31], v4, s[12:15], s54 offen sc1
  buffer_load_dwordx4 a[32:35], v4, s[12:15], s55 offen sc1
  buffer_load_dwordx4 a[36:39], v4, s[12:15], s56 offen sc1
  v_add_u32 v4, 4096, v4
  buffer_load_dwordx4 a[40:43], v4, s[12:15], s52 offen sc1
  buffer_load_dwordx4 a[44:47], v4, s[12:15], s53 offen sc1
  buffer_load_dwordx4 a[48:51], v4, s[12:15], s54 offen sc1
  buffer_load_dwordx4 a[52:55], v4, s[12:15], s55 offen sc1
  buffer_load_dwordx4 a[56:59], v4, s[12:15], s56 offen sc1
  v_add_u32 v4, 4096, v4
  s_add_u32 m0, s36, 0
  s_nop 0
  buffer_load_dwordx4 v4, s[12:15], s52 offen sc1 lds
  s_add_u32 m0, s36, 1024
  s_nop 0
  buffer_load_dwordx4 v4, s[12:15], s53 offen sc1 lds
  s_add_u32 m0, s36, 2048
  s_nop 0
  buffer_load_dwordx4 v4, s[12:15], s54 offen sc1 lds
  s_add_u32 m0, s36, 3072
  s_nop 0
  buffer_load_dwordx4 v4, s[12:15], s55 offen sc1 lds
  s_add_u32 m0, s36, 4096
  s_nop 0
  buffer_load_dwordx4 v4, s[12:15], s56 offen sc1 lds
  v_add_u32 v4, 4096, v4
  s_add_u32 m0, s36, 5120
  s_nop 0
  buffer_load_dwordx4 v4, s[12:15], s52 offen sc1 lds
  s_add_u32 m0, s36, 6144
  s_nop 0
  buffer_load_dwordx4 v4, s[12:15], s53 offen sc1 lds
  s_add_u32 m0, s36, 7168
  s_nop 0
  buffer_load_dwordx4 v4, s[12:15], s54 offen sc1 lds
  s_add_u32 m0, s36, 8192
  s_nop 0
  buffer_load_dwordx4 v4, s[12:15], s55 offen sc1 lds
  s_add_u32 m0, s36, 9216
  s_nop 0
  buffer_load_dwordx4 v4, s[12:15], s56 offen sc1 lds
  v_add_u32 v4, 4096, v4
  s_add_u32 m0, s36, 10240
  s_nop 0
  buffer_load_dwordx4 v4, s[12:15], s52 offen sc1 lds
  s_add_u32 m0, s36, 11264
  s_nop 0
  buffer_load_dwordx4 v4, s[12:15], s53 offen sc1 lds
  s_add_u32 m0, s36, 12288
  s_nop 0
  buffer_load_dwordx4 v4, s[12:15], s54 offen sc1 lds
  s_add_u32 m0, s36, 13312
  s_nop 0
  buffer_load_dwordx4 v4, s[12:15], s55 offen sc1 lds
  s_add_u32 m0, s36, 14336
  s_nop 0
  buffer_load_dwordx4 v4, s[12:15], s56 offen sc1 lds
  v_add_u32 v4, 4096, v4
  v_mov_b32 v16, 0
  v_mov_b32 v17, 0
  v_mov_b32 v18, 0
  v_mov_b32 v19, 0
  v_mov_b32 v20, 0
  v_mov_b32 v21, 0
  v_mov_b32 v22, 0
  v_mov_b32 v23, 0
  v_mov_b32 v24, 0
  v_mov_b32 v25, 0
  v_mov_b32 v26, 0
  v_mov_b32 v27, 0
  v_mov_b32 v28, 0
  v_mov_b32 v29, 0
  v_mov_b32 v30, 0
  v_mov_b32 v31, 0
  v_mov_b32 v32, 0
  v_mov_b32 v33, 0
  v_mov_b32 v34, 0
  v_mov_b32 v35, 0
  v_mov_b32 v36, 0
  v_mov_b32 v37, 0
  v_mov_b32 v38, 0
  v_mov_b32 v39, 0
  v_mov_b32 v40, 0
  v_mov_b32 v41, 0
  v_mov_b32 v42, 0
  v_mov_b32 v43, 0
  v_mov_b32 v44, 0
  v_mov_b32 v45, 0
  v_mov_b32 v46, 0
  v_mov_b32 v47, 0
  v_mov_b32 v48, 0
  v_mov_b32 v49, 0
  v_mov_b32 v50, 0
  v_mov_b32 v51, 0
  v_mov_b32 v52, 0
  v_mov_b32 v53, 0
  v_mov_b32 v54, 0
  v_mov_b32 v55, 0
  v_mov_b32 v56, 0
  v_mov_b32 v57, 0
  v_mov_b32 v58, 0
  v_mov_b32 v59, 0
  v_mov_b32 v60, 0
  v_mov_b32 v61, 0
  v_mov_b32 v62, 0
  v_mov_b32 v63, 0
  v_mov_b32 v64, 0
  v_mov_b32 v65, 0
  v_mov_b32 v66, 0
  v_mov_b32 v67, 0
  v_mov_b32 v68, 0
  v_mov_b32 v69, 0
  v_mov_b32 v70, 0
  v_mov_b32 v71, 0
  v_mov_b32 v72, 0
  v_mov_b32 v73, 0
  v_mov_b32 v74, 0
  v_mov_b32 v75, 0
  v_mov_b32 v76, 0
  v_mov_b32 v77, 0
  v_mov_b32 v78, 0
  v_mov_b32 v79, 0
  v_mov_b32 v80, 0
  v_mov_b32 v81, 0
  v_mov_b32 v82, 0
  v_mov_b32 v83, 0
  v_mov_b32 v84, 0
  v_mov_b32 v85, 0
  v_mov_b32 v86, 0
  v_mov_b32 v87, 0
  v_mov_b32 v88, 0
  v_mov_b32 v89, 0
  v_mov_b32 v90, 0
  v_mov_b32 v91, 0
  v_mov_b32 v92, 0
  v_mov_b32 v93, 0
  v_mov_b32 v94, 0
  v_mov_b32 v95, 0
  s_cmp_lt_u32 s3, 4
  s_cbranch_scc1 K1_P2W2
  s_waitcnt vmcnt(40)
  v_lshlrev_b32 v14, 16, v96
  v_and_b32 v15, 0xffff0000, v96
  v_sub_f32 v12, v14, v10
  v_sub_f32 v8, v15, v10
  v_cvt_pk_bf16_f32 v12, v12, v8
  v_and_b32 v8, 0xffff0000, v12
  v_lshlrev_b32 v12, 16, v12
  v_mul_f32 v12, v12, v11
  v_mul_f32 v8, v8, v11
  v_cvt_pk_bf16_f32 v12, v12, v8
  v_and_b32 v8, 0xffff0000, v12
  v_lshlrev_b32 v12, 16, v12
  v_lshlrev_b32 v5, 16, v106
  v_and_b32 v6, 0xffff0000, v106
  v_mul_f32 v12, v12, v5
  v_mul_f32 v8, v8, v6
  v_cvt_pk_bf16_f32 v12, v12, v8
  v_and_b32 v8, 0xffff0000, v12
  v_lshlrev_b32 v12, 16, v12
  v_add_f32 v16, v12, v14
  v_add_f32 v17, v8, v15

  v_lshlrev_b32 v14, 16, v97
  v_and_b32 v15, 0xffff0000, v97
  v_sub_f32 v12, v14, v10
  v_sub_f32 v8, v15, v10
  v_cvt_pk_bf16_f32 v12, v12, v8
  v_and_b32 v8, 0xffff0000, v12
  v_lshlrev_b32 v12, 16, v12
  v_mul_f32 v12, v12, v11
  v_mul_f32 v8, v8, v11
  v_cvt_pk_bf16_f32 v12, v12, v8
  v_and_b32 v8, 0xffff0000, v12
  v_lshlrev_b32 v12, 16, v12
  v_lshlrev_b32 v5, 16, v107
  v_and_b32 v6, 0xffff0000, v107
  v_mul_f32 v12, v12, v5
  v_mul_f32 v8, v8, v6
  v_cvt_pk_bf16_f32 v12, v12, v8
  v_and_b32 v8, 0xffff0000, v12
  v_lshlrev_b32 v12, 16, v12
  v_add_f32 v18, v12, v14
  v_add_f32 v19, v8, v15

  v_lshlrev_b32 v14, 16, v98
  v_and_b32 v15, 0xffff0000, v98
  v_sub_f32 v12, v14, v10
  v_sub_f32 v8, v15, v10
  v_cvt_pk_bf16_f32 v12, v12, v8
  v_and_b32 v8, 0xffff0000, v12
  v_lshlrev_b32 v12, 16, v12
  v_mul_f32 v12, v12, v11
  v_mul_f32 v8, v8, v11
  v_cvt_pk_bf16_f32 v12, v12, v8
  v_and_b32 v8, 0xffff0000, v12
  v_lshlrev_b32 v12, 16, v12
  v_lshlrev_b32 v5, 16, v108
  v_and_b32 v6, 0xffff0000, v108
  v_mul_f32 v12, v12, v5
  v_mul_f32 v8, v8, v6
  v_cvt_pk_bf16_f32 v12, v12, v8
  v_and_b32 v8, 0xffff0000, v12
  v_lshlrev_b32 v12, 16, v12
  v_add_f32 v32, v12, v14
  v_add_f32 v33, v8, v15

  v_lshlrev_b32 v14, 16, v99
  v_and_b32 v15, 0xffff0000, v99
  v_sub_f32 v12, v14, v10
  v_sub_f32 v8, v15, v10
  v_cvt_pk_bf16_f32 v12, v12, v8
  v_and_b32 v8, 0xffff0000, v12
  v_lshlrev_b32 v12, 16, v12
  v_mul_f32 v12, v12, v11
  v_mul_f32 v8, v8, v11
  v_cvt_pk_bf16_f32 v12, v12, v8
  v_and_b32 v8, 0xffff0000, v12
  v_lshlrev_b32 v12, 16, v12
  v_lshlrev_b32 v5, 16, v109
  v_and_b32 v6, 0xffff0000, v109
  v_mul_f32 v12, v12, v5
  v_mul_f32 v8, v8, v6
  v_cvt_pk_bf16_f32 v12, v12, v8
  v_and_b32 v8, 0xffff0000, v12
  v_lshlrev_b32 v12, 16, v12
  v_add_f32 v34, v12, v14
  v_add_f32 v35, v8, v15

  v_lshlrev_b32 v14, 16, v100
  v_and_b32 v15, 0xffff0000, v100
  v_sub_f32 v12, v14, v10
  v_sub_f32 v8, v15, v10
  v_cvt_pk_bf16_f32 v12, v12, v8
  v_and_b32 v8, 0xffff0000, v12
  v_lshlrev_b32 v12, 16, v12
  v_mul_f32 v12, v12, v11
  v_mul_f32 v8, v8, v11
  v_cvt_pk_bf16_f32 v12, v12, v8
  v_and_b32 v8, 0xffff0000, v12
  v_lshlrev_b32 v12, 16, v12
  v_lshlrev_b32 v5, 16, v110
  v_and_b32 v6, 0xffff0000, v110
  v_mul_f32 v12, v12, v5
  v_mul_f32 v8, v8, v6
  v_cvt_pk_bf16_f32 v12, v12, v8
  v_and_b32 v8, 0xffff0000, v12
  v_lshlrev_b32 v12, 16, v12
  v_add_f32 v48, v12, v14
  v_add_f32 v49, v8, v15

  v_lshlrev_b32 v14, 16, v101
  v_and_b32 v15, 0xffff0000, v101
  v_sub_f32 v12, v14, v10
  v_sub_f32 v8, v15, v10
  v_cvt_pk_bf16_f32 v12, v12, v8
  v_and_b32 v8, 0xffff0000, v12
  v_lshlrev_b32 v12, 16, v12
  v_mul_f32 v12, v12, v11
  v_mul_f32 v8, v8, v11
  v_cvt_pk_bf16_f32 v12, v12, v8
  v_and_b32 v8, 0xffff0000, v12
  v_lshlrev_b32 v12, 16, v12
  v_lshlrev_b32 v5, 16, v111
  v_and_b32 v6, 0xffff0000, v111
  v_mul_f32 v12, v12, v5
  v_mul_f32 v8, v8, v6
  v_cvt_pk_bf16_f32 v12, v12, v8
  v_and_b32 v8, 0xffff0000, v12
  v_lshlrev_b32 v12, 16, v12
  v_add_f32 v50, v12, v14
  v_add_f32 v51, v8, v15

  v_lshlrev_b32 v14, 16, v102
  v_and_b32 v15, 0xffff0000, v102
  v_sub_f32 v12, v14, v10
  v_sub_f32 v8, v15, v10
  v_cvt_pk_bf16_f32 v12, v12, v8
  v_and_b32 v8, 0xffff0000, v12
  v_lshlrev_b32 v12, 16, v12
  v_mul_f32 v12, v12, v11
  v_mul_f32 v8, v8, v11
  v_cvt_pk_bf16_f32 v12, v12, v8
  v_and_b32 v8, 0xffff0000, v12
  v_lshlrev_b32 v12, 16, v12
  v_lshlrev_b32 v5, 16, v112
  v_and_b32 v6, 0xffff0000, v112
  v_mul_f32 v12, v12, v5
  v_mul_f32 v8, v8, v6
  v_cvt_pk_bf16_f32 v12, v12, v8
  v_and_b32 v8, 0xffff0000, v12
  v_lshlrev_b32 v12, 16, v12
  v_add_f32 v64, v12, v14
  v_add_f32 v65, v8, v15

  v_lshlrev_b32 v14, 16, v103
  v_and_b32 v15, 0xffff0000, v103
  v_sub_f32 v12, v14, v10
  v_sub_f32 v8, v15, v10
  v_cvt_pk_bf16_f32 v12, v12, v8
  v_and_b32 v8, 0xffff0000, v12
  v_lshlrev_b32 v12, 16, v12
  v_mul_f32 v12, v12, v11
  v_mul_f32 v8, v8, v11
  v_cvt_pk_bf16_f32 v12, v12, v8
  v_and_b32 v8, 0xffff0000, v12
  v_lshlrev_b32 v12, 16, v12
  v_lshlrev_b32 v5, 16, v113
  v_and_b32 v6, 0xffff0000, v113
  v_mul_f32 v12, v12, v5
  v_mul_f32 v8, v8, v6
  v_cvt_pk_bf16_f32 v12, v12, v8
  v_and_b32 v8, 0xffff0000, v12
  v_lshlrev_b32 v12, 16, v12
  v_add_f32 v66, v12, v14
  v_add_f32 v67, v8, v15

  v_lshlrev_b32 v14, 16, v104
  v_and_b32 v15, 0xffff0000, v104
  v_sub_f32 v12, v14, v10
  v_sub_f32 v8, v15, v10
  v_cvt_pk_bf16_f32 v12, v12, v8
  v_and_b32 v8, 0xffff0000, v12
  v_lshlrev_b32 v12, 16, v12
  v_mul_f32 v12, v12, v11
  v_mul_f32 v8, v8, v11
  v_cvt_pk_bf16_f32 v12, v12, v8
  v_and_b32 v8, 0xffff0000, v12
  v_lshlrev_b32 v12, 16, v12
  v_lshlrev_b32 v5, 16, v114
  v_and_b32 v6, 0xffff0000, v114
  v_mul_f32 v12, v12, v5
  v_mul_f32 v8, v8, v6
  v_cvt_pk_bf16_f32 v12, v12, v8
  v_and_b32 v8, 0xffff0000, v12
  v_lshlrev_b32 v12, 16, v12
  v_add_f32 v80, v12, v14
  v_add_f32 v81, v8, v15

  v_lshlrev_b32 v14, 16, v105
  v_and_b32 v15, 0xffff0000, v105
  v_sub_f32 v12, v14, v10
  v_sub_f32 v8, v15, v10
  v_cvt_pk_bf16_f32 v12, v12, v8
  v_and_b32 v8, 0xffff0000, v12
  v_lshlrev_b32 v12, 16, v12
  v_mul_f32 v12, v12, v11
  v_mul_f32 v8, v8, v11
  v_cvt_pk_bf16_f32 v12, v12, v8
  v_and_b32 v8, 0xffff0000, v12
  v_lshlrev_b32 v12, 16, v12
  v_lshlrev_b32 v5, 16, v115
  v_and_b32 v6, 0xffff0000, v115
  v_mul_f32 v12, v12, v5
  v_mul_f32 v8, v8, v6
  v_cvt_pk_bf16_f32 v12, v12, v8
  v_and_b32 v8, 0xffff0000, v12
  v_lshlrev_b32 v12, 16, v12
  v_add_f32 v82, v12, v14
  v_add_f32 v83, v8, v15

K1_P2W2:
  v_add_u32 v10, 4, v9
  v_add_u32 v11, 8, v9
  v_and_b32 v5, 31, v1
  v_lshlrev_b32 v5, 2, v5
  s_lshl_b32 s65, s48, 8

  s_xor_b32 s66, s3, 1
  s_xor_b32 s67, s66, 2
  s_cmp_ge_u32 s66, 4
  s_cselect_b32 s66, s67, s66
  s_mul_i32 s66, s66, 20480
  s_add_u32 s66, s66, 0
  v_add_u32 v184, s66, v2

  s_xor_b32 s66, s3, 2
  s_xor_b32 s67, s66, 2
  s_cmp_ge_u32 s66, 4
  s_cselect_b32 s66, s67, s66
  s_mul_i32 s66, s66, 20480
  s_add_u32 s66, s66, 5120
  v_add_u32 v185, s66, v2

  s_xor_b32 s66, s3, 3
  s_xor_b32 s67, s66, 2
  s_cmp_ge_u32 s66, 4
  s_cselect_b32 s66, s67, s66
  s_mul_i32 s66, s66, 20480
  s_add_u32 s66, s66, 10240
  v_add_u32 v186, s66, v2

  s_xor_b32 s66, s3, 4
  s_xor_b32 s67, s66, 2
  s_cmp_ge_u32 s66, 4
  s_cselect_b32 s66, s67, s66
  s_mul_i32 s66, s66, 20480
  s_add_u32 s66, s66, 15360
  v_add_u32 v187, s66, v2

  s_xor_b32 s66, s3, 5
  s_xor_b32 s67, s66, 2
  s_cmp_ge_u32 s66, 4
  s_cselect_b32 s66, s67, s66
  s_mul_i32 s66, s66, 20480
  s_add_u32 s66, s66, 0
  v_add_u32 v188, s66, v2

  s_xor_b32 s66, s3, 6
  s_xor_b32 s67, s66, 2
  s_cmp_ge_u32 s66, 4
  s_cselect_b32 s66, s67, s66
  s_mul_i32 s66, s66, 20480
  s_add_u32 s66, s66, 5120
  v_add_u32 v189, s66, v2

  s_xor_b32 s66, s3, 7
  s_xor_b32 s67, s66, 2
  s_cmp_ge_u32 s66, 4
  s_cselect_b32 s66, s67, s66
  s_mul_i32 s66, s66, 20480
  s_add_u32 s66, s66, 10240
  v_add_u32 v190, s66, v2

  s_mov_b32 s67, 0
K1_HD:
  ds_read_b32 v6, v9 offset:12
  s_add_u32 s67, s67, 1
  s_waitcnt lgkmcnt(0)
  v_readfirstlane_b32 s66, v6
  s_cmp_ge_u32 s66, 68
  s_cbranch_scc1 K1_HD_OK
  s_cmp_ge_u32 s67, 1000000
  s_cbranch_scc1 K1_HD_OK
  s_sleep 1
  s_branch K1_HD

K1_HD_OK:
  s_mov_b32 s67, 0
  s_cmp_eq_u32 s3, 4
  s_cbranch_scc0 K1_P2SPINH
K1_P2POLLH:
  buffer_load_dword v6, v5, s[20:23], s65 offen sc1
  s_waitcnt vmcnt(0)
  v_cmp_eq_u32 vcc, s95, v6
  s_add_u32 s67, s67, 1
  s_or_b32 s66, vcc_lo, 0x3ff
  s_cmp_eq_u32 s66, -1
  s_cbranch_scc1 K1_P2SETH
  s_cmp_ge_u32 s67, 100000
  s_cbranch_scc1 K1_P2SETH
  s_sleep 4
  s_branch K1_P2POLLH

K1_P2SETH:
  v_mov_b32 v6, 1
  ds_write_b32 v10, v6
  s_branch K1_P2GOH
K1_P2SPINH:
  ds_read_b32 v6, v10
  s_add_u32 s67, s67, 1
  s_waitcnt lgkmcnt(0)
  v_readfirstlane_b32 s66, v6
  s_cmp_lg_u32 s66, 0
  s_cbranch_scc1 K1_P2GOH
  s_cmp_ge_u32 s67, 1000000
  s_cbranch_scc1 K1_P2GOH
  s_sleep 1
  s_branch K1_P2SPINH

K1_P2GOH:
  buffer_load_dwordx4 v[96:99], v3, s[8:11], s32 offen sc1
  buffer_load_dwordx4 v[100:103], v3, s[8:11], s33 offen sc1
  buffer_load_dwordx4 v[104:107], v3, s[8:11], s34 offen sc1
  buffer_load_dwordx4 v[108:111], v3, s[8:11], s35 offen sc1
  v_add_u32 v3, s38, v3
  buffer_load_dwordx4 v[112:115], v3, s[8:11], s32 offen sc1
  buffer_load_dwordx4 v[116:119], v3, s[8:11], s33 offen sc1
  buffer_load_dwordx4 v[120:123], v3, s[8:11], s34 offen sc1
  buffer_load_dwordx4 v[124:127], v3, s[8:11], s35 offen sc1
  v_add_u32 v3, s40, v3
  s_cmp_ge_u32 s3, 4
  s_cbranch_scc1 K1_P2GOS
  s_mov_b32 s67, 0
  s_cmp_eq_u32 s3, 0
  s_cbranch_scc0 K1_P2SPINS
K1_P2POLLS:
  buffer_load_dword v6, v5, s[20:23], s65 offen sc1
  s_waitcnt vmcnt(0)
  v_cmp_eq_u32 vcc, s95, v6
  s_add_u32 s67, s67, 1
  s_and_b32 s66, vcc_lo, 0x3ff
  s_cmp_eq_u32 s66, 0x3ff
  s_cbranch_scc1 K1_P2SETS
  s_cmp_ge_u32 s67, 100000
  s_cbranch_scc1 K1_P2SETS
  s_sleep 4
  s_branch K1_P2POLLS

K1_P2SETS:
  v_mov_b32 v6, 1
  ds_write_b32 v11, v6
  s_branch K1_P2GOS
K1_P2SPINS:
  ds_read_b32 v6, v11
  s_add_u32 s67, s67, 1
  s_waitcnt lgkmcnt(0)
  v_readfirstlane_b32 s66, v6
  s_cmp_lg_u32 s66, 0
  s_cbranch_scc1 K1_P2GOS
  s_cmp_ge_u32 s67, 1000000
  s_cbranch_scc1 K1_P2GOS
  s_sleep 1
  s_branch K1_P2SPINS

K1_P2GOS:
  buffer_load_dwordx4 v[128:131], v3, s[8:11], s32 offen sc1
  buffer_load_dwordx4 v[132:135], v3, s[8:11], s33 offen sc1
  buffer_load_dwordx4 v[136:139], v3, s[8:11], s34 offen sc1
  buffer_load_dwordx4 v[140:143], v3, s[8:11], s35 offen sc1
  v_add_u32 v3, 4096, v3
  s_waitcnt vmcnt(8)
  v_mfma_f32_16x16x32_bf16 v[16:19], v[144:147], v[96:99], v[16:19]
  v_mfma_f32_16x16x32_bf16 v[20:23], v[144:147], v[100:103], v[20:23]
  v_mfma_f32_16x16x32_bf16 v[24:27], v[144:147], v[104:107], v[24:27]
  v_mfma_f32_16x16x32_bf16 v[28:31], v[144:147], v[108:111], v[28:31]
  v_mfma_f32_16x16x32_bf16 v[32:35], v[148:151], v[96:99], v[32:35]
  v_mfma_f32_16x16x32_bf16 v[36:39], v[148:151], v[100:103], v[36:39]
  v_mfma_f32_16x16x32_bf16 v[40:43], v[148:151], v[104:107], v[40:43]
  v_mfma_f32_16x16x32_bf16 v[44:47], v[148:151], v[108:111], v[44:47]
  ds_read_b128 v[144:147], v13 offset:0
  v_mfma_f32_16x16x32_bf16 v[48:51], v[152:155], v[96:99], v[48:51]
  v_mfma_f32_16x16x32_bf16 v[52:55], v[152:155], v[100:103], v[52:55]
  v_mfma_f32_16x16x32_bf16 v[56:59], v[152:155], v[104:107], v[56:59]
  v_mfma_f32_16x16x32_bf16 v[60:63], v[152:155], v[108:111], v[60:63]
  ds_read_b128 v[148:151], v13 offset:1024
  v_mfma_f32_16x16x32_bf16 v[64:67], v[156:159], v[96:99], v[64:67]
  v_mfma_f32_16x16x32_bf16 v[68:71], v[156:159], v[100:103], v[68:71]
  v_mfma_f32_16x16x32_bf16 v[72:75], v[156:159], v[104:107], v[72:75]
  v_mfma_f32_16x16x32_bf16 v[76:79], v[156:159], v[108:111], v[76:79]
  ds_read_b128 v[152:155], v13 offset:2048
  v_mfma_f32_16x16x32_bf16 v[80:83], v[160:163], v[96:99], v[80:83]
  v_mfma_f32_16x16x32_bf16 v[84:87], v[160:163], v[100:103], v[84:87]
  v_mfma_f32_16x16x32_bf16 v[88:91], v[160:163], v[104:107], v[88:91]
  v_mfma_f32_16x16x32_bf16 v[92:95], v[160:163], v[108:111], v[92:95]
  ds_read_b128 v[156:159], v13 offset:3072
  buffer_load_dwordx4 v[96:99], v3, s[8:11], s32 offen sc1
  buffer_load_dwordx4 v[100:103], v3, s[8:11], s33 offen sc1
  buffer_load_dwordx4 v[104:107], v3, s[8:11], s34 offen sc1
  buffer_load_dwordx4 v[108:111], v3, s[8:11], s35 offen sc1
  v_add_u32 v3, 4096, v3
  ds_read_b128 v[160:163], v13 offset:4096
  s_waitcnt vmcnt(8)
  v_mfma_f32_16x16x32_bf16 v[16:19], v[164:167], v[112:115], v[16:19]
  v_mfma_f32_16x16x32_bf16 v[20:23], v[164:167], v[116:119], v[20:23]
  v_mfma_f32_16x16x32_bf16 v[24:27], v[164:167], v[120:123], v[24:27]
  v_mfma_f32_16x16x32_bf16 v[28:31], v[164:167], v[124:127], v[28:31]
  v_mfma_f32_16x16x32_bf16 v[32:35], v[168:171], v[112:115], v[32:35]
  v_mfma_f32_16x16x32_bf16 v[36:39], v[168:171], v[116:119], v[36:39]
  v_mfma_f32_16x16x32_bf16 v[40:43], v[168:171], v[120:123], v[40:43]
  v_mfma_f32_16x16x32_bf16 v[44:47], v[168:171], v[124:127], v[44:47]
  ds_read_b128 v[164:167], v13 offset:5120
  v_mfma_f32_16x16x32_bf16 v[48:51], v[172:175], v[112:115], v[48:51]
  v_mfma_f32_16x16x32_bf16 v[52:55], v[172:175], v[116:119], v[52:55]
  v_mfma_f32_16x16x32_bf16 v[56:59], v[172:175], v[120:123], v[56:59]
  v_mfma_f32_16x16x32_bf16 v[60:63], v[172:175], v[124:127], v[60:63]
  ds_read_b128 v[168:171], v13 offset:6144
  v_mfma_f32_16x16x32_bf16 v[64:67], v[176:179], v[112:115], v[64:67]
  v_mfma_f32_16x16x32_bf16 v[68:71], v[176:179], v[116:119], v[68:71]
  v_mfma_f32_16x16x32_bf16 v[72:75], v[176:179], v[120:123], v[72:75]
  v_mfma_f32_16x16x32_bf16 v[76:79], v[176:179], v[124:127], v[76:79]
  ds_read_b128 v[172:175], v13 offset:7168
  v_mfma_f32_16x16x32_bf16 v[80:83], v[180:183], v[112:115], v[80:83]
  v_mfma_f32_16x16x32_bf16 v[84:87], v[180:183], v[116:119], v[84:87]
  v_mfma_f32_16x16x32_bf16 v[88:91], v[180:183], v[120:123], v[88:91]
  v_mfma_f32_16x16x32_bf16 v[92:95], v[180:183], v[124:127], v[92:95]
  ds_read_b128 v[176:179], v13 offset:8192
  buffer_load_dwordx4 v[112:115], v3, s[8:11], s32 offen sc1
  buffer_load_dwordx4 v[116:119], v3, s[8:11], s33 offen sc1
  buffer_load_dwordx4 v[120:123], v3, s[8:11], s34 offen sc1
  buffer_load_dwordx4 v[124:127], v3, s[8:11], s35 offen sc1
  v_add_u32 v3, 4096, v3
  ds_read_b128 v[180:183], v13 offset:9216
  s_waitcnt vmcnt(8)
  v_mfma_f32_16x16x32_bf16 v[16:19], a[0:3], v[128:131], v[16:19]
  v_mfma_f32_16x16x32_bf16 v[20:23], a[0:3], v[132:135], v[20:23]
  v_mfma_f32_16x16x32_bf16 v[24:27], a[0:3], v[136:139], v[24:27]
  v_mfma_f32_16x16x32_bf16 v[28:31], a[0:3], v[140:143], v[28:31]
  v_mfma_f32_16x16x32_bf16 v[32:35], a[4:7], v[128:131], v[32:35]
  v_mfma_f32_16x16x32_bf16 v[36:39], a[4:7], v[132:135], v[36:39]
  v_mfma_f32_16x16x32_bf16 v[40:43], a[4:7], v[136:139], v[40:43]
  v_mfma_f32_16x16x32_bf16 v[44:47], a[4:7], v[140:143], v[44:47]
  ds_read_b128 a[0:3], v13 offset:10240
  v_mfma_f32_16x16x32_bf16 v[48:51], a[8:11], v[128:131], v[48:51]
  v_mfma_f32_16x16x32_bf16 v[52:55], a[8:11], v[132:135], v[52:55]
  v_mfma_f32_16x16x32_bf16 v[56:59], a[8:11], v[136:139], v[56:59]
  v_mfma_f32_16x16x32_bf16 v[60:63], a[8:11], v[140:143], v[60:63]
  ds_read_b128 a[4:7], v13 offset:11264
  v_mfma_f32_16x16x32_bf16 v[64:67], a[12:15], v[128:131], v[64:67]
  v_mfma_f32_16x16x32_bf16 v[68:71], a[12:15], v[132:135], v[68:71]
  v_mfma_f32_16x16x32_bf16 v[72:75], a[12:15], v[136:139], v[72:75]
  v_mfma_f32_16x16x32_bf16 v[76:79], a[12:15], v[140:143], v[76:79]
  ds_read_b128 a[8:11], v13 offset:12288
  v_mfma_f32_16x16x32_bf16 v[80:83], a[16:19], v[128:131], v[80:83]
  v_mfma_f32_16x16x32_bf16 v[84:87], a[16:19], v[132:135], v[84:87]
  v_mfma_f32_16x16x32_bf16 v[88:91], a[16:19], v[136:139], v[88:91]
  v_mfma_f32_16x16x32_bf16 v[92:95], a[16:19], v[140:143], v[92:95]
  ds_read_b128 a[12:15], v13 offset:13312
  buffer_load_dwordx4 v[128:131], v3, s[8:11], s32 offen sc1
  buffer_load_dwordx4 v[132:135], v3, s[8:11], s33 offen sc1
  buffer_load_dwordx4 v[136:139], v3, s[8:11], s34 offen sc1
  buffer_load_dwordx4 v[140:143], v3, s[8:11], s35 offen sc1
  v_add_u32 v3, 4096, v3
  ds_read_b128 a[16:19], v13 offset:14336
  s_waitcnt vmcnt(8)
  v_mfma_f32_16x16x32_bf16 v[16:19], a[20:23], v[96:99], v[16:19]
  v_mfma_f32_16x16x32_bf16 v[20:23], a[20:23], v[100:103], v[20:23]
  v_mfma_f32_16x16x32_bf16 v[24:27], a[20:23], v[104:107], v[24:27]
  v_mfma_f32_16x16x32_bf16 v[28:31], a[20:23], v[108:111], v[28:31]
  v_mfma_f32_16x16x32_bf16 v[32:35], a[24:27], v[96:99], v[32:35]
  v_mfma_f32_16x16x32_bf16 v[36:39], a[24:27], v[100:103], v[36:39]
  v_mfma_f32_16x16x32_bf16 v[40:43], a[24:27], v[104:107], v[40:43]
  v_mfma_f32_16x16x32_bf16 v[44:47], a[24:27], v[108:111], v[44:47]
  buffer_load_dwordx4 a[20:23], v4, s[12:15], s52 offen sc1
  v_mfma_f32_16x16x32_bf16 v[48:51], a[28:31], v[96:99], v[48:51]
  v_mfma_f32_16x16x32_bf16 v[52:55], a[28:31], v[100:103], v[52:55]
  v_mfma_f32_16x16x32_bf16 v[56:59], a[28:31], v[104:107], v[56:59]
  v_mfma_f32_16x16x32_bf16 v[60:63], a[28:31], v[108:111], v[60:63]
  buffer_load_dwordx4 a[24:27], v4, s[12:15], s53 offen sc1
  v_mfma_f32_16x16x32_bf16 v[64:67], a[32:35], v[96:99], v[64:67]
  v_mfma_f32_16x16x32_bf16 v[68:71], a[32:35], v[100:103], v[68:71]
  v_mfma_f32_16x16x32_bf16 v[72:75], a[32:35], v[104:107], v[72:75]
  v_mfma_f32_16x16x32_bf16 v[76:79], a[32:35], v[108:111], v[76:79]
  buffer_load_dwordx4 a[28:31], v4, s[12:15], s54 offen sc1
  v_mfma_f32_16x16x32_bf16 v[80:83], a[36:39], v[96:99], v[80:83]
  v_mfma_f32_16x16x32_bf16 v[84:87], a[36:39], v[100:103], v[84:87]
  v_mfma_f32_16x16x32_bf16 v[88:91], a[36:39], v[104:107], v[88:91]
  v_mfma_f32_16x16x32_bf16 v[92:95], a[36:39], v[108:111], v[92:95]
  buffer_load_dwordx4 a[32:35], v4, s[12:15], s55 offen sc1
  buffer_load_dwordx4 v[96:99], v3, s[8:11], s32 offen sc1
  buffer_load_dwordx4 v[100:103], v3, s[8:11], s33 offen sc1
  buffer_load_dwordx4 v[104:107], v3, s[8:11], s34 offen sc1
  buffer_load_dwordx4 v[108:111], v3, s[8:11], s35 offen sc1
  v_add_u32 v3, 4096, v3
  buffer_load_dwordx4 a[36:39], v4, s[12:15], s56 offen sc1
  v_add_u32 v4, s41, v4
  s_waitcnt vmcnt(13)
  v_mfma_f32_16x16x32_bf16 v[16:19], a[40:43], v[112:115], v[16:19]
  v_mfma_f32_16x16x32_bf16 v[20:23], a[40:43], v[116:119], v[20:23]
  v_mfma_f32_16x16x32_bf16 v[24:27], a[40:43], v[120:123], v[24:27]
  v_mfma_f32_16x16x32_bf16 v[28:31], a[40:43], v[124:127], v[28:31]
  v_mfma_f32_16x16x32_bf16 v[32:35], a[44:47], v[112:115], v[32:35]
  v_mfma_f32_16x16x32_bf16 v[36:39], a[44:47], v[116:119], v[36:39]
  v_mfma_f32_16x16x32_bf16 v[40:43], a[44:47], v[120:123], v[40:43]
  v_mfma_f32_16x16x32_bf16 v[44:47], a[44:47], v[124:127], v[44:47]
  buffer_load_dwordx4 a[40:43], v4, s[12:15], s52 offen sc1
  v_mfma_f32_16x16x32_bf16 v[48:51], a[48:51], v[112:115], v[48:51]
  v_mfma_f32_16x16x32_bf16 v[52:55], a[48:51], v[116:119], v[52:55]
  v_mfma_f32_16x16x32_bf16 v[56:59], a[48:51], v[120:123], v[56:59]
  v_mfma_f32_16x16x32_bf16 v[60:63], a[48:51], v[124:127], v[60:63]
  buffer_load_dwordx4 a[44:47], v4, s[12:15], s53 offen sc1
  v_mfma_f32_16x16x32_bf16 v[64:67], a[52:55], v[112:115], v[64:67]
  v_mfma_f32_16x16x32_bf16 v[68:71], a[52:55], v[116:119], v[68:71]
  v_mfma_f32_16x16x32_bf16 v[72:75], a[52:55], v[120:123], v[72:75]
  v_mfma_f32_16x16x32_bf16 v[76:79], a[52:55], v[124:127], v[76:79]
  buffer_load_dwordx4 a[48:51], v4, s[12:15], s54 offen sc1
  v_mfma_f32_16x16x32_bf16 v[80:83], a[56:59], v[112:115], v[80:83]
  v_mfma_f32_16x16x32_bf16 v[84:87], a[56:59], v[116:119], v[84:87]
  v_mfma_f32_16x16x32_bf16 v[88:91], a[56:59], v[120:123], v[88:91]
  v_mfma_f32_16x16x32_bf16 v[92:95], a[56:59], v[124:127], v[92:95]
  buffer_load_dwordx4 a[52:55], v4, s[12:15], s55 offen sc1
  buffer_load_dwordx4 v[112:115], v3, s[8:11], s32 offen sc1
  buffer_load_dwordx4 v[116:119], v3, s[8:11], s33 offen sc1
  buffer_load_dwordx4 v[120:123], v3, s[8:11], s34 offen sc1
  buffer_load_dwordx4 v[124:127], v3, s[8:11], s35 offen sc1
  v_add_u32 v3, 4096, v3
  buffer_load_dwordx4 a[56:59], v4, s[12:15], s56 offen sc1
  v_add_u32 v4, 4096, v4
  s_waitcnt vmcnt(18) lgkmcnt(0)
  v_mfma_f32_16x16x32_bf16 v[16:19], v[144:147], v[128:131], v[16:19]
  v_mfma_f32_16x16x32_bf16 v[20:23], v[144:147], v[132:135], v[20:23]
  v_mfma_f32_16x16x32_bf16 v[24:27], v[144:147], v[136:139], v[24:27]
  v_mfma_f32_16x16x32_bf16 v[28:31], v[144:147], v[140:143], v[28:31]
  v_mfma_f32_16x16x32_bf16 v[32:35], v[148:151], v[128:131], v[32:35]
  v_mfma_f32_16x16x32_bf16 v[36:39], v[148:151], v[132:135], v[36:39]
  v_mfma_f32_16x16x32_bf16 v[40:43], v[148:151], v[136:139], v[40:43]
  v_mfma_f32_16x16x32_bf16 v[44:47], v[148:151], v[140:143], v[44:47]
  buffer_load_dwordx4 v[144:147], v4, s[12:15], s52 offen sc1
  v_mfma_f32_16x16x32_bf16 v[48:51], v[152:155], v[128:131], v[48:51]
  v_mfma_f32_16x16x32_bf16 v[52:55], v[152:155], v[132:135], v[52:55]
  v_mfma_f32_16x16x32_bf16 v[56:59], v[152:155], v[136:139], v[56:59]
  v_mfma_f32_16x16x32_bf16 v[60:63], v[152:155], v[140:143], v[60:63]
  buffer_load_dwordx4 v[148:151], v4, s[12:15], s53 offen sc1
  v_mfma_f32_16x16x32_bf16 v[64:67], v[156:159], v[128:131], v[64:67]
  v_mfma_f32_16x16x32_bf16 v[68:71], v[156:159], v[132:135], v[68:71]
  v_mfma_f32_16x16x32_bf16 v[72:75], v[156:159], v[136:139], v[72:75]
  v_mfma_f32_16x16x32_bf16 v[76:79], v[156:159], v[140:143], v[76:79]
  buffer_load_dwordx4 v[152:155], v4, s[12:15], s54 offen sc1
  v_mfma_f32_16x16x32_bf16 v[80:83], v[160:163], v[128:131], v[80:83]
  v_mfma_f32_16x16x32_bf16 v[84:87], v[160:163], v[132:135], v[84:87]
  v_mfma_f32_16x16x32_bf16 v[88:91], v[160:163], v[136:139], v[88:91]
  v_mfma_f32_16x16x32_bf16 v[92:95], v[160:163], v[140:143], v[92:95]
  buffer_load_dwordx4 v[156:159], v4, s[12:15], s55 offen sc1
  buffer_load_dwordx4 v[128:131], v3, s[8:11], s32 offen sc1
  buffer_load_dwordx4 v[132:135], v3, s[8:11], s33 offen sc1
  buffer_load_dwordx4 v[136:139], v3, s[8:11], s34 offen sc1
  buffer_load_dwordx4 v[140:143], v3, s[8:11], s35 offen sc1
  v_add_u32 v3, s41, v3
  buffer_load_dwordx4 v[160:163], v4, s[12:15], s56 offen sc1
  v_add_u32 v4, s39, v4
  s_waitcnt vmcnt(19) lgkmcnt(0)
  v_mfma_f32_16x16x32_bf16 v[16:19], v[164:167], v[96:99], v[16:19]
  v_mfma_f32_16x16x32_bf16 v[20:23], v[164:167], v[100:103], v[20:23]
  v_mfma_f32_16x16x32_bf16 v[24:27], v[164:167], v[104:107], v[24:27]
  v_mfma_f32_16x16x32_bf16 v[28:31], v[164:167], v[108:111], v[28:31]
  v_mfma_f32_16x16x32_bf16 v[32:35], v[168:171], v[96:99], v[32:35]
  v_mfma_f32_16x16x32_bf16 v[36:39], v[168:171], v[100:103], v[36:39]
  v_mfma_f32_16x16x32_bf16 v[40:43], v[168:171], v[104:107], v[40:43]
  v_mfma_f32_16x16x32_bf16 v[44:47], v[168:171], v[108:111], v[44:47]
  buffer_load_dwordx4 v[164:167], v4, s[12:15], s52 offen sc1
  v_mfma_f32_16x16x32_bf16 v[48:51], v[172:175], v[96:99], v[48:51]
  v_mfma_f32_16x16x32_bf16 v[52:55], v[172:175], v[100:103], v[52:55]
  v_mfma_f32_16x16x32_bf16 v[56:59], v[172:175], v[104:107], v[56:59]
  v_mfma_f32_16x16x32_bf16 v[60:63], v[172:175], v[108:111], v[60:63]
  buffer_load_dwordx4 v[168:171], v4, s[12:15], s53 offen sc1
  v_mfma_f32_16x16x32_bf16 v[64:67], v[176:179], v[96:99], v[64:67]
  v_mfma_f32_16x16x32_bf16 v[68:71], v[176:179], v[100:103], v[68:71]
  v_mfma_f32_16x16x32_bf16 v[72:75], v[176:179], v[104:107], v[72:75]
  v_mfma_f32_16x16x32_bf16 v[76:79], v[176:179], v[108:111], v[76:79]
  buffer_load_dwordx4 v[172:175], v4, s[12:15], s54 offen sc1
  v_mfma_f32_16x16x32_bf16 v[80:83], v[180:183], v[96:99], v[80:83]
  v_mfma_f32_16x16x32_bf16 v[84:87], v[180:183], v[100:103], v[84:87]
  v_mfma_f32_16x16x32_bf16 v[88:91], v[180:183], v[104:107], v[88:91]
  v_mfma_f32_16x16x32_bf16 v[92:95], v[180:183], v[108:111], v[92:95]
  buffer_load_dwordx4 v[176:179], v4, s[12:15], s55 offen sc1
  buffer_load_dwordx4 v[96:99], v3, s[8:11], s32 offen sc1
  buffer_load_dwordx4 v[100:103], v3, s[8:11], s33 offen sc1
  buffer_load_dwordx4 v[104:107], v3, s[8:11], s34 offen sc1
  buffer_load_dwordx4 v[108:111], v3, s[8:11], s35 offen sc1
  v_add_u32 v3, 4096, v3
  buffer_load_dwordx4 v[180:183], v4, s[12:15], s56 offen sc1
  v_add_u32 v4, 4096, v4
  s_waitcnt vmcnt(19) lgkmcnt(0)
  v_mfma_f32_16x16x32_bf16 v[16:19], a[0:3], v[112:115], v[16:19]
  v_mfma_f32_16x16x32_bf16 v[20:23], a[0:3], v[116:119], v[20:23]
  v_mfma_f32_16x16x32_bf16 v[24:27], a[0:3], v[120:123], v[24:27]
  v_mfma_f32_16x16x32_bf16 v[28:31], a[0:3], v[124:127], v[28:31]
  v_mfma_f32_16x16x32_bf16 v[32:35], a[4:7], v[112:115], v[32:35]
  v_mfma_f32_16x16x32_bf16 v[36:39], a[4:7], v[116:119], v[36:39]
  v_mfma_f32_16x16x32_bf16 v[40:43], a[4:7], v[120:123], v[40:43]
  v_mfma_f32_16x16x32_bf16 v[44:47], a[4:7], v[124:127], v[44:47]
  v_mfma_f32_16x16x32_bf16 v[48:51], a[8:11], v[112:115], v[48:51]
  v_mfma_f32_16x16x32_bf16 v[52:55], a[8:11], v[116:119], v[52:55]
  v_mfma_f32_16x16x32_bf16 v[56:59], a[8:11], v[120:123], v[56:59]
  v_mfma_f32_16x16x32_bf16 v[60:63], a[8:11], v[124:127], v[60:63]
  v_mfma_f32_16x16x32_bf16 v[64:67], a[12:15], v[112:115], v[64:67]
  v_mfma_f32_16x16x32_bf16 v[68:71], a[12:15], v[116:119], v[68:71]
  v_mfma_f32_16x16x32_bf16 v[72:75], a[12:15], v[120:123], v[72:75]
  v_mfma_f32_16x16x32_bf16 v[76:79], a[12:15], v[124:127], v[76:79]
  v_mfma_f32_16x16x32_bf16 v[80:83], a[16:19], v[112:115], v[80:83]
  v_mfma_f32_16x16x32_bf16 v[84:87], a[16:19], v[116:119], v[84:87]
  v_mfma_f32_16x16x32_bf16 v[88:91], a[16:19], v[120:123], v[88:91]
  v_mfma_f32_16x16x32_bf16 v[92:95], a[16:19], v[124:127], v[92:95]
  buffer_load_dwordx4 v[112:115], v3, s[8:11], s32 offen sc1
  buffer_load_dwordx4 v[116:119], v3, s[8:11], s33 offen sc1
  buffer_load_dwordx4 v[120:123], v3, s[8:11], s34 offen sc1
  buffer_load_dwordx4 v[124:127], v3, s[8:11], s35 offen sc1
  v_add_u32 v3, s39, v3
  s_waitcnt vmcnt(14)
  v_mfma_f32_16x16x32_bf16 v[16:19], a[20:23], v[128:131], v[16:19]
  v_mfma_f32_16x16x32_bf16 v[20:23], a[20:23], v[132:135], v[20:23]
  v_mfma_f32_16x16x32_bf16 v[24:27], a[20:23], v[136:139], v[24:27]
  v_mfma_f32_16x16x32_bf16 v[28:31], a[20:23], v[140:143], v[28:31]
  v_mfma_f32_16x16x32_bf16 v[32:35], a[24:27], v[128:131], v[32:35]
  v_mfma_f32_16x16x32_bf16 v[36:39], a[24:27], v[132:135], v[36:39]
  v_mfma_f32_16x16x32_bf16 v[40:43], a[24:27], v[136:139], v[40:43]
  v_mfma_f32_16x16x32_bf16 v[44:47], a[24:27], v[140:143], v[44:47]
  v_mfma_f32_16x16x32_bf16 v[48:51], a[28:31], v[128:131], v[48:51]
  v_mfma_f32_16x16x32_bf16 v[52:55], a[28:31], v[132:135], v[52:55]
  v_mfma_f32_16x16x32_bf16 v[56:59], a[28:31], v[136:139], v[56:59]
  v_mfma_f32_16x16x32_bf16 v[60:63], a[28:31], v[140:143], v[60:63]
  v_mfma_f32_16x16x32_bf16 v[64:67], a[32:35], v[128:131], v[64:67]
  v_mfma_f32_16x16x32_bf16 v[68:71], a[32:35], v[132:135], v[68:71]
  v_mfma_f32_16x16x32_bf16 v[72:75], a[32:35], v[136:139], v[72:75]
  v_mfma_f32_16x16x32_bf16 v[76:79], a[32:35], v[140:143], v[76:79]
  v_mfma_f32_16x16x32_bf16 v[80:83], a[36:39], v[128:131], v[80:83]
  v_mfma_f32_16x16x32_bf16 v[84:87], a[36:39], v[132:135], v[84:87]
  v_mfma_f32_16x16x32_bf16 v[88:91], a[36:39], v[136:139], v[88:91]
  v_mfma_f32_16x16x32_bf16 v[92:95], a[36:39], v[140:143], v[92:95]
  buffer_load_dwordx4 v[128:131], v3, s[8:11], s32 offen sc1
  buffer_load_dwordx4 v[132:135], v3, s[8:11], s33 offen sc1
  buffer_load_dwordx4 v[136:139], v3, s[8:11], s34 offen sc1
  buffer_load_dwordx4 v[140:143], v3, s[8:11], s35 offen sc1
  v_add_u32 v3, 4096, v3
  s_waitcnt vmcnt(9)
  s_cmp_lt_u32 s3, 4
  s_cbranch_scc1 K1_P2X_30
  s_bitcmp1_b32 s3, 0
  s_cbranch_scc1 K1_P2O_29
  v_swap_b32 v98, v100
  v_swap_b32 v99, v101
  v_swap_b32 v106, v108
  v_swap_b32 v107, v109
  s_branch K1_P2X_30
K1_P2O_29:
  v_swap_b32 v96, v102
  v_swap_b32 v97, v103
  v_swap_b32 v104, v110
  v_swap_b32 v105, v111
K1_P2X_30:
  s_nop 1
  v_mfma_f32_16x16x32_bf16 v[16:19], a[40:43], v[96:99], v[16:19]
  v_mfma_f32_16x16x32_bf16 v[20:23], a[40:43], v[100:103], v[20:23]
  v_mfma_f32_16x16x32_bf16 v[24:27], a[40:43], v[104:107], v[24:27]
  v_mfma_f32_16x16x32_bf16 v[28:31], a[40:43], v[108:111], v[28:31]
  v_mfma_f32_16x16x32_bf16 v[32:35], a[44:47], v[96:99], v[32:35]
  v_mfma_f32_16x16x32_bf16 v[36:39], a[44:47], v[100:103], v[36:39]
  v_mfma_f32_16x16x32_bf16 v[40:43], a[44:47], v[104:107], v[40:43]
  v_mfma_f32_16x16x32_bf16 v[44:47], a[44:47], v[108:111], v[44:47]
  v_mfma_f32_16x16x32_bf16 v[48:51], a[48:51], v[96:99], v[48:51]
  v_mfma_f32_16x16x32_bf16 v[52:55], a[48:51], v[100:103], v[52:55]
  v_mfma_f32_16x16x32_bf16 v[56:59], a[48:51], v[104:107], v[56:59]
  v_mfma_f32_16x16x32_bf16 v[60:63], a[48:51], v[108:111], v[60:63]
  v_mfma_f32_16x16x32_bf16 v[64:67], a[52:55], v[96:99], v[64:67]
  v_mfma_f32_16x16x32_bf16 v[68:71], a[52:55], v[100:103], v[68:71]
  v_mfma_f32_16x16x32_bf16 v[72:75], a[52:55], v[104:107], v[72:75]
  v_mfma_f32_16x16x32_bf16 v[76:79], a[52:55], v[108:111], v[76:79]
  v_mfma_f32_16x16x32_bf16 v[80:83], a[56:59], v[96:99], v[80:83]
  v_mfma_f32_16x16x32_bf16 v[84:87], a[56:59], v[100:103], v[84:87]
  v_mfma_f32_16x16x32_bf16 v[88:91], a[56:59], v[104:107], v[88:91]
  v_mfma_f32_16x16x32_bf16 v[92:95], a[56:59], v[108:111], v[92:95]
  s_waitcnt vmcnt(4)
  s_cmp_lt_u32 s3, 4
  s_cbranch_scc1 K1_P2X_32
  s_bitcmp1_b32 s3, 0
  s_cbranch_scc1 K1_P2O_31
  v_swap_b32 v114, v116
  v_swap_b32 v115, v117
  v_swap_b32 v122, v124
  v_swap_b32 v123, v125
  s_branch K1_P2X_32
K1_P2O_31:
  v_swap_b32 v112, v118
  v_swap_b32 v113, v119
  v_swap_b32 v120, v126
  v_swap_b32 v121, v127
K1_P2X_32:
  s_nop 1
  v_mfma_f32_16x16x32_bf16 v[16:19], v[144:147], v[112:115], v[16:19]
  v_mfma_f32_16x16x32_bf16 v[20:23], v[144:147], v[116:119], v[20:23]
  v_mfma_f32_16x16x32_bf16 v[24:27], v[144:147], v[120:123], v[24:27]
  v_mfma_f32_16x16x32_bf16 v[28:31], v[144:147], v[124:127], v[28:31]
  v_mfma_f32_16x16x32_bf16 v[32:35], v[148:151], v[112:115], v[32:35]
  v_mfma_f32_16x16x32_bf16 v[36:39], v[148:151], v[116:119], v[36:39]
  v_mfma_f32_16x16x32_bf16 v[40:43], v[148:151], v[120:123], v[40:43]
  v_mfma_f32_16x16x32_bf16 v[44:47], v[148:151], v[124:127], v[44:47]
  v_mfma_f32_16x16x32_bf16 v[48:51], v[152:155], v[112:115], v[48:51]
  v_mfma_f32_16x16x32_bf16 v[52:55], v[152:155], v[116:119], v[52:55]
  v_mfma_f32_16x16x32_bf16 v[56:59], v[152:155], v[120:123], v[56:59]
  v_mfma_f32_16x16x32_bf16 v[60:63], v[152:155], v[124:127], v[60:63]
  v_mfma_f32_16x16x32_bf16 v[64:67], v[156:159], v[112:115], v[64:67]
  v_mfma_f32_16x16x32_bf16 v[68:71], v[156:159], v[116:119], v[68:71]
  v_mfma_f32_16x16x32_bf16 v[72:75], v[156:159], v[120:123], v[72:75]
  v_mfma_f32_16x16x32_bf16 v[76:79], v[156:159], v[124:127], v[76:79]
  v_mfma_f32_16x16x32_bf16 v[80:83], v[160:163], v[112:115], v[80:83]
  v_mfma_f32_16x16x32_bf16 v[84:87], v[160:163], v[116:119], v[84:87]
  v_mfma_f32_16x16x32_bf16 v[88:91], v[160:163], v[120:123], v[88:91]
  v_mfma_f32_16x16x32_bf16 v[92:95], v[160:163], v[124:127], v[92:95]
  s_waitcnt vmcnt(0)
  s_cmp_lt_u32 s3, 4
  s_cbranch_scc1 K1_P2X_34
  s_bitcmp1_b32 s3, 0
  s_cbranch_scc1 K1_P2O_33
  v_swap_b32 v130, v132
  v_swap_b32 v131, v133
  v_swap_b32 v138, v140
  v_swap_b32 v139, v141
  s_branch K1_P2X_34
K1_P2O_33:
  v_swap_b32 v128, v134
  v_swap_b32 v129, v135
  v_swap_b32 v136, v142
  v_swap_b32 v137, v143
K1_P2X_34:
  s_nop 1
  v_mfma_f32_16x16x32_bf16 v[16:19], v[164:167], v[128:131], v[16:19]
  v_mfma_f32_16x16x32_bf16 v[20:23], v[164:167], v[132:135], v[20:23]
  v_mfma_f32_16x16x32_bf16 v[24:27], v[164:167], v[136:139], v[24:27]
  v_mfma_f32_16x16x32_bf16 v[28:31], v[164:167], v[140:143], v[28:31]
  v_mfma_f32_16x16x32_bf16 v[32:35], v[168:171], v[128:131], v[32:35]
  v_mfma_f32_16x16x32_bf16 v[36:39], v[168:171], v[132:135], v[36:39]
  v_mfma_f32_16x16x32_bf16 v[40:43], v[168:171], v[136:139], v[40:43]
  v_mfma_f32_16x16x32_bf16 v[44:47], v[168:171], v[140:143], v[44:47]
  v_mfma_f32_16x16x32_bf16 v[48:51], v[172:175], v[128:131], v[48:51]
  v_mfma_f32_16x16x32_bf16 v[52:55], v[172:175], v[132:135], v[52:55]
  v_mfma_f32_16x16x32_bf16 v[56:59], v[172:175], v[136:139], v[56:59]
  v_mfma_f32_16x16x32_bf16 v[60:63], v[172:175], v[140:143], v[60:63]
  ds_write_b128 v13, v[20:23] offset:0
  ds_write_b128 v13, v[24:27] offset:5120
  ds_write_b128 v13, v[28:31] offset:10240
  v_mfma_f32_16x16x32_bf16 v[64:67], v[176:179], v[128:131], v[64:67]
  v_mfma_f32_16x16x32_bf16 v[68:71], v[176:179], v[132:135], v[68:71]
  v_mfma_f32_16x16x32_bf16 v[72:75], v[176:179], v[136:139], v[72:75]
  v_mfma_f32_16x16x32_bf16 v[76:79], v[176:179], v[140:143], v[76:79]
  ds_write_b128 v13, v[36:39] offset:1024
  ds_write_b128 v13, v[40:43] offset:6144
  ds_write_b128 v13, v[44:47] offset:11264
  v_mfma_f32_16x16x32_bf16 v[80:83], v[180:183], v[128:131], v[80:83]
  v_mfma_f32_16x16x32_bf16 v[84:87], v[180:183], v[132:135], v[84:87]
  v_mfma_f32_16x16x32_bf16 v[88:91], v[180:183], v[136:139], v[88:91]
  v_mfma_f32_16x16x32_bf16 v[92:95], v[180:183], v[140:143], v[92:95]
  ds_write_b128 v13, v[52:55] offset:2048
  ds_write_b128 v13, v[56:59] offset:7168
  ds_write_b128 v13, v[60:63] offset:12288
K1_P2FIN:
  ds_write_b128 v13, v[68:71] offset:3072
  ds_write_b128 v13, v[72:75] offset:8192
  ds_write_b128 v13, v[76:79] offset:13312
  s_nop 7
  s_nop 7
  ds_write_b128 v13, v[84:87] offset:4096
  ds_write_b128 v13, v[88:91] offset:9216
  ds_write_b128 v13, v[92:95] offset:14336
  s_cmp_lt_u32 s3, 4
  s_cbranch_scc1 K1_P2FB
  ds_write_b128 v13, v[64:67] offset:18432
  ds_write_b128 v13, v[80:83] offset:19456
  s_waitcnt lgkmcnt(0)
  s_barrier
  ds_read_b128 v[96:99], v184 offset:0
  ds_read_b128 v[100:103], v185 offset:0
  ds_read_b128 v[104:107], v186 offset:0
  ds_read_b128 v[108:111], v187 offset:0
  ds_read_b128 v[112:115], v188 offset:0
  ds_read_b128 v[116:119], v189 offset:0
  ds_read_b128 v[120:123], v190 offset:0
  ds_read_b128 v[124:127], v184 offset:1024
  ds_read_b128 v[128:131], v185 offset:1024
  ds_read_b128 v[132:135], v186 offset:1024
  ds_read_b128 v[136:139], v187 offset:1024
  ds_read_b128 v[140:143], v188 offset:1024
  ds_read_b128 v[144:147], v189 offset:1024
  ds_read_b128 v[148:151], v190 offset:1024
  ds_read_b128 v[152:155], v184 offset:2048
  ds_read_b128 v[156:159], v185 offset:2048
  ds_read_b128 v[160:163], v186 offset:2048
  ds_read_b128 v[164:167], v187 offset:2048
  ds_read_b128 v[168:171], v188 offset:2048
  ds_read_b128 v[172:175], v189 offset:2048
  ds_read_b128 v[176:179], v190 offset:2048
  s_waitcnt lgkmcnt(15)
  v_pk_add_f32 v[96:97], v[96:97], v[100:101]
  v_pk_add_f32 v[104:105], v[104:105], v[108:109]
  v_pk_add_f32 v[98:99], v[98:99], v[102:103]
  v_pk_add_f32 v[106:107], v[106:107], v[110:111]
  v_pk_add_f32 v[16:17], v[16:17], v[96:97]
  v_pk_add_f32 v[18:19], v[18:19], v[98:99]
  v_pk_add_f32 v[16:17], v[16:17], v[104:105]
  v_pk_add_f32 v[18:19], v[18:19], v[106:107]
  s_waitcnt lgkmcnt(14)
  v_pk_add_f32 v[112:113], v[112:113], v[116:117]
  v_pk_add_f32 v[114:115], v[114:115], v[118:119]
  v_pk_add_f32 v[16:17], v[16:17], v[120:121]
  v_pk_add_f32 v[18:19], v[18:19], v[122:123]
  v_pk_add_f32 v[16:17], v[16:17], v[112:113]
  v_pk_add_f32 v[18:19], v[18:19], v[114:115]
  buffer_store_dwordx4 v[16:19], v7, s[28:31], 0 offen offset:0 sc1
  s_waitcnt lgkmcnt(10)
  v_pk_add_f32 v[124:125], v[124:125], v[128:129]
  v_pk_add_f32 v[132:133], v[132:133], v[136:137]
  v_pk_add_f32 v[126:127], v[126:127], v[130:131]
  v_pk_add_f32 v[134:135], v[134:135], v[138:139]
  v_pk_add_f32 v[32:33], v[32:33], v[124:125]
  v_pk_add_f32 v[34:35], v[34:35], v[126:127]
  v_pk_add_f32 v[32:33], v[32:33], v[132:133]
  v_pk_add_f32 v[34:35], v[34:35], v[134:135]
  s_waitcnt lgkmcnt(7)
  v_pk_add_f32 v[140:141], v[140:141], v[144:145]
  v_pk_add_f32 v[142:143], v[142:143], v[146:147]
  v_pk_add_f32 v[32:33], v[32:33], v[148:149]
  v_pk_add_f32 v[34:35], v[34:35], v[150:151]
  v_pk_add_f32 v[32:33], v[32:33], v[140:141]
  v_pk_add_f32 v[34:35], v[34:35], v[142:143]
  buffer_store_dwordx4 v[32:35], v7, s[28:31], 0 offen offset:64 sc1
  s_waitcnt lgkmcnt(3)
  v_pk_add_f32 v[152:153], v[152:153], v[156:157]
  v_pk_add_f32 v[160:161], v[160:161], v[164:165]
  v_pk_add_f32 v[154:155], v[154:155], v[158:159]
  v_pk_add_f32 v[162:163], v[162:163], v[166:167]
  v_pk_add_f32 v[48:49], v[48:49], v[152:153]
  v_pk_add_f32 v[50:51], v[50:51], v[154:155]
  v_pk_add_f32 v[48:49], v[48:49], v[160:161]
  v_pk_add_f32 v[50:51], v[50:51], v[162:163]
  s_waitcnt lgkmcnt(0)
  v_pk_add_f32 v[168:169], v[168:169], v[172:173]
  v_pk_add_f32 v[170:171], v[170:171], v[174:175]
  v_pk_add_f32 v[48:49], v[48:49], v[176:177]
  v_pk_add_f32 v[50:51], v[50:51], v[178:179]
  v_pk_add_f32 v[48:49], v[48:49], v[168:169]
  v_pk_add_f32 v[50:51], v[50:51], v[170:171]
  buffer_store_dwordx4 v[48:51], v7, s[28:31], 0 offen offset:128 sc1
  s_endpgm
K1_P2FB:
  ds_write_b128 v13, v[16:19] offset:15360
  ds_write_b128 v13, v[32:35] offset:16384
  ds_write_b128 v13, v[48:51] offset:17408
  s_waitcnt lgkmcnt(0)
  s_barrier
  ds_read_b128 v[96:99], v184 offset:3072
  ds_read_b128 v[100:103], v185 offset:3072
  ds_read_b128 v[104:107], v186 offset:3072
  ds_read_b128 v[108:111], v187 offset:3072
  ds_read_b128 v[112:115], v188 offset:3072
  ds_read_b128 v[116:119], v189 offset:3072
  ds_read_b128 v[120:123], v190 offset:3072
  ds_read_b128 v[124:127], v184 offset:4096
  ds_read_b128 v[128:131], v185 offset:4096
  ds_read_b128 v[132:135], v186 offset:4096
  ds_read_b128 v[136:139], v187 offset:4096
  ds_read_b128 v[140:143], v188 offset:4096
  ds_read_b128 v[144:147], v189 offset:4096
  ds_read_b128 v[148:151], v190 offset:4096
  s_waitcnt lgkmcnt(10)
  v_pk_add_f32 v[96:97], v[96:97], v[100:101]
  v_pk_add_f32 v[104:105], v[104:105], v[108:109]
  v_pk_add_f32 v[98:99], v[98:99], v[102:103]
  v_pk_add_f32 v[106:107], v[106:107], v[110:111]
  v_pk_add_f32 v[64:65], v[64:65], v[96:97]
  v_pk_add_f32 v[66:67], v[66:67], v[98:99]
  v_pk_add_f32 v[64:65], v[64:65], v[104:105]
  v_pk_add_f32 v[66:67], v[66:67], v[106:107]
  s_waitcnt lgkmcnt(7)
  v_pk_add_f32 v[112:113], v[112:113], v[116:117]
  v_pk_add_f32 v[114:115], v[114:115], v[118:119]
  v_pk_add_f32 v[64:65], v[64:65], v[120:121]
  v_pk_add_f32 v[66:67], v[66:67], v[122:123]
  v_pk_add_f32 v[64:65], v[64:65], v[112:113]
  v_pk_add_f32 v[66:67], v[66:67], v[114:115]
  buffer_store_dwordx4 v[64:67], v7, s[28:31], 0 offen offset:192 sc1
  s_waitcnt lgkmcnt(3)
  v_pk_add_f32 v[124:125], v[124:125], v[128:129]
  v_pk_add_f32 v[132:133], v[132:133], v[136:137]
  v_pk_add_f32 v[126:127], v[126:127], v[130:131]
  v_pk_add_f32 v[134:135], v[134:135], v[138:139]
  v_pk_add_f32 v[80:81], v[80:81], v[124:125]
  v_pk_add_f32 v[82:83], v[82:83], v[126:127]
  v_pk_add_f32 v[80:81], v[80:81], v[132:133]
  v_pk_add_f32 v[82:83], v[82:83], v[134:135]
  s_waitcnt lgkmcnt(0)
  v_pk_add_f32 v[140:141], v[140:141], v[144:145]
  v_pk_add_f32 v[142:143], v[142:143], v[146:147]
  v_pk_add_f32 v[80:81], v[80:81], v[148:149]
  v_pk_add_f32 v[82:83], v[82:83], v[150:151]
  v_pk_add_f32 v[80:81], v[80:81], v[140:141]
  v_pk_add_f32 v[82:83], v[82:83], v[142:143]
  buffer_store_dwordx4 v[80:83], v7, s[28:31], 0 offen offset:256 sc1
  s_endpgm
K1_END:
  s_endpgm
CODE_END:
.section .rodata,"a"
.p2align 6
.amdhsa_kernel gemm1_kernel
  .amdhsa_next_free_vgpr 252
  .amdhsa_next_free_sgpr 102
  .amdhsa_accum_offset 192
  .amdhsa_group_segment_fixed_size 0
  .amdhsa_kernarg_size 128
  .amdhsa_user_sgpr_count 2
  .amdhsa_user_sgpr_kernarg_segment_ptr 1
  .amdhsa_system_sgpr_workgroup_id_x 1
  .amdhsa_float_denorm_mode_32 3
.end_amdhsa_kernel
```
